```python
import torch

def _softmax(x, axis=-1):
    return torch.softmax(x, dim=axis)

def _gelu(x):
    return torch.nn.functional.gelu(x, approximate='tanh')

def _silu(x):
    return torch.nn.functional.silu(x)

def _sigmoid(x):
    return torch.sigmoid(x)

def _layernorm(x, axis=-1, eps=1e-05):
    m = x.mean(dim=axis, keepdim=True)
    v = x.var(dim=axis, keepdim=True, unbiased=False)
    return (x - m) / torch.sqrt(v + eps)

def _scatter_add(tgt, idx, src, axis=0):
    return tgt.clone().index_add_(axis, idx, src)

def _segment_sum(src, seg, n):
    out = torch.zeros((n,) + src.shape[1:], dtype=src.dtype)
    return out.index_add_(0, seg, src)

def _pad(x, pw):
    flat = tuple((v for pair in reversed(pw) for v in pair))
    return torch.nn.functional.pad(x, flat)
kernel_name = 'adaLN_cond__softmax_full_mha__dense_activation_relu__prompt'

def setup_inputs():

    _w = lambda a: (lambda t: t.to(torch.bfloat16) if t.is_floating_point() else t)(torch.as_tensor(a))

    def _A_setup():
        B, S, D = (1, 2048, 512)
        return {'x': _w((lambda *s: torch.randn(*s, dtype=torch.bfloat16) * 0.05)(B, S, D)), 'wqkv': _w((lambda *s: torch.randn(*s, dtype=torch.bfloat16) * 0.05)(D, 3 * D)), 'wo': _w((lambda *s: torch.randn(*s, dtype=torch.bfloat16) * 0.05)(D, D))}
    _A_in = _A_setup()

    def _B_setup():
        B, S, D, Dff = (1, 2048, 512, 1376)
        return {'x': _w((lambda *s: torch.randn(*s, dtype=torch.bfloat16) * 0.05)(B, S, D)), 'w1': _w((lambda *s: torch.randn(*s, dtype=torch.bfloat16) * 0.05)(D, Dff)), 'w2': _w((lambda *s: torch.randn(*s, dtype=torch.bfloat16) * 0.05)(Dff, D))}
    _B_in = _B_setup()
    return {'A_x': _A_in['x'], 'A_wqkv': _A_in['wqkv'], 'A_wo': _A_in['wo'], 'B_x': _B_in['x'], 'B_w1': _B_in['w1'], 'B_w2': _B_in['w2'], 'c': _w((lambda *s: torch.randn(*s, dtype=torch.bfloat16) * 0.1)(1, 512) * 8.0), 'w_mod': _w((lambda *s: torch.randn(*s, dtype=torch.bfloat16) * 0.1)(512, 6 * 512) * 512 ** (-0.5) * 8.0)}

def reference(A_x, A_wqkv, A_wo, B_x, B_w1, B_w2, c, w_mod):

    def _A_ref(x, wqkv, wo):
        B, S, D = x.shape
        H = 32
        Dh = D // H
        qkv = (lambda x, *d: x.permute(*d))((x @ wqkv).reshape(B, S, 3, H, Dh), 2, 0, 3, 1, 4)
        q, k, v = (qkv[0], qkv[1], qkv[2])
        scale = Dh ** (-0.5)
        scores = torch.einsum('bhqd,bhkd->bhqk', q, k) * scale
        p = _softmax(scores, axis=-1)
        o = torch.einsum('bhqk,bhkd->bhqd', p, v)
        return (lambda x, *d: x.permute(*d))(o, 0, 2, 1, 3).reshape(B, S, D) @ wo

    def _B_ref(x, w1, w2):
        h = torch.einsum('bsd,df->bsf', x, w1)
        zero = torch.zeros_like(h)
        h = torch.maximum(h, zero)
        return torch.einsum('bsf,fd->bsd', h, w2)
    x = A_x
    mod = (_silu(c) @ w_mod).reshape(c.shape[0], 6, 1, -1)
    sa, ca, ga, sb, cb, gb = (mod[:, 0].clone(), mod[:, 1].clone(), mod[:, 2].clone(), mod[:, 3].clone(), mod[:, 4].clone(), mod[:, 5].clone())
    h = _layernorm(x, axis=-1) * (1 + ca) + sa
    x = x + ga * _A_ref(h, A_wqkv, A_wo)
    h = _layernorm(x, axis=-1) * (1 + cb) + sb
    x = x + gb * _B_ref(h, B_w1, B_w2)
    return x
```

```asm
; @launch grid=(256,1,1) block=(512,1,1) lds=163840
.amdgcn_target "amdgcn-amd-amdhsa--gfx950"
.text
.globl adaLN_cond__softmax_full_mha__dense_activation_relu__prompt_kernel
.p2align 8
.type adaLN_cond__softmax_full_mha__dense_activation_relu__prompt_kernel,@function
adaLN_cond__softmax_full_mha__dense_activation_relu__prompt_kernel:
    s_load_dwordx2 s[8:9], s[0:1], 0
    s_load_dwordx2 s[4:5], s[0:1], 80
    v_readfirstlane_b32 s40, v0
    s_lshr_b32 s46, s2, 8
    s_cbranch_scc1 L_exit
    s_lshr_b32 s40, s40, 6
    s_and_b32 s41, s2, 7
    s_lshr_b32 s42, s2, 3
    s_cmp_ge_u32 s40, 4
    s_cbranch_scc1 L_H
    s_load_dwordx2 s[16:17], s[0:1], 56
    s_load_dwordx2 s[20:21], s[0:1], 48
    s_load_dwordx2 s[12:13], s[0:1], 8
    s_load_dwordx2 s[28:29], s[0:1], 64
    s_load_dwordx2 s[32:33], s[0:1], 16
    s_load_dwordx4 s[36:39], s[0:1], 32
    s_getpc_b64 s[98:99]
L_here_1:
    s_lshl_b32 s46, s42, 11
    v_lshl_add_u32 v13, v0, 3, s46
    v_min_u32 v13, L_code_end-L_here_1-4, v13
    v_mov_b32 v15, s99
    v_add_co_u32 v14, vcc, s98, v13
    s_nop 1
    v_addc_co_u32 v15, vcc, 0, v15, vcc
    global_load_dword v13, v[14:15], off
    v_and_b32 v0, 63, v0
    s_mov_b32 s18, 3145728
    s_mov_b32 s19, 0x20000
    s_mov_b32 s22, 1024
    s_mov_b32 s23, 0x20000
    s_mov_b32 s6, 18677760
    s_mov_b32 s7, 0x20000
    s_lshl_b32 s46, s40, 5
    s_add_u32 s62, s46, s42
    s_cmp_ge_u32 s62, 16
    s_cbranch_scc1 L_nomod1_2
    s_setprio 3
    s_lshl_b32 s63, s62, 8
    s_mul_i32 s50, s41, 12288
    s_add_u32 s63, s63, s50
    s_add_u32 s63, s63, 18087936
    s_lshl_b32 s62, s62, 7
    s_mul_i32 s50, s41, 393216
    s_add_u32 s62, s62, s50
    s_lshl_b32 s50, s41, 7
    v_lshrrev_b32 v26, 5, v0
    v_bfe_u32 v27, v0, 2, 2
    v_lshl_add_u32 v26, v26, 2, v27
    v_mul_u32_u24 v25, 6144, v26
    v_bfe_u32 v26, v0, 4, 1
    v_lshl_add_u32 v25, v26, 6, v25
    v_and_b32 v26, 3, v0
    v_lshl_add_u32 v25, v26, 4, v25
    v_lshlrev_b32 v26, 1, v0
    s_mov_b32 m0, 0
    s_waitcnt lgkmcnt(0)
    s_load_dword s45, s[4:5], 0
    buffer_load_ushort v24, v26, s[20:23], s50 offen
    buffer_load_dwordx4 v25, s[16:19], s62 offen lds
    s_mov_b32 m0, 1024
    s_add_u32 s62, s62, 49152
    buffer_load_dwordx4 v25, s[16:19], s62 offen lds
    s_mov_b32 m0, 2048
    s_add_u32 s62, s62, 49152
    buffer_load_dwordx4 v25, s[16:19], s62 offen lds
    s_mov_b32 m0, 3072
    s_add_u32 s62, s62, 49152
    buffer_load_dwordx4 v25, s[16:19], s62 offen lds
    s_mov_b32 m0, 4096
    s_add_u32 s62, s62, 49152
    buffer_load_dwordx4 v25, s[16:19], s62 offen lds
    s_mov_b32 m0, 5120
    s_add_u32 s62, s62, 49152
    buffer_load_dwordx4 v25, s[16:19], s62 offen lds
    s_mov_b32 m0, 6144
    s_add_u32 s62, s62, 49152
    buffer_load_dwordx4 v25, s[16:19], s62 offen lds
    s_mov_b32 m0, 7168
    s_add_u32 s62, s62, 49152
    buffer_load_dwordx4 v25, s[16:19], s62 offen lds
    v_lshlrev_b32 v5, 2, v0
    buffer_load_dword v8, v5, s[4:7], s63 offen sc1
    s_lshr_b32 s46, s42, 3
    s_lshl_b32 s43, s41, 2
    s_add_u32 s43, s43, s46
    s_and_b32 s44, s42, 7
    s_add_u32 s53, s44, s41
    s_mov_b32 s14, 1572864
    s_mov_b32 s15, 0x20000
    s_mov_b32 s30, 2097152
    s_mov_b32 s31, 0x20000
    s_mov_b32 s10, 2097152
    s_mov_b32 s11, 0x20000
    v_lshlrev_b32 v2, 4, v0
    s_mov_b32 s54, 0xffff
    s_mov_b32 s55, 0xffff
    s_mul_i32 s60, s40, 49152
    s_lshl_b32 s47, s44, 7
    s_add_u32 s60, s60, s47
    s_mul_i32 s61, s40, 6144
    v_lshrrev_b32 v4, 5, v0
    v_bfe_u32 v5, v0, 2, 2
    v_lshl_add_u32 v4, v4, 2, v5
    v_mul_u32_u24 v3, 3072, v4
    v_bfe_u32 v4, v0, 4, 1
    v_lshl_add_u32 v3, v4, 6, v3
    v_and_b32 v4, 3, v0
    v_lshl_add_u32 v3, v4, 4, v3
    v_xor_b32 v7, 32, v3
    s_barrier
    s_waitcnt lgkmcnt(0)
    s_add_u32 s45, s45, 0x9e3779b9
    s_and_b32 s3, s45, 0xff
    v_lshrrev_b32 v25, 4, v0
    v_lshlrev_b32 v27, 10, v25
    v_lshlrev_b32 v68, 4, v25
    v_bfe_u32 v25, v0, 2, 2
    v_lshl_add_u32 v27, v25, 6, v27
    v_lshl_add_u32 v69, v25, 6, v68
    v_and_b32 v25, 3, v0
    v_lshl_add_u32 v27, v25, 3, v27
    s_waitcnt vmcnt(9)
    v_lshlrev_b32 v24, 16, v24
    v_mul_f32 v25, 0xbfb8aa3b, v24
    v_exp_f32 v25, v25
    s_nop 0
    v_add_f32 v25, 1.0, v25
    v_rcp_f32 v25, v25
    s_nop 0
    v_mul_f32 v24, v24, v25
    v_cvt_pk_bf16_f32 v24, v24, v24
    ds_write_b16 v26, v24 offset:8192
    ds_read_b128 v[28:31], v68 offset:8192
    ds_read_b128 v[32:35], v68 offset:8256
    v_mov_b32 v26, v69
    v_mov_b32 v25, 0xff
    s_waitcnt vmcnt(1)
    ds_read_b64_tr_b16 v[36:37], v27 offset:0
    ds_read_b64_tr_b16 v[38:39], v27 offset:512
    ds_read_b64_tr_b16 v[40:41], v27 offset:4096
    ds_read_b64_tr_b16 v[42:43], v27 offset:4608
    ds_read_b64_tr_b16 v[44:45], v27 offset:32
    ds_read_b64_tr_b16 v[46:47], v27 offset:544
    ds_read_b64_tr_b16 v[48:49], v27 offset:4128
    ds_read_b64_tr_b16 v[50:51], v27 offset:4640
    ds_read_b64_tr_b16 v[52:53], v27 offset:256
    ds_read_b64_tr_b16 v[54:55], v27 offset:768
    ds_read_b64_tr_b16 v[56:57], v27 offset:4352
    ds_read_b64_tr_b16 v[58:59], v27 offset:4864
    ds_read_b64_tr_b16 v[60:61], v27 offset:288
    ds_read_b64_tr_b16 v[62:63], v27 offset:800
    ds_read_b64_tr_b16 v[64:65], v27 offset:4384
    ds_read_b64_tr_b16 v[66:67], v27 offset:4896
    s_waitcnt lgkmcnt(12)
    v_mfma_f32_16x16x32_bf16 v[68:71], v[36:39], v[28:31], 0
    v_mfma_f32_16x16x32_bf16 v[68:71], v[40:43], v[32:35], v[68:71]
    s_waitcnt lgkmcnt(8)
    v_mfma_f32_16x16x32_bf16 v[36:39], v[44:47], v[28:31], 0
    v_mfma_f32_16x16x32_bf16 v[36:39], v[48:51], v[32:35], v[36:39]
    s_waitcnt lgkmcnt(4)
    v_mfma_f32_16x16x32_bf16 v[44:47], v[52:55], v[28:31], 0
    v_mfma_f32_16x16x32_bf16 v[44:47], v[56:59], v[32:35], v[44:47]
    s_waitcnt lgkmcnt(0)
    v_mfma_f32_16x16x32_bf16 v[52:55], v[60:63], v[28:31], 0
    v_mfma_f32_16x16x32_bf16 v[52:55], v[64:67], v[32:35], v[52:55]
    s_nop 1
    v_mov_b32_dpp v68, v36 quad_perm:[0,1,2,3] row_mask:0xf bank_mask:0x2
    v_mov_b32_dpp v69, v37 quad_perm:[0,1,2,3] row_mask:0xf bank_mask:0x2
    v_mov_b32_dpp v70, v38 quad_perm:[0,1,2,3] row_mask:0xf bank_mask:0x2
    v_mov_b32_dpp v71, v39 quad_perm:[0,1,2,3] row_mask:0xf bank_mask:0x2
    v_mov_b32_dpp v68, v44 quad_perm:[0,1,2,3] row_mask:0xf bank_mask:0x4
    v_mov_b32_dpp v69, v45 quad_perm:[0,1,2,3] row_mask:0xf bank_mask:0x4
    v_mov_b32_dpp v70, v46 quad_perm:[0,1,2,3] row_mask:0xf bank_mask:0x4
    v_mov_b32_dpp v71, v47 quad_perm:[0,1,2,3] row_mask:0xf bank_mask:0x4
    v_mov_b32_dpp v68, v52 quad_perm:[0,1,2,3] row_mask:0xf bank_mask:0x8
    v_mov_b32_dpp v69, v53 quad_perm:[0,1,2,3] row_mask:0xf bank_mask:0x8
    v_mov_b32_dpp v70, v54 quad_perm:[0,1,2,3] row_mask:0xf bank_mask:0x8
    v_mov_b32_dpp v71, v55 quad_perm:[0,1,2,3] row_mask:0xf bank_mask:0x8
    v_bfi_b32 v69, v25, s45, v69
    v_bfi_b32 v71, v25, s45, v71
    s_mov_b32 exec_lo, 0x11111111
    s_mov_b32 exec_hi, 0x11111111
    buffer_store_dwordx4 v[68:71], v26, s[4:7], s63 offen sc1
    s_mov_b64 exec, -1
    s_setprio 0
    s_branch L_join1_3
L_nomod1_2:
    s_lshr_b32 s46, s42, 3
    s_lshl_b32 s43, s41, 2
    s_add_u32 s43, s43, s46
    s_and_b32 s44, s42, 7
    s_add_u32 s53, s44, s41
    s_mov_b32 s14, 1572864
    s_mov_b32 s15, 0x20000
    s_mov_b32 s30, 2097152
    s_mov_b32 s31, 0x20000
    s_mov_b32 s10, 2097152
    s_mov_b32 s11, 0x20000
    v_lshlrev_b32 v2, 4, v0
    s_mov_b32 s54, 0xffff
    s_mov_b32 s55, 0xffff
    s_mul_i32 s60, s40, 49152
    s_lshl_b32 s47, s44, 7
    s_add_u32 s60, s60, s47
    s_mul_i32 s61, s40, 6144
    v_lshrrev_b32 v4, 5, v0
    v_bfe_u32 v5, v0, 2, 2
    v_lshl_add_u32 v4, v4, 2, v5
    v_mul_u32_u24 v3, 3072, v4
    v_bfe_u32 v4, v0, 4, 1
    v_lshl_add_u32 v3, v4, 6, v3
    v_and_b32 v4, 3, v0
    v_lshl_add_u32 v3, v4, 4, v3
    v_xor_b32 v7, 32, v3
    s_waitcnt lgkmcnt(0)
    s_load_dword s45, s[4:5], 0
    s_barrier
L_join1_3:
    s_add_u32 s46, s53, 0
    s_and_b32 s46, s46, 7
    s_mul_i32 s46, s46, 196608
    s_add_u32 s46, s46, s60
    s_add_u32 m0, s61, 65536
    s_nop 0
    buffer_load_dwordx4 v3, s[12:15], s46 offen offset:0 lds
    buffer_load_dwordx4 v3, s[12:15], s46 offen offset:1024 lds
    buffer_load_dwordx4 v3, s[12:15], s46 offen offset:2048 lds
    s_add_u32 m0, s61, 68608
    s_add_u32 s46, s46, 24576
    buffer_load_dwordx4 v7, s[12:15], s46 offen offset:0 lds
    buffer_load_dwordx4 v7, s[12:15], s46 offen offset:1024 lds
    buffer_load_dwordx4 v7, s[12:15], s46 offen offset:2048 lds
    s_add_u32 s46, s53, 1
    s_and_b32 s46, s46, 7
    s_mul_i32 s46, s46, 196608
    s_add_u32 s46, s46, s60
    s_add_u32 m0, s61, 90112
    s_nop 0
    buffer_load_dwordx4 v3, s[12:15], s46 offen offset:0 lds
    buffer_load_dwordx4 v3, s[12:15], s46 offen offset:1024 lds
    buffer_load_dwordx4 v3, s[12:15], s46 offen offset:2048 lds
    s_add_u32 m0, s61, 93184
    s_add_u32 s46, s46, 24576
    buffer_load_dwordx4 v7, s[12:15], s46 offen offset:0 lds
    buffer_load_dwordx4 v7, s[12:15], s46 offen offset:1024 lds
    buffer_load_dwordx4 v7, s[12:15], s46 offen offset:2048 lds
    s_add_u32 s46, s53, 2
    s_and_b32 s46, s46, 7
    s_mul_i32 s46, s46, 196608
    s_add_u32 s46, s46, s60
    s_add_u32 m0, s61, 114688
    s_nop 0
    buffer_load_dwordx4 v3, s[12:15], s46 offen offset:0 lds
    buffer_load_dwordx4 v3, s[12:15], s46 offen offset:1024 lds
    buffer_load_dwordx4 v3, s[12:15], s46 offen offset:2048 lds
    s_add_u32 m0, s61, 117760
    s_add_u32 s46, s46, 24576
    buffer_load_dwordx4 v7, s[12:15], s46 offen offset:0 lds
    buffer_load_dwordx4 v7, s[12:15], s46 offen offset:1024 lds
    buffer_load_dwordx4 v7, s[12:15], s46 offen offset:2048 lds
    s_add_u32 s46, s53, 3
    s_and_b32 s46, s46, 7
    s_mul_i32 s46, s46, 196608
    s_add_u32 s46, s46, s60
    s_add_u32 m0, s61, 139264
    s_nop 0
    buffer_load_dwordx4 v3, s[12:15], s46 offen offset:0 lds
    buffer_load_dwordx4 v3, s[12:15], s46 offen offset:1024 lds
    buffer_load_dwordx4 v3, s[12:15], s46 offen offset:2048 lds
    s_add_u32 m0, s61, 142336
    s_add_u32 s46, s46, 24576
    buffer_load_dwordx4 v7, s[12:15], s46 offen offset:0 lds
    buffer_load_dwordx4 v7, s[12:15], s46 offen offset:1024 lds
    buffer_load_dwordx4 v7, s[12:15], s46 offen offset:2048 lds
    v_and_b32 v4, 15, v0
    v_lshrrev_b32 v5, 4, v0
    v_lshrrev_b32 v6, 1, v4
    v_xor_b32 v6, v6, v5
    v_lshlrev_b32 v6, 4, v6
    v_lshl_add_u32 v16, v4, 7, v6
    v_xor_b32 v17, 64, v16
    v_mul_u32_u24 v18, 3072, v5
    v_bfe_u32 v6, v0, 2, 2
    v_lshl_add_u32 v18, v6, 6, v18
    v_xor_b32 v6, s40, v5
    v_and_b32 v6, 1, v6
    v_lshl_add_u32 v18, v6, 5, v18
    v_and_b32 v6, 3, v0
    v_lshl_add_u32 v18, v6, 3, v18
    s_lshr_b32 s49, s40, 1
    s_lshl_b32 s49, s49, 8
    s_add_u32 s49, s49, 65536
    v_add_u32 v18, s49, v18
    v_add_u32 v19, 49152, v18
    v_and_b32 v6, 4, v4
    v_lshlrev_b32 v6, 1, v6
    v_and_b32 v20, 0xfffffff3, v4
    v_or_b32 v20, v20, v6
    v_and_b32 v6, 8, v4
    v_lshrrev_b32 v6, 1, v6
    v_or_b32 v20, v20, v6
    v_lshlrev_b32 v20, 4, v20
    v_and_b32 v6, 1, v5
    v_lshl_add_u32 v20, v6, 9, v20
    v_lshrrev_b32 v6, 1, v5
    v_lshl_add_u32 v20, v6, 8, v20
    s_lshl_b32 s49, s40, 11
    s_add_u32 s49, s49, 66560
    v_add_u32 v21, s49, v2
    s_lshl_b32 s62, s44, 2
    s_add_u32 s62, s62, s40
    s_lshl_b32 s62, s62, 17
    s_lshl_b32 s49, s43, 12
    s_add_u32 s62, s62, s49
    s_add_u32 s62, s62, 1048576
    s_lshl_b32 s47, s40, 10
    s_add_u32 s48, s47, 18087936
    s_cmp_ge_u32 s40, 2
    s_cselect_b32 s49, 1.0, 0
    v_add_u32 v4, s47, v2
    s_lshl_b32 s46, s40, 5
    s_add_u32 s46, s46, s42
    s_cmp_lt_u32 s46, 16
    s_cbranch_scc1 L_hastag_4
    s_waitcnt lgkmcnt(0)
    s_add_u32 s45, s45, 0x9e3779b9
    s_and_b32 s3, s45, 0xff
L_hastag_4:
    s_waitcnt vmcnt(12)
    s_barrier
    s_mov_b32 s50, s48
    buffer_load_dwordx4 v[24:27], v2, s[4:7], s50 offen sc1
    s_add_u32 s50, s50, 12288
    buffer_load_dwordx4 v[28:31], v2, s[4:7], s50 offen sc1
    s_add_u32 s50, s50, 12288
    buffer_load_dwordx4 v[32:35], v2, s[4:7], s50 offen sc1
    s_add_u32 s50, s50, 12288
    buffer_load_dwordx4 v[36:39], v2, s[4:7], s50 offen sc1
    s_add_u32 s50, s50, 12288
    buffer_load_dwordx4 v[40:43], v2, s[4:7], s50 offen sc1
    s_add_u32 s50, s50, 12288
    buffer_load_dwordx4 v[44:47], v2, s[4:7], s50 offen sc1
    s_add_u32 s50, s50, 12288
    buffer_load_dwordx4 v[48:51], v2, s[4:7], s50 offen sc1
    s_add_u32 s50, s50, 12288
    buffer_load_dwordx4 v[52:55], v2, s[4:7], s50 offen sc1
    ds_read_b64_tr_b16 v[128:129], v18 offset:0
    ds_read_b64_tr_b16 v[130:131], v18 offset:512
    ds_read_b64_tr_b16 v[132:133], v18 offset:1024
    ds_read_b64_tr_b16 v[134:135], v18 offset:1536
    ds_read_b64_tr_b16 v[136:137], v18 offset:2048
    ds_read_b64_tr_b16 v[138:139], v18 offset:2560
    ds_read_b64_tr_b16 v[140:141], v18 offset:12288
    ds_read_b64_tr_b16 v[142:143], v18 offset:12800
    ds_read_b64_tr_b16 v[144:145], v18 offset:13312
    ds_read_b64_tr_b16 v[146:147], v18 offset:13824
    ds_read_b64_tr_b16 v[148:149], v18 offset:14336
    ds_read_b64_tr_b16 v[150:151], v18 offset:14848
    ds_read_b64_tr_b16 v[152:153], v18 offset:24576
    ds_read_b64_tr_b16 v[154:155], v18 offset:25088
    ds_read_b64_tr_b16 v[156:157], v18 offset:25600
    ds_read_b64_tr_b16 v[158:159], v18 offset:26112
    ds_read_b64_tr_b16 v[160:161], v18 offset:26624
    ds_read_b64_tr_b16 v[162:163], v18 offset:27136
    ds_read_b64_tr_b16 v[164:165], v18 offset:36864
    ds_read_b64_tr_b16 v[166:167], v18 offset:37376
    ds_read_b64_tr_b16 v[168:169], v18 offset:37888
    ds_read_b64_tr_b16 v[170:171], v18 offset:38400
    ds_read_b64_tr_b16 v[172:173], v18 offset:38912
    ds_read_b64_tr_b16 v[174:175], v18 offset:39424
    s_waitcnt lgkmcnt(0)
    s_barrier
    s_add_u32 s46, s53, 4
    s_and_b32 s46, s46, 7
    s_mul_i32 s46, s46, 196608
    s_add_u32 s46, s46, s60
    s_add_u32 m0, s61, 65536
    s_nop 0
    buffer_load_dwordx4 v3, s[12:15], s46 offen offset:0 lds
    buffer_load_dwordx4 v3, s[12:15], s46 offen offset:1024 lds
    buffer_load_dwordx4 v3, s[12:15], s46 offen offset:2048 lds
    s_add_u32 m0, s61, 68608
    s_add_u32 s46, s46, 24576
    buffer_load_dwordx4 v7, s[12:15], s46 offen offset:0 lds
    buffer_load_dwordx4 v7, s[12:15], s46 offen offset:1024 lds
    buffer_load_dwordx4 v7, s[12:15], s46 offen offset:2048 lds
    s_mov_b32 s52, 400000
L_g_m1_5:
    s_waitcnt vmcnt(13)
    v_xor_b32 v25, s3, v25
    v_xor_b32 v27, s3, v27
    v_or_b32 v56, v25, v27
    s_waitcnt vmcnt(12)
    v_xor_b32 v29, s3, v29
    v_xor_b32 v31, s3, v31
    v_or3_b32 v56, v56, v29, v31
    v_pk_add_f32 v[24:25], v[24:25], v[28:29]
    v_pk_add_f32 v[26:27], v[26:27], v[30:31]
    s_waitcnt vmcnt(11)
    v_xor_b32 v33, s3, v33
    v_xor_b32 v35, s3, v35
    v_or3_b32 v56, v56, v33, v35
    v_pk_add_f32 v[24:25], v[24:25], v[32:33]
    v_pk_add_f32 v[26:27], v[26:27], v[34:35]
    s_waitcnt vmcnt(10)
    v_xor_b32 v37, s3, v37
    v_xor_b32 v39, s3, v39
    v_or3_b32 v56, v56, v37, v39
    v_pk_add_f32 v[24:25], v[24:25], v[36:37]
    v_pk_add_f32 v[26:27], v[26:27], v[38:39]
    s_waitcnt vmcnt(9)
    v_xor_b32 v41, s3, v41
    v_xor_b32 v43, s3, v43
    v_or3_b32 v56, v56, v41, v43
    v_pk_add_f32 v[24:25], v[24:25], v[40:41]
    v_pk_add_f32 v[26:27], v[26:27], v[42:43]
    s_waitcnt vmcnt(8)
    v_xor_b32 v45, s3, v45
    v_xor_b32 v47, s3, v47
    v_or3_b32 v56, v56, v45, v47
    v_pk_add_f32 v[24:25], v[24:25], v[44:45]
    v_pk_add_f32 v[26:27], v[26:27], v[46:47]
    s_waitcnt vmcnt(7)
    v_xor_b32 v49, s3, v49
    v_xor_b32 v51, s3, v51
    v_or3_b32 v56, v56, v49, v51
    v_pk_add_f32 v[24:25], v[24:25], v[48:49]
    v_pk_add_f32 v[26:27], v[26:27], v[50:51]
    s_waitcnt vmcnt(6)
    v_xor_b32 v53, s3, v53
    v_xor_b32 v55, s3, v55
    v_or3_b32 v56, v56, v53, v55
    v_pk_add_f32 v[24:25], v[24:25], v[52:53]
    v_pk_add_f32 v[26:27], v[26:27], v[54:55]
    v_and_b32 v56, 0xff, v56
    v_cmp_ne_u32 vcc, 0, v56
    s_sub_u32 s52, s52, 1
    s_cmp_eq_u32 s52, 0
    s_cbranch_scc1 L_gd_m1_6
    s_cbranch_vccz L_gd_m1_6
    s_mov_b32 s50, s48
    buffer_load_dwordx4 v[24:27], v2, s[4:7], s50 offen sc1
    s_add_u32 s50, s50, 12288
    buffer_load_dwordx4 v[28:31], v2, s[4:7], s50 offen sc1
    s_add_u32 s50, s50, 12288
    buffer_load_dwordx4 v[32:35], v2, s[4:7], s50 offen sc1
    s_add_u32 s50, s50, 12288
    buffer_load_dwordx4 v[36:39], v2, s[4:7], s50 offen sc1
    s_add_u32 s50, s50, 12288
    buffer_load_dwordx4 v[40:43], v2, s[4:7], s50 offen sc1
    s_add_u32 s50, s50, 12288
    buffer_load_dwordx4 v[44:47], v2, s[4:7], s50 offen sc1
    s_add_u32 s50, s50, 12288
    buffer_load_dwordx4 v[48:51], v2, s[4:7], s50 offen sc1
    s_add_u32 s50, s50, 12288
    buffer_load_dwordx4 v[52:55], v2, s[4:7], s50 offen sc1
    s_waitcnt vmcnt(0)
    s_branch L_g_m1_5
L_gd_m1_6:
    v_cvt_pk_bf16_f32 v28, v24, v25
    v_cvt_pk_bf16_f32 v29, v26, v27
    v_and_b32 v25, 0xffff0000, v28
    v_lshlrev_b32 v24, 16, v28
    v_and_b32 v27, 0xffff0000, v29
    v_lshlrev_b32 v26, 16, v29
    v_add_f32 v24, s49, v24
    v_add_f32 v25, s49, v25
    v_add_f32 v26, s49, v26
    v_add_f32 v27, s49, v27
    v_cvt_pk_bf16_f32 v28, v24, v25
    v_cvt_pk_bf16_f32 v29, v26, v27
    v_and_b32 v25, 0xffff0000, v28
    v_lshlrev_b32 v24, 16, v28
    v_and_b32 v27, 0xffff0000, v29
    v_lshlrev_b32 v26, 16, v29
    ds_write_b128 v4, v[24:27] offset:57344
    s_waitcnt lgkmcnt(0)
    s_barrier
    s_cmp_eq_u32 s40, 1
    s_cselect_b32 s24, s36, s38
    s_cselect_b32 s25, s37, s39
    s_mov_b32 s26, 1409024
    s_mov_b32 s46, 5504
    s_mov_b32 s47, 88
    s_cmp_eq_u32 s40, 0
    s_cselect_b32 s24, s32, s24
    s_cselect_b32 s25, s33, s25
    s_cselect_b32 s26, 524288, s26
    s_cselect_b32 s46, 2048, s46
    s_cselect_b32 s47, 32, s47
    s_cmp_eq_u32 s40, 3
    s_cselect_b32 s24, s16, s24
    s_cselect_b32 s25, s17, s25
    s_cselect_b32 s26, s18, s26
    s_cselect_b32 s46, 12288, s46
    s_cselect_b32 s47, 128, s47
    s_cselect_b32 s50, 2048, 0
    s_mov_b32 s27, 0x20000
    s_mul_i32 s46, s46, s2
    s_add_u32 s46, s46, s50
    v_lshrrev_b32 v9, 5, v0
    v_mul_u32_u24 v9, s50, v9
    v_mad_u32_u24 v9, v0, s47, v9
    buffer_load_dword v23, v9, s[24:27], s46 offen
    s_lshl_b32 s46, s44, 2
    s_add_u32 s46, s46, s40
    s_lshl_b32 s46, s46, 5
    s_add_u32 s46, s46, s43
    s_lshl_b32 s46, s46, 7
    s_add_u32 s47, s46, 18513920
    v_mov_b32 v22, s47
    s_mov_b64 exec, 7
    buffer_load_dword v22, v22, s[4:7], 0 offen sc1
    s_mov_b64 exec, -1
    ds_read_b64_tr_b16 v[176:177], v19 offset:0
    ds_read_b64_tr_b16 v[178:179], v19 offset:512
    ds_read_b64_tr_b16 v[180:181], v19 offset:1024
    ds_read_b64_tr_b16 v[182:183], v19 offset:1536
    ds_read_b64_tr_b16 v[184:185], v19 offset:2048
    ds_read_b64_tr_b16 v[186:187], v19 offset:2560
    ds_read_b64_tr_b16 v[188:189], v19 offset:12288
    ds_read_b64_tr_b16 v[190:191], v19 offset:12800
    ds_read_b64_tr_b16 v[192:193], v19 offset:13312
    ds_read_b64_tr_b16 v[194:195], v19 offset:13824
    ds_read_b64_tr_b16 v[196:197], v19 offset:14336
    ds_read_b64_tr_b16 v[198:199], v19 offset:14848
    ds_read_b64_tr_b16 v[200:201], v19 offset:24576
    ds_read_b64_tr_b16 v[202:203], v19 offset:25088
    ds_read_b64_tr_b16 v[204:205], v19 offset:25600
    ds_read_b64_tr_b16 v[206:207], v19 offset:26112
    ds_read_b64_tr_b16 v[208:209], v19 offset:26624
    ds_read_b64_tr_b16 v[210:211], v19 offset:27136
    ds_read_b64_tr_b16 v[212:213], v19 offset:36864
    ds_read_b64_tr_b16 v[214:215], v19 offset:37376
    ds_read_b64_tr_b16 v[216:217], v19 offset:37888
    ds_read_b64_tr_b16 v[218:219], v19 offset:38400
    ds_read_b64_tr_b16 v[220:221], v19 offset:38912
    ds_read_b64_tr_b16 v[222:223], v19 offset:39424
    s_lshl_b32 s48, s43, 3
    s_add_u32 s83, s48, s44
    s_lshl_b32 s83, s83, 7
    s_add_u32 s84, s48, s40
    s_lshl_b32 s84, s84, 7
    s_mul_i32 s85, s83, 10
    s_add_u32 s85, s85, 18186240
    s_mul_i32 s86, s84, 10
    s_add_u32 s86, s86, 18186240
    s_and_b32 s50, s40, 1
    s_lshl_b32 s65, s50, 6
    s_add_u32 s65, s65, 0
    s_lshl_b32 s64, s43, 1
    s_bfe_u32 s49, s40, 0x10001
    s_add_u32 s64, s64, s49
    s_lshl_b32 s64, s64, 15
    s_lshl_b32 s48, s44, 7
    s_add_u32 s64, s64, s48
    s_add_u32 s64, s64, s65
    s_lshl_b32 s48, s44, 1
    s_add_u32 s48, s48, s50
    s_lshl_b32 s68, s48, 15
    s_add_u32 s68, s68, 524288
    s_mul_i32 s66, s48, 90112
    s_mul_i32 s49, s49, 11264
    s_add_u32 s66, s66, s49
    s_add_u32 s66, s66, 16646144
    s_and_b32 s47, s40, 3
    s_lshl_b32 s46, s44, 2
    s_add_u32 s46, s46, s47
    s_lshl_b32 s56, s46, 17
    s_add_u32 s56, s56, 1048576
    s_lshl_b32 s70, s46, 12
    s_add_u32 s90, s70, 18513920
    s_add_u32 s70, s70, 131072
    s_lshl_b32 s81, s40, 13
    s_add_u32 s81, s81, 98304
    s_mul_i32 s58, s44, 11
    s_min_u32 s48, s47, 2
    s_add_u32 s58, s58, s48
    s_add_u32 s58, s58, 8
    s_lshl_b32 s59, s58, 14
    s_add_u32 s59, s59, 15204352
    s_cmp_eq_u32 s40, 3
    s_cselect_b32 s59, 0x40000000, s59
    s_and_b32 s57, s43, 28
    s_lshl_b32 s57, s57, 12
    s_waitcnt lgkmcnt(0)
    s_barrier
    ds_read_b128 v[72:75], v16 offset:0
    ds_read_b128 v[76:79], v16 offset:2048
    ds_read_b128 v[80:83], v16 offset:4096
    ds_read_b128 v[84:87], v16 offset:6144
    ds_read_b128 v[88:91], v17 offset:0
    ds_read_b128 v[92:95], v17 offset:2048
    ds_read_b128 v[96:99], v17 offset:4096
    ds_read_b128 v[100:103], v17 offset:6144
    s_waitcnt lgkmcnt(4)
    v_mfma_f32_16x16x32_bf16 v[24:27], v[128:131], v[72:75], 0
    ds_read_b128 v[104:107], v16 offset:8192
    v_mfma_f32_16x16x32_bf16 v[40:43], v[132:135], v[72:75], 0
    ds_read_b128 v[108:111], v16 offset:10240
    v_mfma_f32_16x16x32_bf16 v[56:59], v[72:75], v[136:139], 0
    ds_read_b128 v[112:115], v16 offset:12288
    v_mfma_f32_16x16x32_bf16 v[28:31], v[128:131], v[76:79], 0
    ds_read_b128 v[116:119], v16 offset:14336
    v_mfma_f32_16x16x32_bf16 v[44:47], v[132:135], v[76:79], 0
    s_add_u32 s46, s53, 5
    s_and_b32 s46, s46, 7
    s_mul_i32 s46, s46, 196608
    s_add_u32 s46, s46, s60
    s_add_u32 m0, s61, 90112
    s_nop 0
    buffer_load_dwordx4 v3, s[12:15], s46 offen offset:0 lds
    v_mfma_f32_16x16x32_bf16 v[60:63], v[76:79], v[136:139], 0
    v_mfma_f32_16x16x32_bf16 v[32:35], v[128:131], v[80:83], 0
    v_mfma_f32_16x16x32_bf16 v[48:51], v[132:135], v[80:83], 0
    buffer_load_dwordx4 v3, s[12:15], s46 offen offset:1024 lds
    v_mfma_f32_16x16x32_bf16 v[64:67], v[80:83], v[136:139], 0
    v_mfma_f32_16x16x32_bf16 v[36:39], v[128:131], v[84:87], 0
    v_mfma_f32_16x16x32_bf16 v[52:55], v[132:135], v[84:87], 0
    buffer_load_dwordx4 v3, s[12:15], s46 offen offset:2048 lds
    v_mfma_f32_16x16x32_bf16 v[68:71], v[84:87], v[136:139], 0
    s_waitcnt lgkmcnt(4)
    v_mfma_f32_16x16x32_bf16 v[24:27], v[140:143], v[88:91], v[24:27]
    ds_read_b128 v[72:75], v17 offset:8192
    v_mfma_f32_16x16x32_bf16 v[40:43], v[144:147], v[88:91], v[40:43]
    ds_read_b128 v[76:79], v17 offset:10240
    v_mfma_f32_16x16x32_bf16 v[56:59], v[88:91], v[148:151], v[56:59]
    ds_read_b128 v[80:83], v17 offset:12288
    v_mfma_f32_16x16x32_bf16 v[28:31], v[140:143], v[92:95], v[28:31]
    ds_read_b128 v[84:87], v17 offset:14336
    v_mfma_f32_16x16x32_bf16 v[44:47], v[144:147], v[92:95], v[44:47]
    s_add_u32 m0, s61, 93184
    s_add_u32 s46, s46, 24576
    buffer_load_dwordx4 v7, s[12:15], s46 offen offset:0 lds
    v_mfma_f32_16x16x32_bf16 v[60:63], v[92:95], v[148:151], v[60:63]
    v_mfma_f32_16x16x32_bf16 v[32:35], v[140:143], v[96:99], v[32:35]
    v_mfma_f32_16x16x32_bf16 v[48:51], v[144:147], v[96:99], v[48:51]
    buffer_load_dwordx4 v7, s[12:15], s46 offen offset:1024 lds
    v_mfma_f32_16x16x32_bf16 v[64:67], v[96:99], v[148:151], v[64:67]
    v_mfma_f32_16x16x32_bf16 v[36:39], v[140:143], v[100:103], v[36:39]
    v_mfma_f32_16x16x32_bf16 v[52:55], v[144:147], v[100:103], v[52:55]
    buffer_load_dwordx4 v7, s[12:15], s46 offen offset:2048 lds
    v_mfma_f32_16x16x32_bf16 v[68:71], v[100:103], v[148:151], v[68:71]
    s_waitcnt lgkmcnt(4)
    v_mfma_f32_16x16x32_bf16 v[24:27], v[152:155], v[104:107], v[24:27]
    ds_read_b128 v[88:91], v16 offset:16384
    v_mfma_f32_16x16x32_bf16 v[40:43], v[156:159], v[104:107], v[40:43]
    ds_read_b128 v[92:95], v16 offset:18432
    v_mfma_f32_16x16x32_bf16 v[56:59], v[104:107], v[160:163], v[56:59]
    ds_read_b128 v[96:99], v16 offset:20480
    v_mfma_f32_16x16x32_bf16 v[28:31], v[152:155], v[108:111], v[28:31]
    ds_read_b128 v[100:103], v16 offset:22528
    v_mfma_f32_16x16x32_bf16 v[44:47], v[156:159], v[108:111], v[44:47]
    s_add_u32 s46, s53, 6
    s_and_b32 s46, s46, 7
    s_mul_i32 s46, s46, 196608
    s_add_u32 s46, s46, s60
    s_add_u32 m0, s61, 114688
    s_nop 0
    buffer_load_dwordx4 v3, s[12:15], s46 offen offset:0 lds
    v_mfma_f32_16x16x32_bf16 v[60:63], v[108:111], v[160:163], v[60:63]
    v_mfma_f32_16x16x32_bf16 v[32:35], v[152:155], v[112:115], v[32:35]
    v_mfma_f32_16x16x32_bf16 v[48:51], v[156:159], v[112:115], v[48:51]
    buffer_load_dwordx4 v3, s[12:15], s46 offen offset:1024 lds
    v_mfma_f32_16x16x32_bf16 v[64:67], v[112:115], v[160:163], v[64:67]
    v_mfma_f32_16x16x32_bf16 v[36:39], v[152:155], v[116:119], v[36:39]
    v_mfma_f32_16x16x32_bf16 v[52:55], v[156:159], v[116:119], v[52:55]
    buffer_load_dwordx4 v3, s[12:15], s46 offen offset:2048 lds
    v_mfma_f32_16x16x32_bf16 v[68:71], v[116:119], v[160:163], v[68:71]
    s_waitcnt lgkmcnt(4)
    v_mfma_f32_16x16x32_bf16 v[24:27], v[164:167], v[72:75], v[24:27]
    ds_read_b128 v[104:107], v17 offset:16384
    v_mfma_f32_16x16x32_bf16 v[40:43], v[168:171], v[72:75], v[40:43]
    ds_read_b128 v[108:111], v17 offset:18432
    v_mfma_f32_16x16x32_bf16 v[56:59], v[72:75], v[172:175], v[56:59]
    ds_read_b128 v[112:115], v17 offset:20480
    v_mfma_f32_16x16x32_bf16 v[28:31], v[164:167], v[76:79], v[28:31]
    ds_read_b128 v[116:119], v17 offset:22528
    v_mfma_f32_16x16x32_bf16 v[44:47], v[168:171], v[76:79], v[44:47]
    s_add_u32 m0, s61, 117760
    s_add_u32 s46, s46, 24576
    buffer_load_dwordx4 v7, s[12:15], s46 offen offset:0 lds
    v_mfma_f32_16x16x32_bf16 v[60:63], v[76:79], v[172:175], v[60:63]
    v_mfma_f32_16x16x32_bf16 v[32:35], v[164:167], v[80:83], v[32:35]
    v_mfma_f32_16x16x32_bf16 v[48:51], v[168:171], v[80:83], v[48:51]
    buffer_load_dwordx4 v7, s[12:15], s46 offen offset:1024 lds
    v_mfma_f32_16x16x32_bf16 v[64:67], v[80:83], v[172:175], v[64:67]
    v_mfma_f32_16x16x32_bf16 v[36:39], v[164:167], v[84:87], v[36:39]
    v_mfma_f32_16x16x32_bf16 v[52:55], v[168:171], v[84:87], v[52:55]
    buffer_load_dwordx4 v7, s[12:15], s46 offen offset:2048 lds
    v_mfma_f32_16x16x32_bf16 v[68:71], v[84:87], v[172:175], v[68:71]
    s_waitcnt lgkmcnt(4)
    v_mfma_f32_16x16x32_bf16 v[24:27], v[176:179], v[88:91], v[24:27]
    ds_read_b128 v[72:75], v16 offset:24576
    v_mfma_f32_16x16x32_bf16 v[40:43], v[180:183], v[88:91], v[40:43]
    ds_read_b128 v[76:79], v16 offset:26624
    v_mfma_f32_16x16x32_bf16 v[56:59], v[88:91], v[184:187], v[56:59]
    ds_read_b128 v[80:83], v16 offset:28672
    v_mfma_f32_16x16x32_bf16 v[28:31], v[176:179], v[92:95], v[28:31]
    ds_read_b128 v[84:87], v16 offset:30720
    v_mfma_f32_16x16x32_bf16 v[44:47], v[180:183], v[92:95], v[44:47]
    s_add_u32 s46, s53, 7
    s_and_b32 s46, s46, 7
    s_mul_i32 s46, s46, 196608
    s_add_u32 s46, s46, s60
    s_add_u32 m0, s61, 139264
    s_nop 0
    buffer_load_dwordx4 v3, s[12:15], s46 offen offset:0 lds
    v_mfma_f32_16x16x32_bf16 v[60:63], v[92:95], v[184:187], v[60:63]
    v_mfma_f32_16x16x32_bf16 v[32:35], v[176:179], v[96:99], v[32:35]
    v_mfma_f32_16x16x32_bf16 v[48:51], v[180:183], v[96:99], v[48:51]
    buffer_load_dwordx4 v3, s[12:15], s46 offen offset:1024 lds
    v_mfma_f32_16x16x32_bf16 v[64:67], v[96:99], v[184:187], v[64:67]
    v_mfma_f32_16x16x32_bf16 v[36:39], v[176:179], v[100:103], v[36:39]
    v_mfma_f32_16x16x32_bf16 v[52:55], v[180:183], v[100:103], v[52:55]
    buffer_load_dwordx4 v3, s[12:15], s46 offen offset:2048 lds
    v_mfma_f32_16x16x32_bf16 v[68:71], v[100:103], v[184:187], v[68:71]
    s_waitcnt lgkmcnt(4)
    v_mfma_f32_16x16x32_bf16 v[24:27], v[188:191], v[104:107], v[24:27]
    ds_read_b128 v[88:91], v17 offset:24576
    v_mfma_f32_16x16x32_bf16 v[40:43], v[192:195], v[104:107], v[40:43]
    ds_read_b128 v[92:95], v17 offset:26624
    v_mfma_f32_16x16x32_bf16 v[56:59], v[104:107], v[196:199], v[56:59]
    ds_read_b128 v[96:99], v17 offset:28672
    v_mfma_f32_16x16x32_bf16 v[28:31], v[188:191], v[108:111], v[28:31]
    ds_read_b128 v[100:103], v17 offset:30720
    v_mfma_f32_16x16x32_bf16 v[44:47], v[192:195], v[108:111], v[44:47]
    s_add_u32 m0, s61, 142336
    s_add_u32 s46, s46, 24576
    buffer_load_dwordx4 v7, s[12:15], s46 offen offset:0 lds
    v_mfma_f32_16x16x32_bf16 v[60:63], v[108:111], v[196:199], v[60:63]
    v_mfma_f32_16x16x32_bf16 v[32:35], v[188:191], v[112:115], v[32:35]
    v_mfma_f32_16x16x32_bf16 v[48:51], v[192:195], v[112:115], v[48:51]
    buffer_load_dwordx4 v7, s[12:15], s46 offen offset:1024 lds
    v_mfma_f32_16x16x32_bf16 v[64:67], v[112:115], v[196:199], v[64:67]
    v_mfma_f32_16x16x32_bf16 v[36:39], v[188:191], v[116:119], v[36:39]
    v_mfma_f32_16x16x32_bf16 v[52:55], v[192:195], v[116:119], v[52:55]
    buffer_load_dwordx4 v7, s[12:15], s46 offen offset:2048 lds
    v_mfma_f32_16x16x32_bf16 v[68:71], v[116:119], v[196:199], v[68:71]
    s_waitcnt lgkmcnt(4)
    v_mfma_f32_16x16x32_bf16 v[24:27], v[200:203], v[72:75], v[24:27]
    s_waitcnt vmcnt(12)
    s_barrier
    ds_read_b64_tr_b16 v[128:129], v18 offset:0
    v_mfma_f32_16x16x32_bf16 v[40:43], v[204:207], v[72:75], v[40:43]
    ds_read_b64_tr_b16 v[130:131], v18 offset:512
    v_mfma_f32_16x16x32_bf16 v[56:59], v[72:75], v[208:211], v[56:59]
    ds_read_b64_tr_b16 v[132:133], v18 offset:1024
    v_mfma_f32_16x16x32_bf16 v[28:31], v[200:203], v[76:79], v[28:31]
    ds_read_b64_tr_b16 v[134:135], v18 offset:1536
    v_mfma_f32_16x16x32_bf16 v[44:47], v[204:207], v[76:79], v[44:47]
    ds_read_b64_tr_b16 v[136:137], v18 offset:2048
    v_mfma_f32_16x16x32_bf16 v[60:63], v[76:79], v[208:211], v[60:63]
    ds_read_b64_tr_b16 v[138:139], v18 offset:2560
    v_mfma_f32_16x16x32_bf16 v[32:35], v[200:203], v[80:83], v[32:35]
    ds_read_b128 v[104:107], v16 offset:32768
    v_mfma_f32_16x16x32_bf16 v[48:51], v[204:207], v[80:83], v[48:51]
    ds_read_b128 v[108:111], v16 offset:34816
    v_mfma_f32_16x16x32_bf16 v[64:67], v[80:83], v[208:211], v[64:67]
    ds_read_b128 v[112:115], v16 offset:36864
    v_mfma_f32_16x16x32_bf16 v[36:39], v[200:203], v[84:87], v[36:39]
    ds_read_b128 v[116:119], v16 offset:38912
    v_mfma_f32_16x16x32_bf16 v[52:55], v[204:207], v[84:87], v[52:55]
    v_mfma_f32_16x16x32_bf16 v[68:71], v[84:87], v[208:211], v[68:71]
    s_waitcnt lgkmcnt(10)
    v_mfma_f32_16x16x32_bf16 v[24:27], v[212:215], v[88:91], v[24:27]
    ds_read_b64_tr_b16 v[140:141], v18 offset:12288
    v_mfma_f32_16x16x32_bf16 v[40:43], v[216:219], v[88:91], v[40:43]
    ds_read_b64_tr_b16 v[142:143], v18 offset:12800
    v_mfma_f32_16x16x32_bf16 v[56:59], v[88:91], v[220:223], v[56:59]
    ds_read_b64_tr_b16 v[144:145], v18 offset:13312
    v_mfma_f32_16x16x32_bf16 v[28:31], v[212:215], v[92:95], v[28:31]
    ds_read_b64_tr_b16 v[146:147], v18 offset:13824
    v_mfma_f32_16x16x32_bf16 v[44:47], v[216:219], v[92:95], v[44:47]
    ds_read_b64_tr_b16 v[148:149], v18 offset:14336
    v_mfma_f32_16x16x32_bf16 v[60:63], v[92:95], v[220:223], v[60:63]
    ds_read_b64_tr_b16 v[150:151], v18 offset:14848
    v_mfma_f32_16x16x32_bf16 v[32:35], v[212:215], v[96:99], v[32:35]
    ds_read_b128 v[72:75], v17 offset:32768
    v_mfma_f32_16x16x32_bf16 v[48:51], v[216:219], v[96:99], v[48:51]
    ds_read_b128 v[76:79], v17 offset:34816
    v_mfma_f32_16x16x32_bf16 v[64:67], v[96:99], v[220:223], v[64:67]
    ds_read_b128 v[80:83], v17 offset:36864
    v_mfma_f32_16x16x32_bf16 v[36:39], v[212:215], v[100:103], v[36:39]
    ds_read_b128 v[84:87], v17 offset:38912
    v_mfma_f32_16x16x32_bf16 v[52:55], v[216:219], v[100:103], v[52:55]
    v_mfma_f32_16x16x32_bf16 v[68:71], v[100:103], v[220:223], v[68:71]
    s_waitcnt lgkmcnt(10)
    v_mfma_f32_16x16x32_bf16 v[24:27], v[128:131], v[104:107], v[24:27]
    ds_read_b64_tr_b16 v[152:153], v18 offset:24576
    v_mfma_f32_16x16x32_bf16 v[40:43], v[132:135], v[104:107], v[40:43]
    ds_read_b64_tr_b16 v[154:155], v18 offset:25088
    v_mfma_f32_16x16x32_bf16 v[56:59], v[104:107], v[136:139], v[56:59]
    ds_read_b64_tr_b16 v[156:157], v18 offset:25600
    v_mfma_f32_16x16x32_bf16 v[28:31], v[128:131], v[108:111], v[28:31]
    ds_read_b64_tr_b16 v[158:159], v18 offset:26112
    v_mfma_f32_16x16x32_bf16 v[44:47], v[132:135], v[108:111], v[44:47]
    ds_read_b64_tr_b16 v[160:161], v18 offset:26624
    v_mfma_f32_16x16x32_bf16 v[60:63], v[108:111], v[136:139], v[60:63]
    ds_read_b64_tr_b16 v[162:163], v18 offset:27136
    v_mfma_f32_16x16x32_bf16 v[32:35], v[128:131], v[112:115], v[32:35]
    ds_read_b128 v[88:91], v16 offset:40960
    v_mfma_f32_16x16x32_bf16 v[48:51], v[132:135], v[112:115], v[48:51]
    ds_read_b128 v[92:95], v16 offset:43008
    v_mfma_f32_16x16x32_bf16 v[64:67], v[112:115], v[136:139], v[64:67]
    ds_read_b128 v[96:99], v16 offset:45056
    v_mfma_f32_16x16x32_bf16 v[36:39], v[128:131], v[116:119], v[36:39]
    ds_read_b128 v[100:103], v16 offset:47104
    v_mfma_f32_16x16x32_bf16 v[52:55], v[132:135], v[116:119], v[52:55]
    v_mfma_f32_16x16x32_bf16 v[68:71], v[116:119], v[136:139], v[68:71]
    s_waitcnt lgkmcnt(10)
    v_mfma_f32_16x16x32_bf16 v[24:27], v[140:143], v[72:75], v[24:27]
    ds_read_b64_tr_b16 v[164:165], v18 offset:36864
    v_mfma_f32_16x16x32_bf16 v[40:43], v[144:147], v[72:75], v[40:43]
    ds_read_b64_tr_b16 v[166:167], v18 offset:37376
    v_mfma_f32_16x16x32_bf16 v[56:59], v[72:75], v[148:151], v[56:59]
    ds_read_b64_tr_b16 v[168:169], v18 offset:37888
    v_mfma_f32_16x16x32_bf16 v[28:31], v[140:143], v[76:79], v[28:31]
    ds_read_b64_tr_b16 v[170:171], v18 offset:38400
    v_mfma_f32_16x16x32_bf16 v[44:47], v[144:147], v[76:79], v[44:47]
    ds_read_b64_tr_b16 v[172:173], v18 offset:38912
    v_mfma_f32_16x16x32_bf16 v[60:63], v[76:79], v[148:151], v[60:63]
    ds_read_b64_tr_b16 v[174:175], v18 offset:39424
    v_mfma_f32_16x16x32_bf16 v[32:35], v[140:143], v[80:83], v[32:35]
    ds_read_b128 v[104:107], v17 offset:40960
    v_mfma_f32_16x16x32_bf16 v[48:51], v[144:147], v[80:83], v[48:51]
    ds_read_b128 v[108:111], v17 offset:43008
    v_mfma_f32_16x16x32_bf16 v[64:67], v[80:83], v[148:151], v[64:67]
    ds_read_b128 v[112:115], v17 offset:45056
    v_mfma_f32_16x16x32_bf16 v[36:39], v[140:143], v[84:87], v[36:39]
    ds_read_b128 v[116:119], v17 offset:47104
    v_mfma_f32_16x16x32_bf16 v[52:55], v[144:147], v[84:87], v[52:55]
    v_mfma_f32_16x16x32_bf16 v[68:71], v[84:87], v[148:151], v[68:71]
    s_waitcnt lgkmcnt(10)
    v_mfma_f32_16x16x32_bf16 v[40:43], v[156:159], v[88:91], v[40:43]
    s_waitcnt vmcnt(0)
    s_barrier
    ds_read_b64_tr_b16 v[176:177], v19 offset:0
    ds_read_b64_tr_b16 v[178:179], v19 offset:512
    v_mfma_f32_16x16x32_bf16 v[56:59], v[88:91], v[160:163], v[56:59]
    ds_read_b64_tr_b16 v[180:181], v19 offset:1024
    v_mfma_f32_16x16x32_bf16 v[44:47], v[156:159], v[92:95], v[44:47]
    ds_read_b64_tr_b16 v[182:183], v19 offset:1536
    v_mfma_f32_16x16x32_bf16 v[60:63], v[92:95], v[160:163], v[60:63]
    ds_read_b64_tr_b16 v[184:185], v19 offset:2048
    v_mfma_f32_16x16x32_bf16 v[48:51], v[156:159], v[96:99], v[48:51]
    ds_read_b64_tr_b16 v[186:187], v19 offset:2560
    ds_read_b128 v[72:75], v16 offset:49152
    v_mfma_f32_16x16x32_bf16 v[64:67], v[96:99], v[160:163], v[64:67]
    ds_read_b128 v[76:79], v16 offset:51200
    v_mfma_f32_16x16x32_bf16 v[52:55], v[156:159], v[100:103], v[52:55]
    ds_read_b128 v[80:83], v16 offset:53248
    v_mfma_f32_16x16x32_bf16 v[68:71], v[100:103], v[160:163], v[68:71]
    ds_read_b128 v[84:87], v16 offset:55296
    s_waitcnt lgkmcnt(10)
    v_mfma_f32_16x16x32_bf16 v[40:43], v[168:171], v[104:107], v[40:43]
    ds_read_b64_tr_b16 v[188:189], v19 offset:12288
    ds_read_b64_tr_b16 v[190:191], v19 offset:12800
    v_mfma_f32_16x16x32_bf16 v[56:59], v[104:107], v[172:175], v[56:59]
    ds_read_b64_tr_b16 v[192:193], v19 offset:13312
    v_mfma_f32_16x16x32_bf16 v[44:47], v[168:171], v[108:111], v[44:47]
    ds_read_b64_tr_b16 v[194:195], v19 offset:13824
    v_mfma_f32_16x16x32_bf16 v[60:63], v[108:111], v[172:175], v[60:63]
    ds_read_b64_tr_b16 v[196:197], v19 offset:14336
    v_mfma_f32_16x16x32_bf16 v[48:51], v[168:171], v[112:115], v[48:51]
    ds_read_b64_tr_b16 v[198:199], v19 offset:14848
    ds_read_b128 v[88:91], v17 offset:49152
    v_mfma_f32_16x16x32_bf16 v[64:67], v[112:115], v[172:175], v[64:67]
    ds_read_b128 v[92:95], v17 offset:51200
    v_mfma_f32_16x16x32_bf16 v[52:55], v[168:171], v[116:119], v[52:55]
    ds_read_b128 v[96:99], v17 offset:53248
    v_mfma_f32_16x16x32_bf16 v[68:71], v[116:119], v[172:175], v[68:71]
    ds_read_b128 v[100:103], v17 offset:55296
    s_waitcnt lgkmcnt(10)
    v_mfma_f32_16x16x32_bf16 v[40:43], v[180:183], v[72:75], v[40:43]
    ds_read_b64_tr_b16 v[200:201], v19 offset:24576
    ds_read_b64_tr_b16 v[202:203], v19 offset:25088
    v_mfma_f32_16x16x32_bf16 v[56:59], v[72:75], v[184:187], v[56:59]
    ds_read_b64_tr_b16 v[204:205], v19 offset:25600
    v_mfma_f32_16x16x32_bf16 v[44:47], v[180:183], v[76:79], v[44:47]
    ds_read_b64_tr_b16 v[206:207], v19 offset:26112
    v_mfma_f32_16x16x32_bf16 v[60:63], v[76:79], v[184:187], v[60:63]
    ds_read_b64_tr_b16 v[208:209], v19 offset:26624
    v_mfma_f32_16x16x32_bf16 v[48:51], v[180:183], v[80:83], v[48:51]
    ds_read_b64_tr_b16 v[210:211], v19 offset:27136
    ds_read_b128 v[104:107], v16 offset:57344
    v_mfma_f32_16x16x32_bf16 v[64:67], v[80:83], v[184:187], v[64:67]
    ds_read_b128 v[108:111], v16 offset:59392
    v_mfma_f32_16x16x32_bf16 v[52:55], v[180:183], v[84:87], v[52:55]
    ds_read_b128 v[112:115], v16 offset:61440
    v_mfma_f32_16x16x32_bf16 v[68:71], v[84:87], v[184:187], v[68:71]
    ds_read_b128 v[116:119], v16 offset:63488
    s_waitcnt lgkmcnt(10)
    v_mfma_f32_16x16x32_bf16 v[40:43], v[192:195], v[88:91], v[40:43]
    ds_read_b64_tr_b16 v[212:213], v19 offset:36864
    ds_read_b64_tr_b16 v[214:215], v19 offset:37376
    v_mfma_f32_16x16x32_bf16 v[56:59], v[88:91], v[196:199], v[56:59]
    ds_read_b64_tr_b16 v[216:217], v19 offset:37888
    v_mfma_f32_16x16x32_bf16 v[44:47], v[192:195], v[92:95], v[44:47]
    ds_read_b64_tr_b16 v[218:219], v19 offset:38400
    v_mfma_f32_16x16x32_bf16 v[60:63], v[92:95], v[196:199], v[60:63]
    ds_read_b64_tr_b16 v[220:221], v19 offset:38912
    v_mfma_f32_16x16x32_bf16 v[48:51], v[192:195], v[96:99], v[48:51]
    ds_read_b64_tr_b16 v[222:223], v19 offset:39424
    ds_read_b128 v[72:75], v17 offset:57344
    v_mfma_f32_16x16x32_bf16 v[64:67], v[96:99], v[196:199], v[64:67]
    ds_read_b128 v[76:79], v17 offset:59392
    v_mfma_f32_16x16x32_bf16 v[52:55], v[192:195], v[100:103], v[52:55]
    ds_read_b128 v[80:83], v17 offset:61440
    v_mfma_f32_16x16x32_bf16 v[68:71], v[100:103], v[196:199], v[68:71]
    ds_read_b128 v[84:87], v17 offset:63488
    s_waitcnt lgkmcnt(10)
    v_mfma_f32_16x16x32_bf16 v[40:43], v[204:207], v[104:107], v[40:43]
    ds_read_b128 v[88:91], v16 offset:40960
    v_mfma_f32_16x16x32_bf16 v[56:59], v[104:107], v[208:211], v[56:59]
    ds_read_b128 v[92:95], v16 offset:43008
    v_mfma_f32_16x16x32_bf16 v[44:47], v[204:207], v[108:111], v[44:47]
    ds_read_b128 v[96:99], v16 offset:45056
    v_mfma_f32_16x16x32_bf16 v[60:63], v[108:111], v[208:211], v[60:63]
    ds_read_b128 v[100:103], v16 offset:47104
    v_mfma_f32_16x16x32_bf16 v[48:51], v[204:207], v[112:115], v[48:51]
    v_mfma_f32_16x16x32_bf16 v[64:67], v[112:115], v[208:211], v[64:67]
    v_mfma_f32_16x16x32_bf16 v[52:55], v[204:207], v[116:119], v[52:55]
    v_mfma_f32_16x16x32_bf16 v[68:71], v[116:119], v[208:211], v[68:71]
    s_waitcnt lgkmcnt(4)
    v_mfma_f32_16x16x32_bf16 v[40:43], v[216:219], v[72:75], v[40:43]
    ds_read_b128 v[104:107], v17 offset:40960
    v_mfma_f32_16x16x32_bf16 v[56:59], v[72:75], v[220:223], v[56:59]
    ds_read_b128 v[108:111], v17 offset:43008
    v_mfma_f32_16x16x32_bf16 v[44:47], v[216:219], v[76:79], v[44:47]
    ds_read_b128 v[112:115], v17 offset:45056
    v_mfma_f32_16x16x32_bf16 v[60:63], v[76:79], v[220:223], v[60:63]
    ds_read_b128 v[116:119], v17 offset:47104
    v_mfma_f32_16x16x32_bf16 v[48:51], v[216:219], v[80:83], v[48:51]
    v_mfma_f32_16x16x32_bf16 v[64:67], v[80:83], v[220:223], v[64:67]
    v_mfma_f32_16x16x32_bf16 v[52:55], v[216:219], v[84:87], v[52:55]
    v_mfma_f32_16x16x32_bf16 v[68:71], v[84:87], v[220:223], v[68:71]
    v_cvt_pk_bf16_f32 v224, v40, v41
    v_cvt_pk_bf16_f32 v226, v44, v45
    v_cvt_pk_bf16_f32 v225, v42, v43
    v_cvt_pk_bf16_f32 v227, v46, v47
    v_permlane16_swap_b32 v224, v226
    s_nop 0
    v_permlane16_swap_b32 v225, v227
    buffer_store_dwordx4 v[224:227], v2, s[4:7], s62 offen offset:0 sc1
    v_cvt_pk_bf16_f32 v228, v56, v57
    v_cvt_pk_bf16_f32 v230, v60, v61
    v_cvt_pk_bf16_f32 v229, v58, v59
    v_cvt_pk_bf16_f32 v231, v62, v63
    v_permlane16_swap_b32 v228, v230
    s_nop 0
    v_permlane16_swap_b32 v229, v231
    buffer_store_dwordx4 v[228:231], v20, s[4:7], s62 offen offset:1024 sc1
    v_cvt_pk_bf16_f32 v232, v48, v49
    v_cvt_pk_bf16_f32 v234, v52, v53
    v_cvt_pk_bf16_f32 v233, v50, v51
    v_cvt_pk_bf16_f32 v235, v54, v55
    v_permlane16_swap_b32 v232, v234
    s_nop 0
    v_permlane16_swap_b32 v233, v235
    buffer_store_dwordx4 v[232:235], v2, s[4:7], s62 offen offset:2048 sc1
    v_cvt_pk_bf16_f32 v236, v64, v65
    v_cvt_pk_bf16_f32 v238, v68, v69
    v_cvt_pk_bf16_f32 v237, v66, v67
    v_cvt_pk_bf16_f32 v239, v70, v71
    v_permlane16_swap_b32 v236, v238
    s_nop 0
    v_permlane16_swap_b32 v237, v239
    buffer_store_dwordx4 v[236:239], v20, s[4:7], s62 offen offset:3072 sc1
    s_waitcnt lgkmcnt(4)
    v_mfma_f32_16x16x32_bf16 v[24:27], v[152:155], v[88:91], v[24:27]
    ds_read_b128 v[72:75], v16 offset:49152
    v_mfma_f32_16x16x32_bf16 v[28:31], v[152:155], v[92:95], v[28:31]
    ds_read_b128 v[76:79], v16 offset:51200
    v_mfma_f32_16x16x32_bf16 v[32:35], v[152:155], v[96:99], v[32:35]
    ds_read_b128 v[80:83], v16 offset:53248
    v_mfma_f32_16x16x32_bf16 v[36:39], v[152:155], v[100:103], v[36:39]
    ds_read_b128 v[84:87], v16 offset:55296
    s_waitcnt lgkmcnt(4)
    v_mfma_f32_16x16x32_bf16 v[24:27], v[164:167], v[104:107], v[24:27]
    ds_read_b128 v[88:91], v17 offset:49152
    v_mfma_f32_16x16x32_bf16 v[28:31], v[164:167], v[108:111], v[28:31]
    ds_read_b128 v[92:95], v17 offset:51200
    v_mfma_f32_16x16x32_bf16 v[32:35], v[164:167], v[112:115], v[32:35]
    ds_read_b128 v[96:99], v17 offset:53248
    v_mfma_f32_16x16x32_bf16 v[36:39], v[164:167], v[116:119], v[36:39]
    ds_read_b128 v[100:103], v17 offset:55296
    s_waitcnt lgkmcnt(4)
    v_mfma_f32_16x16x32_bf16 v[24:27], v[176:179], v[72:75], v[24:27]
    ds_read_b128 v[104:107], v16 offset:57344
    v_mfma_f32_16x16x32_bf16 v[28:31], v[176:179], v[76:79], v[28:31]
    ds_read_b128 v[108:111], v16 offset:59392
    v_mfma_f32_16x16x32_bf16 v[32:35], v[176:179], v[80:83], v[32:35]
    ds_read_b128 v[112:115], v16 offset:61440
    v_mfma_f32_16x16x32_bf16 v[36:39], v[176:179], v[84:87], v[36:39]
    ds_read_b128 v[116:119], v16 offset:63488
    s_waitcnt lgkmcnt(4)
    v_mfma_f32_16x16x32_bf16 v[24:27], v[188:191], v[88:91], v[24:27]
    ds_read_b128 v[72:75], v17 offset:57344
    v_mfma_f32_16x16x32_bf16 v[28:31], v[188:191], v[92:95], v[28:31]
    ds_read_b128 v[76:79], v17 offset:59392
    v_mfma_f32_16x16x32_bf16 v[32:35], v[188:191], v[96:99], v[32:35]
    ds_read_b128 v[80:83], v17 offset:61440
    v_mfma_f32_16x16x32_bf16 v[36:39], v[188:191], v[100:103], v[36:39]
    ds_read_b128 v[84:87], v17 offset:63488
    s_waitcnt lgkmcnt(4)
    v_mfma_f32_16x16x32_bf16 v[24:27], v[200:203], v[104:107], v[24:27]
    v_mfma_f32_16x16x32_bf16 v[28:31], v[200:203], v[108:111], v[28:31]
    v_mfma_f32_16x16x32_bf16 v[32:35], v[200:203], v[112:115], v[32:35]
    v_mfma_f32_16x16x32_bf16 v[36:39], v[200:203], v[116:119], v[36:39]
    s_waitcnt lgkmcnt(0)
    v_mfma_f32_16x16x32_bf16 v[24:27], v[212:215], v[72:75], v[24:27]
    v_mfma_f32_16x16x32_bf16 v[28:31], v[212:215], v[76:79], v[28:31]
    v_mfma_f32_16x16x32_bf16 v[32:35], v[212:215], v[80:83], v[32:35]
    v_mfma_f32_16x16x32_bf16 v[36:39], v[212:215], v[84:87], v[36:39]
    s_lshl_b32 s46, s44, 2
    s_add_u32 s46, s46, s40
    s_lshl_b32 s46, s46, 5
    s_add_u32 s46, s46, s43
    s_lshl_b32 s46, s46, 7
    s_add_u32 s47, s46, 18513920
    s_add_u32 s46, s46, 131072
    v_mov_b32 v250, s45
    v_lshlrev_b32 v251, 2, v0
    s_waitcnt vmcnt(0)
    s_mov_b32 exec_hi, 0
    buffer_store_dword v250, v251, s[4:7], s47 offen
    buffer_store_dword v250, v251, s[4:7], s46 offen sc1
    s_mov_b64 exec, -1
    s_mul_i32 s46, s40, 3072
    s_add_u32 s46, s46, 74752
    v_add_u32 v4, s46, v2
    v_add_u32 v5, s46, v20
    ds_write_b128 v4, v[232:235]
    ds_write_b128 v5, v[228:231] offset:1024
    ds_write_b128 v5, v[236:239] offset:2048
    s_mov_b32 s46, 0x3eb8aa3b
    v_mul_f32 v24, s46, v24
    v_mul_f32 v25, s46, v25
    v_mul_f32 v26, s46, v26
    v_mul_f32 v27, s46, v27
    v_mul_f32 v28, s46, v28
    v_mul_f32 v29, s46, v29
    v_mul_f32 v30, s46, v30
    v_mul_f32 v31, s46, v31
    v_mul_f32 v32, s46, v32
    v_mul_f32 v33, s46, v33
    v_mul_f32 v34, s46, v34
    v_mul_f32 v35, s46, v35
    v_mul_f32 v36, s46, v36
    v_mul_f32 v37, s46, v37
    v_mul_f32 v38, s46, v38
    v_mul_f32 v39, s46, v39
    v_cvt_pk_bf16_f32 v8, v24, v25
    v_cvt_pk_bf16_f32 v10, v28, v29
    v_cvt_pk_bf16_f32 v9, v26, v27
    v_cvt_pk_bf16_f32 v11, v30, v31
    v_permlane16_swap_b32 v8, v10
    s_nop 0
    v_permlane16_swap_b32 v9, v11
    ds_write_b128 v21, v[8:11] offset:0
    v_cvt_pk_bf16_f32 v12, v32, v33
    v_cvt_pk_bf16_f32 v14, v36, v37
    v_cvt_pk_bf16_f32 v13, v34, v35
    v_cvt_pk_bf16_f32 v15, v38, v39
    v_permlane16_swap_b32 v12, v14
    s_nop 0
    v_permlane16_swap_b32 v13, v15
    ds_write_b128 v21, v[12:15] offset:1024
    s_waitcnt lgkmcnt(0)
    s_barrier
    s_and_b32 s46, s43, 28
    v_add_u32 v252, s46, v0
    v_and_b32 v252, 31, v252
    v_lshlrev_b32 v252, 7, v252
    s_mov_b64 exec, 15
    s_mov_b32 s52, 400000
L_poll_kv0_7:
    s_and_b32 s50, s52, 7
    s_cmp_eq_u32 s50, 1
    s_cselect_b32 s50, s70, s90
    buffer_load_dword v254, v252, s[4:7], s50 offen sc1
    s_sub_u32 s52, s52, 1
    s_cmp_eq_u32 s52, 0
    s_waitcnt vmcnt(0)
    s_cbranch_scc1 L_pdone_kv0_8
    v_cmp_ne_u32 vcc, s45, v254
    s_nop 0
    s_cbranch_vccnz L_poll_kv0_7
L_pdone_kv0_8:
    s_mov_b64 exec, -1
    s_add_u32 s46, s43, 1
    s_and_b32 s46, s46, 3
    s_lshl_b32 s46, s46, 12
    s_add_u32 s46, s46, s57
    s_add_u32 s46, s46, s56
    buffer_load_dwordx4 v[84:87], v2, s[4:7], s46 offen sc1
    s_add_u32 m0, s81, 0
    s_nop 0
    buffer_load_dwordx4 v2, s[4:7], s46 offen offset:1024 sc1 lds
    s_add_u32 s46, s43, 2
    s_and_b32 s46, s46, 3
    s_lshl_b32 s46, s46, 12
    s_add_u32 s46, s46, s57
    s_add_u32 s46, s46, s56
    buffer_load_dwordx4 v[88:91], v2, s[4:7], s46 offen sc1
    s_add_u32 m0, s81, 1024
    s_nop 0
    buffer_load_dwordx4 v2, s[4:7], s46 offen offset:1024 sc1 lds
    s_add_u32 s46, s43, 3
    s_and_b32 s46, s46, 3
    s_lshl_b32 s46, s46, 12
    s_add_u32 s46, s46, s57
    s_add_u32 s46, s46, s56
    buffer_load_dwordx4 v[92:95], v2, s[4:7], s46 offen sc1
    s_add_u32 m0, s81, 2048
    s_nop 0
    buffer_load_dwordx4 v2, s[4:7], s46 offen offset:1024 sc1 lds
    s_add_u32 s57, s57, 16384
    s_and_b32 s57, s57, 0x1ffff
    buffer_load_dword v254, v252, s[4:7], s70 offen sc1
    v_xor_b32 v7, 0, v2
    v_lshrrev_b32 v5, 5, v0
    v_lshlrev_b32 v48, 4, v5
    v_and_b32 v6, 31, v0
    v_lshl_add_u32 v6, v6, 10, v48
    v_and_b32 v48, 15, v0
    v_lshlrev_b32 v48, 4, v48
    v_lshl_add_u32 v3, v5, 8, v48
    v_add_u32 v3, s81, v3
    v_mov_b32 v4, 0xdddddddd
    v_and_b32 v48, 27, v0
    v_cmp_eq_u32 vcc, 16, v48
    v_mov_b32 v48, 0x3f803f80
    s_nop 0
    v_cndmask_b32 v48, 0, v48, vcc
    v_mov_b32 v49, v48
    v_pk_mov_b32 v[112:113], v[48:49], v[48:49] op_sel:[0,1]
    v_pk_mov_b32 v[114:115], v[48:49], v[48:49] op_sel:[0,1]
    v_pk_mov_b32 v[116:117], v[48:49], v[48:49] op_sel:[0,1]
    v_pk_mov_b32 v[118:119], v[48:49], v[48:49] op_sel:[0,1]
    v_pk_mov_b32 v[120:121], v[48:49], v[48:49] op_sel:[0,1]
    v_pk_mov_b32 v[122:123], v[48:49], v[48:49] op_sel:[0,1]
    v_pk_mov_b32 v[124:125], v[48:49], v[48:49] op_sel:[0,1]
    v_pk_mov_b32 v[126:127], v[48:49], v[48:49] op_sel:[0,1]
    v_pk_mov_b32 v[16:17], 0, 0
    v_pk_mov_b32 v[18:19], 0, 0
    v_pk_mov_b32 v[20:21], 0, 0
    v_pk_mov_b32 v[22:23], 0, 0
    v_pk_mov_b32 v[24:25], 0, 0
    v_pk_mov_b32 v[26:27], 0, 0
    v_pk_mov_b32 v[28:29], 0, 0
    v_pk_mov_b32 v[30:31], 0, 0
    v_pk_mov_b32 v[32:33], 0, 0
    v_pk_mov_b32 v[34:35], 0, 0
    v_pk_mov_b32 v[36:37], 0, 0
    v_pk_mov_b32 v[38:39], 0, 0
    v_pk_mov_b32 v[40:41], 0, 0
    v_pk_mov_b32 v[42:43], 0, 0
    v_pk_mov_b32 v[44:45], 0, 0
    v_pk_mov_b32 v[46:47], 0, 0
    s_and_b32 s46, s40, 3
    s_mul_i32 s46, s46, 3072
    s_add_u32 s46, s46, 74752
    s_sub_u32 s46, s46, s81
    v_add_u32 v5, s46, v3
    s_mov_b64 exec, s[54:55]
    ds_read_b128 v[112:115], v5 offset:1024
    ds_read_b128 v[116:119], v5 offset:1536
    s_mov_b64 exec, -1
    v_mfma_f32_32x32x16_bf16 v[48:63], v[224:227], v[8:11], 0
    s_nop 11
    v_exp_f32 v48, v48
    v_exp_f32 v49, v49
    v_exp_f32 v50, v50
    v_exp_f32 v51, v51
    v_exp_f32 v52, v52
    v_mfma_f32_32x32x16_bf16 v[64:79], v[224:227], v[12:15], 0
    s_waitcnt lgkmcnt(0)
    v_exp_f32 v53, v53
    v_exp_f32 v54, v54
    v_exp_f32 v55, v55
    v_exp_f32 v56, v56
    v_exp_f32 v57, v57
    v_smfmac_f32_32x32x32_bf16 v[16:31], v[112:115], v[48:55], v4
    v_exp_f32 v58, v58
    v_exp_f32 v59, v59
    v_exp_f32 v60, v60
    v_exp_f32 v61, v61
    v_exp_f32 v62, v62
    v_exp_f32 v63, v63
    v_exp_f32 v64, v64
    v_exp_f32 v65, v65
    v_smfmac_f32_32x32x32_bf16 v[16:31], v[116:119], v[56:63], v4
    v_exp_f32 v66, v66
    v_exp_f32 v67, v67
    v_exp_f32 v68, v68
    v_exp_f32 v69, v69
    v_exp_f32 v70, v70
    v_exp_f32 v71, v71
    v_exp_f32 v72, v72
    v_exp_f32 v73, v73
    v_smfmac_f32_32x32x32_bf16 v[32:47], v[112:115], v[64:71], v4
    s_setprio 3
    v_exp_f32 v74, v74
    v_exp_f32 v75, v75
    v_exp_f32 v76, v76
    v_exp_f32 v77, v77
    v_exp_f32 v78, v78
    v_exp_f32 v79, v79
    s_waitcnt vmcnt(6)
    v_mfma_f32_32x32x16_bf16 v[48:63], v[84:87], v[8:11], 0
    s_waitcnt vmcnt(5)
    s_mov_b64 exec, s[54:55]
    ds_read_b128 v[120:123], v3 offset:1024
    ds_read_b128 v[124:127], v3 offset:1536
    s_mov_b64 exec, -1
    s_nop 6
    v_exp_f32 v48, v48
    v_exp_f32 v49, v49
    v_smfmac_f32_32x32x32_bf16 v[32:47], v[116:119], v[72:79], v4
    s_waitcnt vmcnt(3)
    s_mov_b64 exec, s[54:55]
    ds_read_b128 v[112:115], v3 offset:2048
    ds_read_b128 v[116:119], v3 offset:2560
    s_mov_b64 exec, -1
    v_exp_f32 v50, v50
    v_exp_f32 v51, v51
    v_exp_f32 v52, v52
    v_mfma_f32_32x32x16_bf16 v[64:79], v[84:87], v[12:15], 0
    s_waitcnt lgkmcnt(2)
    v_exp_f32 v53, v53
    v_exp_f32 v54, v54
    v_exp_f32 v55, v55
    v_exp_f32 v56, v56
    v_exp_f32 v57, v57
    v_smfmac_f32_32x32x32_bf16 v[16:31], v[120:123], v[48:55], v4
    s_waitcnt vmcnt(0)
    v_cmp_ne_u32 vcc, s45, v254
    s_nop 0
    s_mov_b32 s71, vcc_lo
    s_and_b32 s50, s71, 0x10
    s_cbranch_scc1 L_kvw_9
L_kvb_10:
    s_add_u32 s46, s56, s57
    buffer_load_dwordx4 v[96:99], v2, s[4:7], s46 offen sc1
    v_exp_f32 v58, v58
    v_exp_f32 v59, v59
    v_exp_f32 v60, v60
    v_exp_f32 v61, v61
    v_exp_f32 v62, v62
    v_exp_f32 v63, v63
    v_exp_f32 v64, v64
    v_exp_f32 v65, v65
    v_smfmac_f32_32x32x32_bf16 v[16:31], v[124:127], v[56:63], v4
    s_add_u32 m0, s81, 3072
    s_add_u32 s57, s57, 4096
    buffer_load_dwordx4 v2, s[4:7], s46 offen offset:1024 sc1 lds
    v_exp_f32 v66, v66
    v_exp_f32 v67, v67
    v_exp_f32 v68, v68
    v_mfma_f32_32x32x16_bf16 v[48:63], v[88:91], v[8:11], 0
    s_and_b32 s57, s57, 0x1ffff
    v_exp_f32 v69, v69
    v_exp_f32 v70, v70
    v_exp_f32 v71, v71
    v_exp_f32 v72, v72
    v_exp_f32 v73, v73
    v_smfmac_f32_32x32x32_bf16 v[32:47], v[120:123], v[64:71], v4
    s_and_b32 s50, s71, 0x20
    s_cbranch_scc1 L_kvw_11
L_kvb_12:
    s_add_u32 s46, s56, s57
    buffer_load_dwordx4 v[100:103], v2, s[4:7], s46 offen sc1
    s_add_u32 m0, s81, 4096
    s_add_u32 s57, s57, 4096
    buffer_load_dwordx4 v2, s[4:7], s46 offen offset:1024 sc1 lds
    s_and_b32 s57, s57, 0x1ffff
    v_exp_f32 v74, v74
    v_exp_f32 v75, v75
    v_exp_f32 v76, v76
    v_exp_f32 v77, v77
    v_exp_f32 v78, v78
    v_exp_f32 v79, v79
    v_exp_f32 v48, v48
    v_exp_f32 v49, v49
    v_smfmac_f32_32x32x32_bf16 v[32:47], v[124:127], v[72:79], v4
    s_mov_b64 exec, s[54:55]
    ds_read_b128 v[120:123], v3 offset:3072
    ds_read_b128 v[124:127], v3 offset:3584
    s_mov_b64 exec, -1
    v_exp_f32 v50, v50
    v_exp_f32 v51, v51
    v_exp_f32 v52, v52
    v_mfma_f32_32x32x16_bf16 v[64:79], v[88:91], v[12:15], 0
    s_waitcnt lgkmcnt(2)
    v_exp_f32 v53, v53
    v_exp_f32 v54, v54
    v_exp_f32 v55, v55
    v_exp_f32 v56, v56
    v_exp_f32 v57, v57
    v_smfmac_f32_32x32x32_bf16 v[16:31], v[112:115], v[48:55], v4
    s_and_b32 s50, s71, 0x40
    s_cbranch_scc1 L_kvw_13
L_kvb_14:
    s_add_u32 s46, s56, s57
    buffer_load_dwordx4 v[104:107], v2, s[4:7], s46 offen sc1
    v_exp_f32 v58, v58
    v_exp_f32 v59, v59
    v_exp_f32 v60, v60
    v_exp_f32 v61, v61
    v_exp_f32 v62, v62
    v_exp_f32 v63, v63
    v_exp_f32 v64, v64
    v_exp_f32 v65, v65
    v_smfmac_f32_32x32x32_bf16 v[16:31], v[116:119], v[56:63], v4
    s_add_u32 m0, s81, 5120
    s_add_u32 s57, s57, 4096
    buffer_load_dwordx4 v2, s[4:7], s46 offen offset:1024 sc1 lds
    v_exp_f32 v66, v66
    v_exp_f32 v67, v67
    v_exp_f32 v68, v68
    v_mfma_f32_32x32x16_bf16 v[48:63], v[92:95], v[8:11], 0
    s_and_b32 s57, s57, 0x1ffff
    v_exp_f32 v69, v69
    v_exp_f32 v70, v70
    v_exp_f32 v71, v71
    v_exp_f32 v72, v72
    v_exp_f32 v73, v73
    v_smfmac_f32_32x32x32_bf16 v[32:47], v[112:115], v[64:71], v4
    s_and_b32 s50, s71, 0x80
    s_cbranch_scc1 L_kvw_15
L_kvb_16:
    s_add_u32 s46, s56, s57
    buffer_load_dwordx4 v[108:111], v2, s[4:7], s46 offen sc1
    s_add_u32 m0, s81, 6144
    s_add_u32 s57, s57, 4096
    buffer_load_dwordx4 v2, s[4:7], s46 offen offset:1024 sc1 lds
    s_and_b32 s57, s57, 0x1ffff
    s_cmp_lg_u32 s40, 3
    s_cbranch_scc1 L_only_17
    s_add_u32 s87, s42, 16
    s_lshl_b32 s63, s87, 8
    s_mul_i32 s50, s41, 12288
    s_add_u32 s63, s63, s50
    s_add_u32 s63, s63, 18087936
    s_lshl_b32 s87, s87, 7
    s_mul_i32 s50, s41, 393216
    s_add_u32 s87, s87, s50
    s_lshl_b32 s50, s41, 7
    v_lshrrev_b32 v202, 5, v0
    v_bfe_u32 v203, v0, 2, 2
    v_lshl_add_u32 v202, v202, 2, v203
    v_mul_u32_u24 v201, 6144, v202
    v_bfe_u32 v202, v0, 4, 1
    v_lshl_add_u32 v201, v202, 6, v201
    v_and_b32 v202, 3, v0
    v_lshl_add_u32 v201, v202, 4, v201
    v_lshlrev_b32 v202, 1, v0
    s_mov_b32 m0, 0
    buffer_load_ushort v200, v202, s[20:23], s50 offen
    buffer_load_dwordx4 v201, s[16:19], s87 offen lds
L_only_17:
    v_exp_f32 v74, v74
    v_exp_f32 v75, v75
    v_exp_f32 v76, v76
    v_exp_f32 v77, v77
    v_exp_f32 v78, v78
    v_exp_f32 v79, v79
    v_exp_f32 v48, v48
    v_exp_f32 v49, v49
    v_smfmac_f32_32x32x32_bf16 v[32:47], v[116:119], v[72:79], v4
    s_waitcnt vmcnt(6)
    s_mov_b64 exec, s[54:55]
    ds_read_b128 v[112:115], v3 offset:4096
    ds_read_b128 v[116:119], v3 offset:4608
    s_mov_b64 exec, -1
    v_exp_f32 v50, v50
    v_exp_f32 v51, v51
    v_exp_f32 v52, v52
    v_mfma_f32_32x32x16_bf16 v[64:79], v[92:95], v[12:15], 0
    s_waitcnt lgkmcnt(2)
    v_exp_f32 v53, v53
    v_exp_f32 v54, v54
    v_exp_f32 v55, v55
    v_exp_f32 v56, v56
    v_exp_f32 v57, v57
    v_smfmac_f32_32x32x32_bf16 v[16:31], v[120:123], v[48:55], v4
    s_and_b32 s50, s71, 0x100
    s_cbranch_scc1 L_kvw_18
L_kvb_19:
    s_add_u32 s46, s56, s57
    buffer_load_dwordx4 v[80:83], v2, s[4:7], s46 offen sc1
    v_exp_f32 v58, v58
    v_exp_f32 v59, v59
    v_exp_f32 v60, v60
    v_exp_f32 v61, v61
    v_exp_f32 v62, v62
    v_exp_f32 v63, v63
    v_exp_f32 v64, v64
    v_exp_f32 v65, v65
    v_smfmac_f32_32x32x32_bf16 v[16:31], v[124:127], v[56:63], v4
    s_add_u32 m0, s81, -1024
    s_add_u32 s57, s57, 4096
    buffer_load_dwordx4 v2, s[4:7], s46 offen offset:1024 sc1 lds
    v_exp_f32 v66, v66
    v_exp_f32 v67, v67
    v_exp_f32 v68, v68
    v_mfma_f32_32x32x16_bf16 v[48:63], v[96:99], v[8:11], 0
    s_and_b32 s57, s57, 0x1ffff
    v_exp_f32 v69, v69
    v_exp_f32 v70, v70
    v_exp_f32 v71, v71
    v_exp_f32 v72, v72
    v_exp_f32 v73, v73
    v_smfmac_f32_32x32x32_bf16 v[32:47], v[120:123], v[64:71], v4
    s_and_b32 s50, s71, 0x200
    s_cbranch_scc1 L_kvw_20
L_kvb_21:
    s_add_u32 s46, s56, s57
    buffer_load_dwordx4 v[84:87], v2, s[4:7], s46 offen sc1
    s_add_u32 m0, s81, 0
    s_add_u32 s57, s57, 4096
    buffer_load_dwordx4 v2, s[4:7], s46 offen offset:1024 sc1 lds
    s_and_b32 s57, s57, 0x1ffff
    s_cmp_lg_u32 s40, 3
    s_cbranch_scc1 L_only_22
    s_mov_b32 m0, 1024
    s_add_u32 s87, s87, 49152
    buffer_load_dwordx4 v201, s[16:19], s87 offen lds
L_only_22:
    v_exp_f32 v74, v74
    v_exp_f32 v75, v75
    v_exp_f32 v76, v76
    v_exp_f32 v77, v77
    v_exp_f32 v78, v78
    v_exp_f32 v79, v79
    v_exp_f32 v48, v48
    v_exp_f32 v49, v49
    v_smfmac_f32_32x32x32_bf16 v[32:47], v[124:127], v[72:79], v4
    s_waitcnt vmcnt(8)
    s_mov_b64 exec, s[54:55]
    ds_read_b128 v[120:123], v3 offset:5120
    ds_read_b128 v[124:127], v3 offset:5632
    s_mov_b64 exec, -1
    v_exp_f32 v50, v50
    v_exp_f32 v51, v51
    v_exp_f32 v52, v52
    v_mfma_f32_32x32x16_bf16 v[64:79], v[96:99], v[12:15], 0
    s_waitcnt lgkmcnt(2)
    v_exp_f32 v53, v53
    v_exp_f32 v54, v54
    v_exp_f32 v55, v55
    v_exp_f32 v56, v56
    v_exp_f32 v57, v57
    v_smfmac_f32_32x32x32_bf16 v[16:31], v[112:115], v[48:55], v4
    s_and_b32 s50, s71, 0x400
    s_cbranch_scc1 L_kvw_23
L_kvb_24:
    s_add_u32 s46, s56, s57
    buffer_load_dwordx4 v[88:91], v2, s[4:7], s46 offen sc1
    v_exp_f32 v58, v58
    v_exp_f32 v59, v59
    v_exp_f32 v60, v60
    v_exp_f32 v61, v61
    v_exp_f32 v62, v62
    v_exp_f32 v63, v63
    v_exp_f32 v64, v64
    v_exp_f32 v65, v65
    v_smfmac_f32_32x32x32_bf16 v[16:31], v[116:119], v[56:63], v4
    s_add_u32 m0, s81, 1024
    s_add_u32 s57, s57, 4096
    buffer_load_dwordx4 v2, s[4:7], s46 offen offset:1024 sc1 lds
    v_exp_f32 v66, v66
    v_exp_f32 v67, v67
    v_exp_f32 v68, v68
    v_mfma_f32_32x32x16_bf16 v[48:63], v[100:103], v[8:11], 0
    s_and_b32 s57, s57, 0x1ffff
    v_exp_f32 v69, v69
    v_exp_f32 v70, v70
    v_exp_f32 v71, v71
    v_exp_f32 v72, v72
    v_exp_f32 v73, v73
    v_smfmac_f32_32x32x32_bf16 v[32:47], v[112:115], v[64:71], v4
    s_cmp_lg_u32 s40, 3
    s_cbranch_scc1 L_only_25
    s_mov_b32 m0, 2048
    s_add_u32 s87, s87, 49152
    buffer_load_dwordx4 v201, s[16:19], s87 offen lds
L_only_25:
    v_exp_f32 v74, v74
    v_exp_f32 v75, v75
    v_exp_f32 v76, v76
    v_exp_f32 v77, v77
    v_exp_f32 v78, v78
    v_exp_f32 v79, v79
    v_exp_f32 v48, v48
    v_exp_f32 v49, v49
    v_smfmac_f32_32x32x32_bf16 v[32:47], v[116:119], v[72:79], v4
    s_waitcnt vmcnt(8)
    s_mov_b64 exec, s[54:55]
    ds_read_b128 v[112:115], v3 offset:6144
    ds_read_b128 v[116:119], v3 offset:6656
    s_mov_b64 exec, -1
    v_exp_f32 v50, v50
    v_exp_f32 v51, v51
    v_exp_f32 v52, v52
    v_mfma_f32_32x32x16_bf16 v[64:79], v[100:103], v[12:15], 0
    s_waitcnt lgkmcnt(2)
    v_exp_f32 v53, v53
    v_exp_f32 v54, v54
    v_exp_f32 v55, v55
    v_exp_f32 v56, v56
    v_exp_f32 v57, v57
    v_smfmac_f32_32x32x32_bf16 v[16:31], v[120:123], v[48:55], v4
    s_and_b32 s50, s71, 0x800
    s_cbranch_scc1 L_kvw_26
L_kvb_27:
    s_add_u32 s46, s56, s57
    buffer_load_dwordx4 v[92:95], v2, s[4:7], s46 offen sc1
    v_exp_f32 v58, v58
    v_exp_f32 v59, v59
    v_exp_f32 v60, v60
    v_exp_f32 v61, v61
    v_exp_f32 v62, v62
    v_exp_f32 v63, v63
    v_exp_f32 v64, v64
    v_exp_f32 v65, v65
    v_smfmac_f32_32x32x32_bf16 v[16:31], v[124:127], v[56:63], v4
    s_add_u32 m0, s81, 2048
    s_add_u32 s57, s57, 4096
    buffer_load_dwordx4 v2, s[4:7], s46 offen offset:1024 sc1 lds
    v_exp_f32 v66, v66
    v_exp_f32 v67, v67
    v_exp_f32 v68, v68
    v_mfma_f32_32x32x16_bf16 v[48:63], v[104:107], v[8:11], 0
    s_and_b32 s57, s57, 0x1ffff
    v_exp_f32 v69, v69
    v_exp_f32 v70, v70
    v_exp_f32 v71, v71
    v_exp_f32 v72, v72
    v_exp_f32 v73, v73
    v_smfmac_f32_32x32x32_bf16 v[32:47], v[120:123], v[64:71], v4
    s_cmp_lg_u32 s40, 3
    s_cbranch_scc1 L_only_28
    s_mov_b32 m0, 3072
    s_add_u32 s87, s87, 49152
    buffer_load_dwordx4 v201, s[16:19], s87 offen lds
L_only_28:
    v_exp_f32 v74, v74
    v_exp_f32 v75, v75
    v_exp_f32 v76, v76
    v_exp_f32 v77, v77
    v_exp_f32 v78, v78
    v_exp_f32 v79, v79
    v_exp_f32 v48, v48
    v_exp_f32 v49, v49
    v_smfmac_f32_32x32x32_bf16 v[32:47], v[124:127], v[72:79], v4
    s_waitcnt vmcnt(8)
    s_mov_b64 exec, s[54:55]
    ds_read_b128 v[120:123], v3 offset:7168
    ds_read_b128 v[124:127], v3 offset:7680
    s_mov_b64 exec, -1
    v_exp_f32 v50, v50
    v_exp_f32 v51, v51
    v_exp_f32 v52, v52
    v_mfma_f32_32x32x16_bf16 v[64:79], v[104:107], v[12:15], 0
    s_waitcnt lgkmcnt(2)
    v_exp_f32 v53, v53
    v_exp_f32 v54, v54
    v_exp_f32 v55, v55
    v_exp_f32 v56, v56
    v_exp_f32 v57, v57
    v_smfmac_f32_32x32x32_bf16 v[16:31], v[112:115], v[48:55], v4
    s_and_b32 s50, s71, 0xfffff000
    s_cbranch_scc1 L_kvw_29
L_kvb_30:
    s_add_u32 s46, s56, s57
    buffer_load_dwordx4 v[96:99], v2, s[4:7], s46 offen sc1
    v_exp_f32 v58, v58
    v_exp_f32 v59, v59
    v_exp_f32 v60, v60
    v_exp_f32 v61, v61
    v_exp_f32 v62, v62
    v_exp_f32 v63, v63
    v_exp_f32 v64, v64
    v_exp_f32 v65, v65
    v_smfmac_f32_32x32x32_bf16 v[16:31], v[116:119], v[56:63], v4
    s_add_u32 m0, s81, 3072
    s_add_u32 s57, s57, 4096
    buffer_load_dwordx4 v2, s[4:7], s46 offen offset:1024 sc1 lds
    v_exp_f32 v66, v66
    v_exp_f32 v67, v67
    v_exp_f32 v68, v68
    v_mfma_f32_32x32x16_bf16 v[48:63], v[108:111], v[8:11], 0
    s_and_b32 s57, s57, 0x1ffff
    v_exp_f32 v69, v69
    v_exp_f32 v70, v70
    v_exp_f32 v71, v71
    v_exp_f32 v72, v72
    v_exp_f32 v73, v73
    v_smfmac_f32_32x32x32_bf16 v[32:47], v[112:115], v[64:71], v4
    s_cmp_lg_u32 s40, 3
    s_cbranch_scc1 L_only_31
    s_mov_b32 m0, 4096
    s_add_u32 s87, s87, 49152
    buffer_load_dwordx4 v201, s[16:19], s87 offen lds
L_only_31:
    v_exp_f32 v74, v74
    v_exp_f32 v75, v75
    v_exp_f32 v76, v76
    v_exp_f32 v77, v77
    v_exp_f32 v78, v78
    v_exp_f32 v79, v79
    v_exp_f32 v48, v48
    v_exp_f32 v49, v49
    v_smfmac_f32_32x32x32_bf16 v[32:47], v[116:119], v[72:79], v4
    s_waitcnt vmcnt(8)
    s_mov_b64 exec, s[54:55]
    ds_read_b128 v[112:115], v3 offset:0
    ds_read_b128 v[116:119], v3 offset:512
    s_mov_b64 exec, -1
    v_exp_f32 v50, v50
    v_exp_f32 v51, v51
    v_exp_f32 v52, v52
    v_mfma_f32_32x32x16_bf16 v[64:79], v[108:111], v[12:15], 0
    s_waitcnt lgkmcnt(2)
    v_exp_f32 v53, v53
    v_exp_f32 v54, v54
    v_exp_f32 v55, v55
    v_exp_f32 v56, v56
    v_exp_f32 v57, v57
    v_smfmac_f32_32x32x32_bf16 v[16:31], v[120:123], v[48:55], v4
    s_add_u32 s46, s56, s57
    buffer_load_dwordx4 v[100:103], v2, s[4:7], s46 offen sc1
    v_exp_f32 v58, v58
    v_exp_f32 v59, v59
    v_exp_f32 v60, v60
    v_exp_f32 v61, v61
    v_exp_f32 v62, v62
    v_exp_f32 v63, v63
    v_exp_f32 v64, v64
    v_exp_f32 v65, v65
    v_smfmac_f32_32x32x32_bf16 v[16:31], v[124:127], v[56:63], v4
    s_add_u32 m0, s81, 4096
    s_add_u32 s57, s57, 4096
    buffer_load_dwordx4 v2, s[4:7], s46 offen offset:1024 sc1 lds
    v_exp_f32 v66, v66
    v_exp_f32 v67, v67
    v_exp_f32 v68, v68
    v_mfma_f32_32x32x16_bf16 v[48:63], v[80:83], v[8:11], 0
    s_and_b32 s57, s57, 0x1ffff
    v_exp_f32 v69, v69
    v_exp_f32 v70, v70
    v_exp_f32 v71, v71
    v_exp_f32 v72, v72
    v_exp_f32 v73, v73
    v_smfmac_f32_32x32x32_bf16 v[32:47], v[120:123], v[64:71], v4
    s_cmp_lg_u32 s40, 3
    s_cbranch_scc1 L_only_32
    s_mov_b32 m0, 5120
    s_add_u32 s87, s87, 49152
    buffer_load_dwordx4 v201, s[16:19], s87 offen lds
L_only_32:
    s_lshl_b32 s47, s44, 12
    s_add_u32 s47, s47, 98304
    buffer_load_dword v253, v252, s[4:7], s47 offen sc1
    v_exp_f32 v74, v74
    v_exp_f32 v75, v75
    v_exp_f32 v76, v76
    v_exp_f32 v77, v77
    v_exp_f32 v78, v78
    v_exp_f32 v79, v79
    v_exp_f32 v48, v48
    v_exp_f32 v49, v49
    v_smfmac_f32_32x32x32_bf16 v[32:47], v[124:127], v[72:79], v4
    s_waitcnt vmcnt(9)
    s_mov_b64 exec, s[54:55]
    ds_read_b128 v[120:123], v3 offset:1024
    ds_read_b128 v[124:127], v3 offset:1536
    s_mov_b64 exec, -1
    v_exp_f32 v50, v50
    v_exp_f32 v51, v51
    v_exp_f32 v52, v52
    v_mfma_f32_32x32x16_bf16 v[64:79], v[80:83], v[12:15], 0
    s_waitcnt lgkmcnt(2)
    v_exp_f32 v53, v53
    v_exp_f32 v54, v54
    v_exp_f32 v55, v55
    v_exp_f32 v56, v56
    v_exp_f32 v57, v57
    v_smfmac_f32_32x32x32_bf16 v[16:31], v[112:115], v[48:55], v4
    s_add_u32 s46, s56, s57
    buffer_load_dwordx4 v[104:107], v2, s[4:7], s46 offen sc1
    v_exp_f32 v58, v58
    v_exp_f32 v59, v59
    v_exp_f32 v60, v60
    v_exp_f32 v61, v61
    v_exp_f32 v62, v62
    v_exp_f32 v63, v63
    v_exp_f32 v64, v64
    v_exp_f32 v65, v65
    v_smfmac_f32_32x32x32_bf16 v[16:31], v[116:119], v[56:63], v4
    s_add_u32 m0, s81, 5120
    s_add_u32 s57, s57, 4096
    buffer_load_dwordx4 v2, s[4:7], s46 offen offset:1024 sc1 lds
    v_exp_f32 v66, v66
    v_exp_f32 v67, v67
    v_exp_f32 v68, v68
    v_mfma_f32_32x32x16_bf16 v[48:63], v[84:87], v[8:11], 0
    s_and_b32 s57, s57, 0x1ffff
    v_exp_f32 v69, v69
    v_exp_f32 v70, v70
    v_exp_f32 v71, v71
    v_exp_f32 v72, v72
    v_exp_f32 v73, v73
    v_smfmac_f32_32x32x32_bf16 v[32:47], v[112:115], v[64:71], v4
    s_cmp_lg_u32 s40, 3
    s_cbranch_scc1 L_only_33
    s_mov_b32 m0, 6144
    s_add_u32 s87, s87, 49152
    buffer_load_dwordx4 v201, s[16:19], s87 offen lds
L_only_33:
    v_exp_f32 v74, v74
    v_exp_f32 v75, v75
    v_exp_f32 v76, v76
    v_exp_f32 v77, v77
    v_exp_f32 v78, v78
    v_exp_f32 v79, v79
    v_exp_f32 v48, v48
    v_exp_f32 v49, v49
    v_smfmac_f32_32x32x32_bf16 v[32:47], v[116:119], v[72:79], v4
    s_waitcnt vmcnt(9)
    s_mov_b64 exec, s[54:55]
    ds_read_b128 v[112:115], v3 offset:2048
    ds_read_b128 v[116:119], v3 offset:2560
    s_mov_b64 exec, -1
    v_exp_f32 v50, v50
    v_exp_f32 v51, v51
    v_exp_f32 v52, v52
    v_mfma_f32_32x32x16_bf16 v[64:79], v[84:87], v[12:15], 0
    s_waitcnt lgkmcnt(2)
    v_exp_f32 v53, v53
    v_exp_f32 v54, v54
    v_exp_f32 v55, v55
    v_exp_f32 v56, v56
    v_exp_f32 v57, v57
    v_smfmac_f32_32x32x32_bf16 v[16:31], v[120:123], v[48:55], v4
    s_add_u32 s46, s56, s57
    buffer_load_dwordx4 v[108:111], v2, s[4:7], s46 offen sc1
    v_exp_f32 v58, v58
    v_exp_f32 v59, v59
    v_exp_f32 v60, v60
    v_exp_f32 v61, v61
    v_exp_f32 v62, v62
    v_exp_f32 v63, v63
    v_exp_f32 v64, v64
    v_exp_f32 v65, v65
    v_smfmac_f32_32x32x32_bf16 v[16:31], v[124:127], v[56:63], v4
    s_add_u32 m0, s81, 6144
    s_add_u32 s57, s57, 4096
    buffer_load_dwordx4 v2, s[4:7], s46 offen offset:1024 sc1 lds
    v_exp_f32 v66, v66
    v_exp_f32 v67, v67
    v_exp_f32 v68, v68
    v_mfma_f32_32x32x16_bf16 v[48:63], v[88:91], v[8:11], 0
    s_and_b32 s57, s57, 0x1ffff
    v_exp_f32 v69, v69
    v_exp_f32 v70, v70
    v_exp_f32 v71, v71
    v_exp_f32 v72, v72
    v_exp_f32 v73, v73
    v_smfmac_f32_32x32x32_bf16 v[32:47], v[120:123], v[64:71], v4
    s_cmp_lg_u32 s40, 3
    s_cbranch_scc1 L_only_34
    s_mov_b32 m0, 7168
    s_add_u32 s87, s87, 49152
    buffer_load_dwordx4 v201, s[16:19], s87 offen lds
L_only_34:
    v_exp_f32 v74, v74
    v_exp_f32 v75, v75
    v_exp_f32 v76, v76
    v_exp_f32 v77, v77
    v_exp_f32 v78, v78
    v_exp_f32 v79, v79
    v_exp_f32 v48, v48
    v_exp_f32 v49, v49
    v_smfmac_f32_32x32x32_bf16 v[32:47], v[124:127], v[72:79], v4
    s_waitcnt vmcnt(9)
    s_mov_b64 exec, s[54:55]
    ds_read_b128 v[120:123], v3 offset:3072
    ds_read_b128 v[124:127], v3 offset:3584
    s_mov_b64 exec, -1
    v_exp_f32 v50, v50
    v_exp_f32 v51, v51
    v_exp_f32 v52, v52
    v_mfma_f32_32x32x16_bf16 v[64:79], v[88:91], v[12:15], 0
    s_waitcnt lgkmcnt(2)
    v_exp_f32 v53, v53
    v_exp_f32 v54, v54
    v_exp_f32 v55, v55
    v_exp_f32 v56, v56
    v_exp_f32 v57, v57
    v_smfmac_f32_32x32x32_bf16 v[16:31], v[112:115], v[48:55], v4
    s_add_u32 s46, s56, s57
    buffer_load_dwordx4 v[80:83], v2, s[4:7], s46 offen sc1
    v_exp_f32 v58, v58
    v_exp_f32 v59, v59
    v_exp_f32 v60, v60
    v_exp_f32 v61, v61
    v_exp_f32 v62, v62
    v_exp_f32 v63, v63
    v_exp_f32 v64, v64
    v_exp_f32 v65, v65
    v_smfmac_f32_32x32x32_bf16 v[16:31], v[116:119], v[56:63], v4
    s_add_u32 m0, s81, -1024
    s_add_u32 s57, s57, 4096
    buffer_load_dwordx4 v2, s[4:7], s46 offen offset:1024 sc1 lds
    v_exp_f32 v66, v66
    v_exp_f32 v67, v67
    v_exp_f32 v68, v68
    v_mfma_f32_32x32x16_bf16 v[48:63], v[92:95], v[8:11], 0
    s_and_b32 s57, s57, 0x1ffff
    v_exp_f32 v69, v69
    v_exp_f32 v70, v70
    v_exp_f32 v71, v71
    v_exp_f32 v72, v72
    v_exp_f32 v73, v73
    v_smfmac_f32_32x32x32_bf16 v[32:47], v[112:115], v[64:71], v4
    s_waitcnt vmcnt(6)
    v_cmp_ne_u32 vcc, s45, v253
    s_nop 0
    s_cbranch_vccz L_f1bok_35
    s_mov_b32 s52, 400000
L_poll_f1b_36:
    buffer_load_dword v253, v252, s[4:7], s47 offen sc1
    s_sub_u32 s52, s52, 1
    s_cmp_eq_u32 s52, 0
    s_waitcnt vmcnt(0)
    s_cbranch_scc1 L_pdone_f1b_37
    v_cmp_ne_u32 vcc, s45, v253
    s_nop 0
    s_cbranch_vccnz L_poll_f1b_36
L_pdone_f1b_37:
L_f1bok_35:
    v_exp_f32 v74, v74
    v_exp_f32 v75, v75
    v_exp_f32 v76, v76
    v_exp_f32 v77, v77
    v_exp_f32 v78, v78
    v_exp_f32 v79, v79
    v_exp_f32 v48, v48
    v_exp_f32 v49, v49
    v_smfmac_f32_32x32x32_bf16 v[32:47], v[116:119], v[72:79], v4
    s_mov_b64 exec, s[54:55]
    ds_read_b128 v[112:115], v3 offset:4096
    ds_read_b128 v[116:119], v3 offset:4608
    s_mov_b64 exec, -1
    v_exp_f32 v50, v50
    v_exp_f32 v51, v51
    v_exp_f32 v52, v52
    v_mfma_f32_32x32x16_bf16 v[64:79], v[92:95], v[12:15], 0
    s_waitcnt lgkmcnt(2)
    v_exp_f32 v53, v53
    v_exp_f32 v54, v54
    v_exp_f32 v55, v55
    v_exp_f32 v56, v56
    v_exp_f32 v57, v57
    v_smfmac_f32_32x32x32_bf16 v[16:31], v[120:123], v[48:55], v4
    s_add_u32 s46, s56, s57
    buffer_load_dwordx4 v[84:87], v2, s[4:7], s46 offen sc1
    v_exp_f32 v58, v58
    v_exp_f32 v59, v59
    v_exp_f32 v60, v60
    v_exp_f32 v61, v61
    v_exp_f32 v62, v62
    v_exp_f32 v63, v63
    v_exp_f32 v64, v64
    v_exp_f32 v65, v65
    v_smfmac_f32_32x32x32_bf16 v[16:31], v[124:127], v[56:63], v4
    s_add_u32 m0, s81, 0
    s_add_u32 s57, s57, 4096
    buffer_load_dwordx4 v2, s[4:7], s46 offen offset:1024 sc1 lds
    v_exp_f32 v66, v66
    v_exp_f32 v67, v67
    v_exp_f32 v68, v68
    v_mfma_f32_32x32x16_bf16 v[48:63], v[96:99], v[8:11], 0
    s_and_b32 s57, s57, 0x1ffff
    v_exp_f32 v69, v69
    v_exp_f32 v70, v70
    v_exp_f32 v71, v71
    v_exp_f32 v72, v72
    v_exp_f32 v73, v73
    v_smfmac_f32_32x32x32_bf16 v[32:47], v[120:123], v[64:71], v4
    buffer_load_dwordx4 v[128:131], v2, s[4:7], s59 offen offset:0 sc1
    buffer_load_dwordx4 v[132:135], v2, s[4:7], s59 offen offset:1024 sc1
    v_exp_f32 v74, v74
    v_exp_f32 v75, v75
    v_exp_f32 v76, v76
    v_exp_f32 v77, v77
    v_exp_f32 v78, v78
    v_exp_f32 v79, v79
    v_exp_f32 v48, v48
    v_exp_f32 v49, v49
    v_smfmac_f32_32x32x32_bf16 v[32:47], v[124:127], v[72:79], v4
    s_mov_b64 exec, s[54:55]
    ds_read_b128 v[120:123], v3 offset:5120
    ds_read_b128 v[124:127], v3 offset:5632
    s_mov_b64 exec, -1
    v_exp_f32 v50, v50
    v_exp_f32 v51, v51
    v_exp_f32 v52, v52
    v_mfma_f32_32x32x16_bf16 v[64:79], v[96:99], v[12:15], 0
    s_waitcnt lgkmcnt(2)
    v_exp_f32 v53, v53
    v_exp_f32 v54, v54
    v_exp_f32 v55, v55
    v_exp_f32 v56, v56
    v_exp_f32 v57, v57
    v_smfmac_f32_32x32x32_bf16 v[16:31], v[112:115], v[48:55], v4
    s_add_u32 s46, s56, s57
    buffer_load_dwordx4 v[88:91], v2, s[4:7], s46 offen sc1
    v_exp_f32 v58, v58
    v_exp_f32 v59, v59
    v_exp_f32 v60, v60
    v_exp_f32 v61, v61
    v_exp_f32 v62, v62
    v_exp_f32 v63, v63
    v_exp_f32 v64, v64
    v_exp_f32 v65, v65
    v_smfmac_f32_32x32x32_bf16 v[16:31], v[116:119], v[56:63], v4
    s_add_u32 m0, s81, 1024
    s_add_u32 s57, s57, 4096
    buffer_load_dwordx4 v2, s[4:7], s46 offen offset:1024 sc1 lds
    v_exp_f32 v66, v66
    v_exp_f32 v67, v67
    v_exp_f32 v68, v68
    v_mfma_f32_32x32x16_bf16 v[48:63], v[100:103], v[8:11], 0
    s_and_b32 s57, s57, 0x1ffff
    v_exp_f32 v69, v69
    v_exp_f32 v70, v70
    v_exp_f32 v71, v71
    v_exp_f32 v72, v72
    v_exp_f32 v73, v73
    v_smfmac_f32_32x32x32_bf16 v[32:47], v[112:115], v[64:71], v4
    buffer_load_dwordx4 v[136:139], v2, s[4:7], s59 offen offset:2048 sc1
    buffer_load_dwordx4 v[140:143], v2, s[4:7], s59 offen offset:3072 sc1
    v_exp_f32 v74, v74
    v_exp_f32 v75, v75
    v_exp_f32 v76, v76
    v_exp_f32 v77, v77
    v_exp_f32 v78, v78
    v_exp_f32 v79, v79
    v_exp_f32 v48, v48
    v_exp_f32 v49, v49
    v_smfmac_f32_32x32x32_bf16 v[32:47], v[116:119], v[72:79], v4
    s_waitcnt vmcnt(12)
    s_mov_b64 exec, s[54:55]
    ds_read_b128 v[112:115], v3 offset:6144
    ds_read_b128 v[116:119], v3 offset:6656
    s_mov_b64 exec, -1
    v_exp_f32 v50, v50
    v_exp_f32 v51, v51
    v_exp_f32 v52, v52
    v_mfma_f32_32x32x16_bf16 v[64:79], v[100:103], v[12:15], 0
    s_waitcnt lgkmcnt(2)
    v_exp_f32 v53, v53
    v_exp_f32 v54, v54
    v_exp_f32 v55, v55
    v_exp_f32 v56, v56
    v_exp_f32 v57, v57
    v_smfmac_f32_32x32x32_bf16 v[16:31], v[120:123], v[48:55], v4
    s_add_u32 s46, s56, s57
    buffer_load_dwordx4 v[92:95], v2, s[4:7], s46 offen sc1
    v_exp_f32 v58, v58
    v_exp_f32 v59, v59
    v_exp_f32 v60, v60
    v_exp_f32 v61, v61
    v_exp_f32 v62, v62
    v_exp_f32 v63, v63
    v_exp_f32 v64, v64
    v_exp_f32 v65, v65
    v_smfmac_f32_32x32x32_bf16 v[16:31], v[124:127], v[56:63], v4
    s_add_u32 m0, s81, 2048
    s_add_u32 s57, s57, 4096
    buffer_load_dwordx4 v2, s[4:7], s46 offen offset:1024 sc1 lds
    v_exp_f32 v66, v66
    v_exp_f32 v67, v67
    v_exp_f32 v68, v68
    v_mfma_f32_32x32x16_bf16 v[48:63], v[104:107], v[8:11], 0
    s_and_b32 s57, s57, 0x1ffff
    v_exp_f32 v69, v69
    v_exp_f32 v70, v70
    v_exp_f32 v71, v71
    v_exp_f32 v72, v72
    v_exp_f32 v73, v73
    v_smfmac_f32_32x32x32_bf16 v[32:47], v[120:123], v[64:71], v4
    s_add_u32 s59, s59, 4096
    buffer_load_dwordx4 v[144:147], v2, s[4:7], s59 offen offset:0 sc1
    v_exp_f32 v74, v74
    v_exp_f32 v75, v75
    v_exp_f32 v76, v76
    v_exp_f32 v77, v77
    v_exp_f32 v78, v78
    v_exp_f32 v79, v79
    v_exp_f32 v48, v48
    v_exp_f32 v49, v49
    v_smfmac_f32_32x32x32_bf16 v[32:47], v[124:127], v[72:79], v4
    s_waitcnt vmcnt(13)
    s_mov_b64 exec, s[54:55]
    ds_read_b128 v[120:123], v3 offset:7168
    ds_read_b128 v[124:127], v3 offset:7680
    s_mov_b64 exec, -1
    v_exp_f32 v50, v50
    v_exp_f32 v51, v51
    v_exp_f32 v52, v52
    v_mfma_f32_32x32x16_bf16 v[64:79], v[104:107], v[12:15], 0
    s_waitcnt lgkmcnt(2)
    v_exp_f32 v53, v53
    v_exp_f32 v54, v54
    v_exp_f32 v55, v55
    v_exp_f32 v56, v56
    v_exp_f32 v57, v57
    v_smfmac_f32_32x32x32_bf16 v[16:31], v[112:115], v[48:55], v4
    s_add_u32 s46, s56, s57
    buffer_load_dwordx4 v[96:99], v2, s[4:7], s46 offen sc1
    v_exp_f32 v58, v58
    v_exp_f32 v59, v59
    v_exp_f32 v60, v60
    v_exp_f32 v61, v61
    v_exp_f32 v62, v62
    v_exp_f32 v63, v63
    v_exp_f32 v64, v64
    v_exp_f32 v65, v65
    v_smfmac_f32_32x32x32_bf16 v[16:31], v[116:119], v[56:63], v4
    s_add_u32 m0, s81, 3072
    s_add_u32 s57, s57, 4096
    buffer_load_dwordx4 v2, s[4:7], s46 offen offset:1024 sc1 lds
    v_exp_f32 v66, v66
    v_exp_f32 v67, v67
    v_exp_f32 v68, v68
    v_mfma_f32_32x32x16_bf16 v[48:63], v[108:111], v[8:11], 0
    s_and_b32 s57, s57, 0x1ffff
    v_exp_f32 v69, v69
    v_exp_f32 v70, v70
    v_exp_f32 v71, v71
    v_exp_f32 v72, v72
    v_exp_f32 v73, v73
    v_smfmac_f32_32x32x32_bf16 v[32:47], v[112:115], v[64:71], v4
    s_cmp_lg_u32 s40, 3
    s_cbranch_scc1 L_only_38
    v_lshrrev_b32 v201, 4, v0
    v_lshlrev_b32 v203, 10, v201
    v_lshlrev_b32 v244, 4, v201
    v_bfe_u32 v201, v0, 2, 2
    v_lshl_add_u32 v203, v201, 6, v203
    v_lshl_add_u32 v245, v201, 6, v244
    v_and_b32 v201, 3, v0
    v_lshl_add_u32 v203, v201, 3, v203
    v_lshlrev_b32 v200, 16, v200
    v_mul_f32 v201, 0xbfb8aa3b, v200
    v_exp_f32 v201, v201
    s_nop 0
    v_add_f32 v201, 1.0, v201
    v_rcp_f32 v201, v201
    s_nop 0
    v_mul_f32 v200, v200, v201
    v_cvt_pk_bf16_f32 v200, v200, v200
    ds_write_b16 v202, v200 offset:8192
    ds_read_b128 v[204:207], v244 offset:8192
    ds_read_b128 v[208:211], v244 offset:8256
    v_mov_b32 v202, v245
    v_mov_b32 v201, 0xff
    s_waitcnt vmcnt(15)
    ds_read_b64_tr_b16 v[212:213], v203 offset:0
    ds_read_b64_tr_b16 v[214:215], v203 offset:512
    ds_read_b64_tr_b16 v[216:217], v203 offset:4096
    ds_read_b64_tr_b16 v[218:219], v203 offset:4608
    ds_read_b64_tr_b16 v[220:221], v203 offset:32
    ds_read_b64_tr_b16 v[222:223], v203 offset:544
    ds_read_b64_tr_b16 v[224:225], v203 offset:4128
    ds_read_b64_tr_b16 v[226:227], v203 offset:4640
    ds_read_b64_tr_b16 v[228:229], v203 offset:256
    ds_read_b64_tr_b16 v[230:231], v203 offset:768
    ds_read_b64_tr_b16 v[232:233], v203 offset:4352
    ds_read_b64_tr_b16 v[234:235], v203 offset:4864
    ds_read_b64_tr_b16 v[236:237], v203 offset:288
    ds_read_b64_tr_b16 v[238:239], v203 offset:800
    ds_read_b64_tr_b16 v[240:241], v203 offset:4384
    ds_read_b64_tr_b16 v[242:243], v203 offset:4896
    s_waitcnt lgkmcnt(12)
    v_mfma_f32_16x16x32_bf16 v[244:247], v[212:215], v[204:207], 0
    v_mfma_f32_16x16x32_bf16 v[244:247], v[216:219], v[208:211], v[244:247]
    s_waitcnt lgkmcnt(8)
    v_mfma_f32_16x16x32_bf16 v[212:215], v[220:223], v[204:207], 0
    v_mfma_f32_16x16x32_bf16 v[212:215], v[224:227], v[208:211], v[212:215]
    s_waitcnt lgkmcnt(4)
    v_mfma_f32_16x16x32_bf16 v[220:223], v[228:231], v[204:207], 0
    v_mfma_f32_16x16x32_bf16 v[220:223], v[232:235], v[208:211], v[220:223]
    s_waitcnt lgkmcnt(0)
    v_mfma_f32_16x16x32_bf16 v[228:231], v[236:239], v[204:207], 0
    v_mfma_f32_16x16x32_bf16 v[228:231], v[240:243], v[208:211], v[228:231]
    s_nop 1
    v_mov_b32_dpp v244, v212 quad_perm:[0,1,2,3] row_mask:0xf bank_mask:0x2
    v_mov_b32_dpp v245, v213 quad_perm:[0,1,2,3] row_mask:0xf bank_mask:0x2
    v_mov_b32_dpp v246, v214 quad_perm:[0,1,2,3] row_mask:0xf bank_mask:0x2
    v_mov_b32_dpp v247, v215 quad_perm:[0,1,2,3] row_mask:0xf bank_mask:0x2
    v_mov_b32_dpp v244, v220 quad_perm:[0,1,2,3] row_mask:0xf bank_mask:0x4
    v_mov_b32_dpp v245, v221 quad_perm:[0,1,2,3] row_mask:0xf bank_mask:0x4
    v_mov_b32_dpp v246, v222 quad_perm:[0,1,2,3] row_mask:0xf bank_mask:0x4
    v_mov_b32_dpp v247, v223 quad_perm:[0,1,2,3] row_mask:0xf bank_mask:0x4
    v_mov_b32_dpp v244, v228 quad_perm:[0,1,2,3] row_mask:0xf bank_mask:0x8
    v_mov_b32_dpp v245, v229 quad_perm:[0,1,2,3] row_mask:0xf bank_mask:0x8
    v_mov_b32_dpp v246, v230 quad_perm:[0,1,2,3] row_mask:0xf bank_mask:0x8
    v_mov_b32_dpp v247, v231 quad_perm:[0,1,2,3] row_mask:0xf bank_mask:0x8
    v_bfi_b32 v245, v201, s45, v245
    v_bfi_b32 v247, v201, s45, v247
    s_mov_b32 exec_lo, 0x11111111
    s_mov_b32 exec_hi, 0x11111111
    buffer_store_dwordx4 v[244:247], v202, s[4:7], s63 offen sc1
    s_mov_b64 exec, -1
L_only_38:
    buffer_load_dwordx4 v[148:151], v2, s[4:7], s59 offen offset:1024 sc1
    buffer_load_dwordx4 v[152:155], v2, s[4:7], s59 offen offset:2048 sc1
    v_exp_f32 v74, v74
    v_exp_f32 v75, v75
    v_exp_f32 v76, v76
    v_exp_f32 v77, v77
    v_exp_f32 v78, v78
    v_exp_f32 v79, v79
    v_exp_f32 v48, v48
    v_exp_f32 v49, v49
    v_smfmac_f32_32x32x32_bf16 v[32:47], v[116:119], v[72:79], v4
    s_waitcnt vmcnt(15)
    s_mov_b64 exec, s[54:55]
    ds_read_b128 v[112:115], v3 offset:0
    ds_read_b128 v[116:119], v3 offset:512
    s_mov_b64 exec, -1
    v_exp_f32 v50, v50
    v_exp_f32 v51, v51
    v_exp_f32 v52, v52
    v_mfma_f32_32x32x16_bf16 v[64:79], v[108:111], v[12:15], 0
    s_waitcnt lgkmcnt(2)
    v_exp_f32 v53, v53
    v_exp_f32 v54, v54
    v_exp_f32 v55, v55
    v_exp_f32 v56, v56
    v_exp_f32 v57, v57
    v_smfmac_f32_32x32x32_bf16 v[16:31], v[120:123], v[48:55], v4
    s_add_u32 s46, s56, s57
    buffer_load_dwordx4 v[100:103], v2, s[4:7], s46 offen sc1
    v_exp_f32 v58, v58
    v_exp_f32 v59, v59
    v_exp_f32 v60, v60
    v_exp_f32 v61, v61
    v_exp_f32 v62, v62
    v_exp_f32 v63, v63
    v_exp_f32 v64, v64
    v_exp_f32 v65, v65
    v_smfmac_f32_32x32x32_bf16 v[16:31], v[124:127], v[56:63], v4
    s_add_u32 m0, s81, 4096
    s_add_u32 s57, s57, 4096
    buffer_load_dwordx4 v2, s[4:7], s46 offen offset:1024 sc1 lds
    v_exp_f32 v66, v66
    v_exp_f32 v67, v67
    v_exp_f32 v68, v68
    v_mfma_f32_32x32x16_bf16 v[48:63], v[80:83], v[8:11], 0
    s_and_b32 s57, s57, 0x1ffff
    v_exp_f32 v69, v69
    v_exp_f32 v70, v70
    v_exp_f32 v71, v71
    v_exp_f32 v72, v72
    v_exp_f32 v73, v73
    v_smfmac_f32_32x32x32_bf16 v[32:47], v[120:123], v[64:71], v4
    s_setprio 2
    buffer_load_dwordx4 v[156:159], v2, s[4:7], s59 offen offset:3072 sc1
    v_exp_f32 v74, v74
    v_exp_f32 v75, v75
    v_exp_f32 v76, v76
    v_exp_f32 v77, v77
    v_exp_f32 v78, v78
    v_exp_f32 v79, v79
    v_exp_f32 v48, v48
    v_exp_f32 v49, v49
    v_smfmac_f32_32x32x32_bf16 v[32:47], v[124:127], v[72:79], v4
    s_waitcnt vmcnt(16)
    s_mov_b64 exec, s[54:55]
    ds_read_b128 v[120:123], v3 offset:1024
    ds_read_b128 v[124:127], v3 offset:1536
    s_mov_b64 exec, -1
    v_exp_f32 v50, v50
    v_exp_f32 v51, v51
    v_exp_f32 v52, v52
    v_mfma_f32_32x32x16_bf16 v[64:79], v[80:83], v[12:15], 0
    s_waitcnt lgkmcnt(2)
    v_exp_f32 v53, v53
    v_exp_f32 v54, v54
    v_exp_f32 v55, v55
    v_exp_f32 v56, v56
    v_exp_f32 v57, v57
    v_smfmac_f32_32x32x32_bf16 v[16:31], v[112:115], v[48:55], v4
    s_add_u32 s46, s56, s57
    buffer_load_dwordx4 v[104:107], v2, s[4:7], s46 offen sc1
    v_exp_f32 v58, v58
    v_exp_f32 v59, v59
    v_exp_f32 v60, v60
    v_exp_f32 v61, v61
    v_exp_f32 v62, v62
    v_exp_f32 v63, v63
    v_exp_f32 v64, v64
    v_exp_f32 v65, v65
    v_smfmac_f32_32x32x32_bf16 v[16:31], v[116:119], v[56:63], v4
    s_add_u32 m0, s81, 5120
    s_add_u32 s57, s57, 4096
    buffer_load_dwordx4 v2, s[4:7], s46 offen offset:1024 sc1 lds
    v_exp_f32 v66, v66
    v_exp_f32 v67, v67
    v_exp_f32 v68, v68
    v_mfma_f32_32x32x16_bf16 v[48:63], v[84:87], v[8:11], 0
    s_and_b32 s57, s57, 0x1ffff
    v_exp_f32 v69, v69
    v_exp_f32 v70, v70
    v_exp_f32 v71, v71
    v_exp_f32 v72, v72
    v_exp_f32 v73, v73
    v_smfmac_f32_32x32x32_bf16 v[32:47], v[112:115], v[64:71], v4
    s_add_u32 s59, s59, 4096
    buffer_load_dwordx4 v[160:163], v2, s[4:7], s59 offen offset:0 sc1
    buffer_load_dwordx4 v[164:167], v2, s[4:7], s59 offen offset:1024 sc1
    v_exp_f32 v74, v74
    v_exp_f32 v75, v75
    v_exp_f32 v76, v76
    v_exp_f32 v77, v77
    v_exp_f32 v78, v78
    v_exp_f32 v79, v79
    v_exp_f32 v48, v48
    v_exp_f32 v49, v49
    v_smfmac_f32_32x32x32_bf16 v[32:47], v[116:119], v[72:79], v4
    s_waitcnt vmcnt(16)
    s_mov_b64 exec, s[54:55]
    ds_read_b128 v[112:115], v3 offset:2048
    ds_read_b128 v[116:119], v3 offset:2560
    s_mov_b64 exec, -1
    v_exp_f32 v50, v50
    v_exp_f32 v51, v51
    v_exp_f32 v52, v52
    v_mfma_f32_32x32x16_bf16 v[64:79], v[84:87], v[12:15], 0
    s_waitcnt lgkmcnt(2)
    v_exp_f32 v53, v53
    v_exp_f32 v54, v54
    v_exp_f32 v55, v55
    v_exp_f32 v56, v56
    v_exp_f32 v57, v57
    v_smfmac_f32_32x32x32_bf16 v[16:31], v[120:123], v[48:55], v4
    s_add_u32 s46, s56, s57
    buffer_load_dwordx4 v[108:111], v2, s[4:7], s46 offen sc1
    v_exp_f32 v58, v58
    v_exp_f32 v59, v59
    v_exp_f32 v60, v60
    v_exp_f32 v61, v61
    v_exp_f32 v62, v62
    v_exp_f32 v63, v63
    v_exp_f32 v64, v64
    v_exp_f32 v65, v65
    v_smfmac_f32_32x32x32_bf16 v[16:31], v[124:127], v[56:63], v4
    s_add_u32 m0, s81, 6144
    s_add_u32 s57, s57, 4096
    buffer_load_dwordx4 v2, s[4:7], s46 offen offset:1024 sc1 lds
    v_exp_f32 v66, v66
    v_exp_f32 v67, v67
    v_exp_f32 v68, v68
    v_mfma_f32_32x32x16_bf16 v[48:63], v[88:91], v[8:11], 0
    s_and_b32 s57, s57, 0x1ffff
    v_exp_f32 v69, v69
    v_exp_f32 v70, v70
    v_exp_f32 v71, v71
    v_exp_f32 v72, v72
    v_exp_f32 v73, v73
    v_smfmac_f32_32x32x32_bf16 v[32:47], v[120:123], v[64:71], v4
    buffer_load_dwordx4 v[168:171], v2, s[4:7], s59 offen offset:2048 sc1
    v_exp_f32 v74, v74
    v_exp_f32 v75, v75
    v_exp_f32 v76, v76
    v_exp_f32 v77, v77
    v_exp_f32 v78, v78
    v_exp_f32 v79, v79
    v_exp_f32 v48, v48
    v_exp_f32 v49, v49
    v_smfmac_f32_32x32x32_bf16 v[32:47], v[124:127], v[72:79], v4
    s_waitcnt vmcnt(15)
    s_mov_b64 exec, s[54:55]
    ds_read_b128 v[120:123], v3 offset:3072
    ds_read_b128 v[124:127], v3 offset:3584
    s_mov_b64 exec, -1
    v_exp_f32 v50, v50
    v_exp_f32 v51, v51
    v_exp_f32 v52, v52
    v_mfma_f32_32x32x16_bf16 v[64:79], v[88:91], v[12:15], 0
    s_waitcnt lgkmcnt(2)
    v_exp_f32 v53, v53
    v_exp_f32 v54, v54
    v_exp_f32 v55, v55
    v_exp_f32 v56, v56
    v_exp_f32 v57, v57
    v_smfmac_f32_32x32x32_bf16 v[16:31], v[112:115], v[48:55], v4
    s_add_u32 s46, s56, s57
    buffer_load_dwordx4 v[80:83], v2, s[4:7], s46 offen sc1
    v_exp_f32 v58, v58
    v_exp_f32 v59, v59
    v_exp_f32 v60, v60
    v_exp_f32 v61, v61
    v_exp_f32 v62, v62
    v_exp_f32 v63, v63
    v_exp_f32 v64, v64
    v_exp_f32 v65, v65
    v_smfmac_f32_32x32x32_bf16 v[16:31], v[116:119], v[56:63], v4
    s_add_u32 m0, s81, -1024
    s_add_u32 s57, s57, 4096
    buffer_load_dwordx4 v2, s[4:7], s46 offen offset:1024 sc1 lds
    v_exp_f32 v66, v66
    v_exp_f32 v67, v67
    v_exp_f32 v68, v68
    v_mfma_f32_32x32x16_bf16 v[48:63], v[92:95], v[8:11], 0
    s_and_b32 s57, s57, 0x1ffff
    v_exp_f32 v69, v69
    v_exp_f32 v70, v70
    v_exp_f32 v71, v71
    v_exp_f32 v72, v72
    v_exp_f32 v73, v73
    v_smfmac_f32_32x32x32_bf16 v[32:47], v[112:115], v[64:71], v4
    buffer_load_dwordx4 v[172:175], v2, s[4:7], s59 offen offset:3072 sc1
    s_add_u32 s59, s59, 4096
    buffer_load_dwordx4 v[176:179], v2, s[4:7], s59 offen offset:0 sc1
    v_exp_f32 v74, v74
    v_exp_f32 v75, v75
    v_exp_f32 v76, v76
    v_exp_f32 v77, v77
    v_exp_f32 v78, v78
    v_exp_f32 v79, v79
    v_exp_f32 v48, v48
    v_exp_f32 v49, v49
    v_smfmac_f32_32x32x32_bf16 v[32:47], v[116:119], v[72:79], v4
    s_waitcnt vmcnt(16)
    s_mov_b64 exec, s[54:55]
    ds_read_b128 v[112:115], v3 offset:4096
    ds_read_b128 v[116:119], v3 offset:4608
    s_mov_b64 exec, -1
    v_exp_f32 v50, v50
    v_exp_f32 v51, v51
    v_exp_f32 v52, v52
    v_mfma_f32_32x32x16_bf16 v[64:79], v[92:95], v[12:15], 0
    s_waitcnt lgkmcnt(2)
    v_exp_f32 v53, v53
    v_exp_f32 v54, v54
    v_exp_f32 v55, v55
    v_exp_f32 v56, v56
    v_exp_f32 v57, v57
    v_smfmac_f32_32x32x32_bf16 v[16:31], v[120:123], v[48:55], v4
    s_add_u32 s46, s56, s57
    buffer_load_dwordx4 v[84:87], v2, s[4:7], s46 offen sc1
    v_exp_f32 v58, v58
    v_exp_f32 v59, v59
    v_exp_f32 v60, v60
    v_exp_f32 v61, v61
    v_exp_f32 v62, v62
    v_exp_f32 v63, v63
    v_exp_f32 v64, v64
    v_exp_f32 v65, v65
    v_smfmac_f32_32x32x32_bf16 v[16:31], v[124:127], v[56:63], v4
    s_add_u32 m0, s81, 0
    s_add_u32 s57, s57, 4096
    buffer_load_dwordx4 v2, s[4:7], s46 offen offset:1024 sc1 lds
    v_exp_f32 v66, v66
    v_exp_f32 v67, v67
    v_exp_f32 v68, v68
    v_mfma_f32_32x32x16_bf16 v[48:63], v[96:99], v[8:11], 0
    s_and_b32 s57, s57, 0x1ffff
    v_exp_f32 v69, v69
    v_exp_f32 v70, v70
    v_exp_f32 v71, v71
    v_exp_f32 v72, v72
    v_exp_f32 v73, v73
    v_smfmac_f32_32x32x32_bf16 v[32:47], v[120:123], v[64:71], v4
    buffer_load_dwordx4 v[180:183], v2, s[4:7], s59 offen offset:1024 sc1
    v_exp_f32 v74, v74
    v_exp_f32 v75, v75
    v_exp_f32 v76, v76
    v_exp_f32 v77, v77
    v_exp_f32 v78, v78
    v_exp_f32 v79, v79
    v_exp_f32 v48, v48
    v_exp_f32 v49, v49
    v_smfmac_f32_32x32x32_bf16 v[32:47], v[124:127], v[72:79], v4
    s_waitcnt vmcnt(15)
    s_mov_b64 exec, s[54:55]
    ds_read_b128 v[120:123], v3 offset:5120
    ds_read_b128 v[124:127], v3 offset:5632
    s_mov_b64 exec, -1
    v_exp_f32 v50, v50
    v_exp_f32 v51, v51
    v_exp_f32 v52, v52
    v_mfma_f32_32x32x16_bf16 v[64:79], v[96:99], v[12:15], 0
    s_waitcnt lgkmcnt(2)
    v_exp_f32 v53, v53
    v_exp_f32 v54, v54
    v_exp_f32 v55, v55
    v_exp_f32 v56, v56
    v_exp_f32 v57, v57
    v_smfmac_f32_32x32x32_bf16 v[16:31], v[112:115], v[48:55], v4
    s_add_u32 s46, s56, s57
    buffer_load_dwordx4 v[88:91], v2, s[4:7], s46 offen sc1
    v_exp_f32 v58, v58
    v_exp_f32 v59, v59
    v_exp_f32 v60, v60
    v_exp_f32 v61, v61
    v_exp_f32 v62, v62
    v_exp_f32 v63, v63
    v_exp_f32 v64, v64
    v_exp_f32 v65, v65
    v_smfmac_f32_32x32x32_bf16 v[16:31], v[116:119], v[56:63], v4
    s_add_u32 m0, s81, 1024
    s_add_u32 s57, s57, 4096
    buffer_load_dwordx4 v2, s[4:7], s46 offen offset:1024 sc1 lds
    v_exp_f32 v66, v66
    v_exp_f32 v67, v67
    v_exp_f32 v68, v68
    v_mfma_f32_32x32x16_bf16 v[48:63], v[100:103], v[8:11], 0
    s_and_b32 s57, s57, 0x1ffff
    v_exp_f32 v69, v69
    v_exp_f32 v70, v70
    v_exp_f32 v71, v71
    v_exp_f32 v72, v72
    v_exp_f32 v73, v73
    v_smfmac_f32_32x32x32_bf16 v[32:47], v[112:115], v[64:71], v4
    buffer_load_dwordx4 v[184:187], v2, s[4:7], s59 offen offset:2048 sc1
    buffer_load_dwordx4 v[188:191], v2, s[4:7], s59 offen offset:3072 sc1
    v_exp_f32 v74, v74
    v_exp_f32 v75, v75
    v_exp_f32 v76, v76
    v_exp_f32 v77, v77
    v_exp_f32 v78, v78
    v_exp_f32 v79, v79
    v_exp_f32 v48, v48
    v_exp_f32 v49, v49
    v_smfmac_f32_32x32x32_bf16 v[32:47], v[116:119], v[72:79], v4
    s_waitcnt vmcnt(16)
    s_mov_b64 exec, s[54:55]
    ds_read_b128 v[112:115], v3 offset:6144
    ds_read_b128 v[116:119], v3 offset:6656
    s_mov_b64 exec, -1
    v_exp_f32 v50, v50
    v_exp_f32 v51, v51
    v_exp_f32 v52, v52
    v_mfma_f32_32x32x16_bf16 v[64:79], v[100:103], v[12:15], 0
    s_waitcnt lgkmcnt(2)
    v_exp_f32 v53, v53
    v_exp_f32 v54, v54
    v_exp_f32 v55, v55
    v_exp_f32 v56, v56
    v_exp_f32 v57, v57
    v_smfmac_f32_32x32x32_bf16 v[16:31], v[120:123], v[48:55], v4
    s_add_u32 s46, s56, s57
    buffer_load_dwordx4 v[92:95], v2, s[4:7], s46 offen sc1
    v_exp_f32 v58, v58
    v_exp_f32 v59, v59
    v_exp_f32 v60, v60
    v_exp_f32 v61, v61
    v_exp_f32 v62, v62
    v_exp_f32 v63, v63
    v_exp_f32 v64, v64
    v_exp_f32 v65, v65
    v_smfmac_f32_32x32x32_bf16 v[16:31], v[124:127], v[56:63], v4
    s_add_u32 m0, s81, 2048
    s_add_u32 s57, s57, 4096
    buffer_load_dwordx4 v2, s[4:7], s46 offen offset:1024 sc1 lds
    v_exp_f32 v66, v66
    v_exp_f32 v67, v67
    v_exp_f32 v68, v68
    v_mfma_f32_32x32x16_bf16 v[48:63], v[104:107], v[8:11], 0
    s_and_b32 s57, s57, 0x1ffff
    v_exp_f32 v69, v69
    v_exp_f32 v70, v70
    v_exp_f32 v71, v71
    v_exp_f32 v72, v72
    v_exp_f32 v73, v73
    v_smfmac_f32_32x32x32_bf16 v[32:47], v[120:123], v[64:71], v4
    s_add_u32 s50, s68, 0
    buffer_load_dwordx4 v[192:195], v7, s[4:7], s50 offen offset:0 sc1
    v_exp_f32 v74, v74
    v_exp_f32 v75, v75
    v_exp_f32 v76, v76
    v_exp_f32 v77, v77
    v_exp_f32 v78, v78
    v_exp_f32 v79, v79
    v_exp_f32 v48, v48
    v_exp_f32 v49, v49
    v_smfmac_f32_32x32x32_bf16 v[32:47], v[124:127], v[72:79], v4
    s_waitcnt vmcnt(15)
    s_mov_b64 exec, s[54:55]
    ds_read_b128 v[120:123], v3 offset:7168
    ds_read_b128 v[124:127], v3 offset:7680
    s_mov_b64 exec, -1
    v_exp_f32 v50, v50
    v_exp_f32 v51, v51
    v_exp_f32 v52, v52
    v_mfma_f32_32x32x16_bf16 v[64:79], v[104:107], v[12:15], 0
    s_waitcnt lgkmcnt(2)
    v_exp_f32 v53, v53
    v_exp_f32 v54, v54
    v_exp_f32 v55, v55
    v_exp_f32 v56, v56
    v_exp_f32 v57, v57
    v_smfmac_f32_32x32x32_bf16 v[16:31], v[112:115], v[48:55], v4
    s_add_u32 s46, s56, s57
    buffer_load_dwordx4 v[96:99], v2, s[4:7], s46 offen sc1
    v_exp_f32 v58, v58
    v_exp_f32 v59, v59
    v_exp_f32 v60, v60
    v_exp_f32 v61, v61
    v_exp_f32 v62, v62
    v_exp_f32 v63, v63
    v_exp_f32 v64, v64
    v_exp_f32 v65, v65
    v_smfmac_f32_32x32x32_bf16 v[16:31], v[116:119], v[56:63], v4
    s_add_u32 m0, s81, 3072
    s_add_u32 s57, s57, 4096
    buffer_load_dwordx4 v2, s[4:7], s46 offen offset:1024 sc1 lds
    v_exp_f32 v66, v66
    v_exp_f32 v67, v67
    v_exp_f32 v68, v68
    v_mfma_f32_32x32x16_bf16 v[48:63], v[108:111], v[8:11], 0
    s_and_b32 s57, s57, 0x1ffff
    v_exp_f32 v69, v69
    v_exp_f32 v70, v70
    v_exp_f32 v71, v71
    v_exp_f32 v72, v72
    v_exp_f32 v73, v73
    v_smfmac_f32_32x32x32_bf16 v[32:47], v[112:115], v[64:71], v4
    s_cmp_lg_u32 s40, 1
    s_cbranch_scc1 L_only_39
    v_lshlrev_b32 v5, 7, v0
    s_mov_b64 exec, 0x380
    buffer_load_dword v5, v5, s[4:7], s85 offen sc1
    s_mov_b64 exec, -1
L_only_39:
    s_cmp_lg_u32 s40, 0
    s_cbranch_scc1 L_only_40
    v_bfe_u32 v5, v0, 4, 1
    v_mul_u32_u24 v5, 5888, v5
    v_and_b32 v253, 31, v0
    v_lshl_add_u32 v5, v253, 4, v5
    s_lshl_b32 s88, s44, 8
    s_add_u32 s88, s88, 18092032
    s_mov_b32 s89, 57344
L_only_40:
    s_cmp_lg_u32 s40, 0
    s_cbranch_scc1 L_only_41
    s_add_u32 m0, s89, 0
    s_add_u32 s50, s88, 0
    buffer_load_dwordx4 v5, s[4:7], s50 offen sc1 lds
L_only_41:
    s_add_u32 s50, s68, 4096
    buffer_load_dwordx4 v[196:199], v7, s[4:7], s50 offen offset:0 sc1
    s_add_u32 s50, s68, 8192
    buffer_load_dwordx4 v[200:203], v7, s[4:7], s50 offen offset:0 sc1
    v_exp_f32 v74, v74
    v_exp_f32 v75, v75
    v_exp_f32 v76, v76
    v_exp_f32 v77, v77
    v_exp_f32 v78, v78
    v_exp_f32 v79, v79
    v_exp_f32 v48, v48
    v_exp_f32 v49, v49
    v_smfmac_f32_32x32x32_bf16 v[32:47], v[116:119], v[72:79], v4
    s_waitcnt vmcnt(16)
    s_mov_b64 exec, s[54:55]
    ds_read_b128 v[112:115], v3 offset:0
    ds_read_b128 v[116:119], v3 offset:512
    s_mov_b64 exec, -1
    v_exp_f32 v50, v50
    v_exp_f32 v51, v51
    v_exp_f32 v52, v52
    v_mfma_f32_32x32x16_bf16 v[64:79], v[108:111], v[12:15], 0
    s_waitcnt lgkmcnt(2)
    v_exp_f32 v53, v53
    v_exp_f32 v54, v54
    v_exp_f32 v55, v55
    v_exp_f32 v56, v56
    v_exp_f32 v57, v57
    v_smfmac_f32_32x32x32_bf16 v[16:31], v[120:123], v[48:55], v4
    s_add_u32 s46, s56, s57
    buffer_load_dwordx4 v[100:103], v2, s[4:7], s46 offen sc1
    v_exp_f32 v58, v58
    v_exp_f32 v59, v59
    v_exp_f32 v60, v60
    v_exp_f32 v61, v61
    v_exp_f32 v62, v62
    v_exp_f32 v63, v63
    v_exp_f32 v64, v64
    v_exp_f32 v65, v65
    v_smfmac_f32_32x32x32_bf16 v[16:31], v[124:127], v[56:63], v4
    s_add_u32 m0, s81, 4096
    s_add_u32 s57, s57, 4096
    buffer_load_dwordx4 v2, s[4:7], s46 offen offset:1024 sc1 lds
    v_exp_f32 v66, v66
    v_exp_f32 v67, v67
    v_exp_f32 v68, v68
    v_mfma_f32_32x32x16_bf16 v[48:63], v[80:83], v[8:11], 0
    s_and_b32 s57, s57, 0x1ffff
    v_exp_f32 v69, v69
    v_exp_f32 v70, v70
    v_exp_f32 v71, v71
    v_exp_f32 v72, v72
    v_exp_f32 v73, v73
    v_smfmac_f32_32x32x32_bf16 v[32:47], v[120:123], v[64:71], v4
    s_cmp_lg_u32 s40, 0
    s_cbranch_scc1 L_only_42
    s_add_u32 m0, s89, 1024
    s_add_u32 s50, s88, 12288
    buffer_load_dwordx4 v5, s[4:7], s50 offen sc1 lds
L_only_42:
    s_add_u32 s50, s68, 12288
    buffer_load_dwordx4 v[204:207], v7, s[4:7], s50 offen offset:0 sc1
    v_exp_f32 v74, v74
    v_exp_f32 v75, v75
    v_exp_f32 v76, v76
    v_exp_f32 v77, v77
    v_exp_f32 v78, v78
    v_exp_f32 v79, v79
    v_exp_f32 v48, v48
    v_exp_f32 v49, v49
    v_smfmac_f32_32x32x32_bf16 v[32:47], v[124:127], v[72:79], v4
    s_waitcnt vmcnt(15)
    s_mov_b64 exec, s[54:55]
    ds_read_b128 v[120:123], v3 offset:1024
    ds_read_b128 v[124:127], v3 offset:1536
    s_mov_b64 exec, -1
    v_exp_f32 v50, v50
    v_exp_f32 v51, v51
    v_exp_f32 v52, v52
    v_mfma_f32_32x32x16_bf16 v[64:79], v[80:83], v[12:15], 0
    s_waitcnt lgkmcnt(2)
    v_exp_f32 v53, v53
    v_exp_f32 v54, v54
    v_exp_f32 v55, v55
    v_exp_f32 v56, v56
    v_exp_f32 v57, v57
    v_smfmac_f32_32x32x32_bf16 v[16:31], v[112:115], v[48:55], v4
    s_add_u32 s46, s56, s57
    buffer_load_dwordx4 v[104:107], v2, s[4:7], s46 offen sc1
    s_add_u32 s50, s68, 0
    buffer_load_dwordx4 v[80:83], v7, s[4:7], s50 offen offset:2048 sc1
    v_exp_f32 v58, v58
    v_exp_f32 v59, v59
    v_exp_f32 v60, v60
    v_exp_f32 v61, v61
    v_exp_f32 v62, v62
    v_exp_f32 v63, v63
    v_exp_f32 v64, v64
    v_exp_f32 v65, v65
    v_smfmac_f32_32x32x32_bf16 v[16:31], v[116:119], v[56:63], v4
    s_add_u32 m0, s81, 5120
    s_add_u32 s57, s57, 4096
    buffer_load_dwordx4 v2, s[4:7], s46 offen offset:1024 sc1 lds
    v_exp_f32 v66, v66
    v_exp_f32 v67, v67
    v_exp_f32 v68, v68
    v_mfma_f32_32x32x16_bf16 v[48:63], v[84:87], v[8:11], 0
    s_and_b32 s57, s57, 0x1ffff
    v_exp_f32 v69, v69
    v_exp_f32 v70, v70
    v_exp_f32 v71, v71
    v_exp_f32 v72, v72
    v_exp_f32 v73, v73
    v_smfmac_f32_32x32x32_bf16 v[32:47], v[112:115], v[64:71], v4
    s_cmp_lg_u32 s40, 0
    s_cbranch_scc1 L_only_43
    s_add_u32 m0, s89, 2048
    s_add_u32 s50, s88, 24576
    buffer_load_dwordx4 v5, s[4:7], s50 offen sc1 lds
L_only_43:
    s_add_u32 s50, s68, 16384
    buffer_load_dwordx4 v[208:211], v7, s[4:7], s50 offen offset:0 sc1
    s_add_u32 s50, s68, 20480
    buffer_load_dwordx4 v[212:215], v7, s[4:7], s50 offen offset:0 sc1
    v_exp_f32 v74, v74
    v_exp_f32 v75, v75
    v_exp_f32 v76, v76
    v_exp_f32 v77, v77
    v_exp_f32 v78, v78
    v_exp_f32 v79, v79
    v_exp_f32 v48, v48
    v_exp_f32 v49, v49
    v_smfmac_f32_32x32x32_bf16 v[32:47], v[116:119], v[72:79], v4
    s_waitcnt vmcnt(17)
    s_mov_b64 exec, s[54:55]
    ds_read_b128 v[112:115], v3 offset:2048
    ds_read_b128 v[116:119], v3 offset:2560
    s_mov_b64 exec, -1
    v_exp_f32 v50, v50
    v_exp_f32 v51, v51
    v_exp_f32 v52, v52
    v_mfma_f32_32x32x16_bf16 v[64:79], v[84:87], v[12:15], 0
    s_waitcnt lgkmcnt(2)
    v_exp_f32 v53, v53
    v_exp_f32 v54, v54
    v_exp_f32 v55, v55
    v_exp_f32 v56, v56
    v_exp_f32 v57, v57
    v_smfmac_f32_32x32x32_bf16 v[16:31], v[120:123], v[48:55], v4
    s_add_u32 s46, s56, s57
    buffer_load_dwordx4 v[108:111], v2, s[4:7], s46 offen sc1
    s_add_u32 s50, s68, 4096
    buffer_load_dwordx4 v[84:87], v7, s[4:7], s50 offen offset:2048 sc1
    v_exp_f32 v58, v58
    v_exp_f32 v59, v59
    v_exp_f32 v60, v60
    v_exp_f32 v61, v61
    v_exp_f32 v62, v62
    v_exp_f32 v63, v63
    v_exp_f32 v64, v64
    v_exp_f32 v65, v65
    v_smfmac_f32_32x32x32_bf16 v[16:31], v[124:127], v[56:63], v4
    s_add_u32 m0, s81, 6144
    s_add_u32 s57, s57, 4096
    buffer_load_dwordx4 v2, s[4:7], s46 offen offset:1024 sc1 lds
    v_exp_f32 v66, v66
    v_exp_f32 v67, v67
    v_exp_f32 v68, v68
    v_mfma_f32_32x32x16_bf16 v[48:63], v[88:91], v[8:11], 0
    s_and_b32 s57, s57, 0x1ffff
    v_exp_f32 v69, v69
    v_exp_f32 v70, v70
    v_exp_f32 v71, v71
    v_exp_f32 v72, v72
    v_exp_f32 v73, v73
    v_smfmac_f32_32x32x32_bf16 v[32:47], v[120:123], v[64:71], v4
    s_cmp_lg_u32 s40, 0
    s_cbranch_scc1 L_only_44
    s_add_u32 m0, s89, 3072
    s_add_u32 s50, s88, 36864
    buffer_load_dwordx4 v5, s[4:7], s50 offen sc1 lds
L_only_44:
    s_add_u32 s50, s68, 24576
    buffer_load_dwordx4 v[216:219], v7, s[4:7], s50 offen offset:0 sc1
    v_exp_f32 v74, v74
    v_exp_f32 v75, v75
    v_exp_f32 v76, v76
    v_exp_f32 v77, v77
    v_exp_f32 v78, v78
    v_exp_f32 v79, v79
    v_exp_f32 v48, v48
    v_exp_f32 v49, v49
    v_smfmac_f32_32x32x32_bf16 v[32:47], v[124:127], v[72:79], v4
    s_waitcnt vmcnt(17)
    s_mov_b64 exec, s[54:55]
    ds_read_b128 v[120:123], v3 offset:3072
    ds_read_b128 v[124:127], v3 offset:3584
    s_mov_b64 exec, -1
    v_exp_f32 v50, v50
    v_exp_f32 v51, v51
    v_exp_f32 v52, v52
    v_mfma_f32_32x32x16_bf16 v[64:79], v[88:91], v[12:15], 0
    s_waitcnt lgkmcnt(2)
    v_exp_f32 v53, v53
    v_exp_f32 v54, v54
    v_exp_f32 v55, v55
    v_exp_f32 v56, v56
    v_exp_f32 v57, v57
    v_smfmac_f32_32x32x32_bf16 v[16:31], v[112:115], v[48:55], v4
    s_add_u32 s50, s68, 8192
    buffer_load_dwordx4 v[88:91], v7, s[4:7], s50 offen offset:2048 sc1
    v_exp_f32 v58, v58
    v_exp_f32 v59, v59
    v_exp_f32 v60, v60
    v_exp_f32 v61, v61
    v_exp_f32 v62, v62
    v_exp_f32 v63, v63
    v_exp_f32 v64, v64
    v_exp_f32 v65, v65
    v_smfmac_f32_32x32x32_bf16 v[16:31], v[116:119], v[56:63], v4
    s_add_u32 s50, s68, 28672
    buffer_load_dwordx4 v[220:223], v7, s[4:7], s50 offen offset:0 sc1
    v_exp_f32 v66, v66
    v_exp_f32 v67, v67
    v_exp_f32 v68, v68
    v_mfma_f32_32x32x16_bf16 v[48:63], v[92:95], v[8:11], 0
    v_exp_f32 v69, v69
    v_exp_f32 v70, v70
    v_exp_f32 v71, v71
    v_exp_f32 v72, v72
    v_exp_f32 v73, v73
    v_smfmac_f32_32x32x32_bf16 v[32:47], v[112:115], v[64:71], v4
    s_cmp_lg_u32 s40, 0
    s_cbranch_scc1 L_only_45
    s_add_u32 m0, s89, 4096
    s_add_u32 s50, s88, 49152
    buffer_load_dwordx4 v5, s[4:7], s50 offen sc1 lds
L_only_45:
    s_add_u32 s50, s68, 0
    buffer_load_dwordx4 v[224:227], v7, s[4:7], s50 offen offset:1024 sc1
    v_exp_f32 v74, v74
    v_exp_f32 v75, v75
    v_exp_f32 v76, v76
    v_exp_f32 v77, v77
    v_exp_f32 v78, v78
    v_exp_f32 v79, v79
    v_exp_f32 v48, v48
    v_exp_f32 v49, v49
    v_smfmac_f32_32x32x32_bf16 v[32:47], v[116:119], v[72:79], v4
    s_waitcnt vmcnt(17)
    s_mov_b64 exec, s[54:55]
    ds_read_b128 v[112:115], v3 offset:4096
    ds_read_b128 v[116:119], v3 offset:4608
    s_mov_b64 exec, -1
    v_exp_f32 v50, v50
    v_exp_f32 v51, v51
    v_exp_f32 v52, v52
    v_mfma_f32_32x32x16_bf16 v[64:79], v[92:95], v[12:15], 0
    s_waitcnt lgkmcnt(2)
    v_exp_f32 v53, v53
    v_exp_f32 v54, v54
    v_exp_f32 v55, v55
    v_exp_f32 v56, v56
    v_exp_f32 v57, v57
    v_smfmac_f32_32x32x32_bf16 v[16:31], v[120:123], v[48:55], v4
    s_add_u32 s50, s68, 12288
    buffer_load_dwordx4 v[92:95], v7, s[4:7], s50 offen offset:2048 sc1
    v_exp_f32 v58, v58
    v_exp_f32 v59, v59
    v_exp_f32 v60, v60
    v_exp_f32 v61, v61
    v_exp_f32 v62, v62
    v_exp_f32 v63, v63
    v_exp_f32 v64, v64
    v_exp_f32 v65, v65
    v_smfmac_f32_32x32x32_bf16 v[16:31], v[124:127], v[56:63], v4
    v_exp_f32 v66, v66
    v_exp_f32 v67, v67
    v_exp_f32 v68, v68
    v_mfma_f32_32x32x16_bf16 v[48:63], v[96:99], v[8:11], 0
    v_exp_f32 v69, v69
    v_exp_f32 v70, v70
    v_exp_f32 v71, v71
    v_exp_f32 v72, v72
    v_exp_f32 v73, v73
    v_smfmac_f32_32x32x32_bf16 v[32:47], v[120:123], v[64:71], v4
    s_setprio 1
    s_cmp_lg_u32 s40, 0
    s_cbranch_scc1 L_only_46
    s_add_u32 m0, s89, 5120
    s_add_u32 s50, s88, 61440
    buffer_load_dwordx4 v5, s[4:7], s50 offen sc1 lds
L_only_46:
    s_add_u32 s50, s68, 4096
    buffer_load_dwordx4 v[228:231], v7, s[4:7], s50 offen offset:1024 sc1
    v_exp_f32 v74, v74
    v_exp_f32 v75, v75
    v_exp_f32 v76, v76
    v_exp_f32 v77, v77
    v_exp_f32 v78, v78
    v_exp_f32 v79, v79
    v_exp_f32 v48, v48
    v_exp_f32 v49, v49
    v_smfmac_f32_32x32x32_bf16 v[32:47], v[124:127], v[72:79], v4
    s_waitcnt vmcnt(15)
    s_mov_b64 exec, s[54:55]
    ds_read_b128 v[120:123], v3 offset:5120
    ds_read_b128 v[124:127], v3 offset:5632
    s_mov_b64 exec, -1
    v_exp_f32 v50, v50
    v_exp_f32 v51, v51
    v_exp_f32 v52, v52
    v_mfma_f32_32x32x16_bf16 v[64:79], v[96:99], v[12:15], 0
    s_waitcnt lgkmcnt(2)
    v_exp_f32 v53, v53
    v_exp_f32 v54, v54
    v_exp_f32 v55, v55
    v_exp_f32 v56, v56
    v_exp_f32 v57, v57
    v_smfmac_f32_32x32x32_bf16 v[16:31], v[112:115], v[48:55], v4
    s_add_u32 s50, s68, 16384
    buffer_load_dwordx4 v[96:99], v7, s[4:7], s50 offen offset:2048 sc1
    v_exp_f32 v58, v58
    v_exp_f32 v59, v59
    v_exp_f32 v60, v60
    v_exp_f32 v61, v61
    v_exp_f32 v62, v62
    v_exp_f32 v63, v63
    v_exp_f32 v64, v64
    v_exp_f32 v65, v65
    v_smfmac_f32_32x32x32_bf16 v[16:31], v[116:119], v[56:63], v4
    s_add_u32 s50, s68, 8192
    buffer_load_dwordx4 v[232:235], v7, s[4:7], s50 offen offset:1024 sc1
    v_exp_f32 v66, v66
    v_exp_f32 v67, v67
    v_exp_f32 v68, v68
    v_mfma_f32_32x32x16_bf16 v[48:63], v[100:103], v[8:11], 0
    v_exp_f32 v69, v69
    v_exp_f32 v70, v70
    v_exp_f32 v71, v71
    v_exp_f32 v72, v72
    v_exp_f32 v73, v73
    v_smfmac_f32_32x32x32_bf16 v[32:47], v[112:115], v[64:71], v4
    s_cmp_lg_u32 s40, 0
    s_cbranch_scc1 L_only_47
    s_add_u32 m0, s89, 6144
    s_add_u32 s50, s88, 73728
    buffer_load_dwordx4 v5, s[4:7], s50 offen sc1 lds
L_only_47:
    s_add_u32 s50, s68, 12288
    buffer_load_dwordx4 v[236:239], v7, s[4:7], s50 offen offset:1024 sc1
    v_exp_f32 v74, v74
    v_exp_f32 v75, v75
    v_exp_f32 v76, v76
    v_exp_f32 v77, v77
    v_exp_f32 v78, v78
    v_exp_f32 v79, v79
    v_exp_f32 v48, v48
    v_exp_f32 v49, v49
    v_smfmac_f32_32x32x32_bf16 v[32:47], v[116:119], v[72:79], v4
    s_waitcnt vmcnt(14)
    s_mov_b64 exec, s[54:55]
    ds_read_b128 v[112:115], v3 offset:6144
    ds_read_b128 v[116:119], v3 offset:6656
    s_mov_b64 exec, -1
    v_exp_f32 v50, v50
    v_exp_f32 v51, v51
    v_exp_f32 v52, v52
    v_mfma_f32_32x32x16_bf16 v[64:79], v[100:103], v[12:15], 0
    s_waitcnt lgkmcnt(2)
    v_exp_f32 v53, v53
    v_exp_f32 v54, v54
    v_exp_f32 v55, v55
    v_exp_f32 v56, v56
    v_exp_f32 v57, v57
    v_smfmac_f32_32x32x32_bf16 v[16:31], v[120:123], v[48:55], v4
    s_add_u32 s50, s68, 20480
    buffer_load_dwordx4 v[100:103], v7, s[4:7], s50 offen offset:2048 sc1
    v_exp_f32 v58, v58
    v_exp_f32 v59, v59
    v_exp_f32 v60, v60
    v_exp_f32 v61, v61
    v_exp_f32 v62, v62
    v_exp_f32 v63, v63
    v_exp_f32 v64, v64
    v_exp_f32 v65, v65
    v_smfmac_f32_32x32x32_bf16 v[16:31], v[124:127], v[56:63], v4
    v_exp_f32 v66, v66
    v_exp_f32 v67, v67
    v_exp_f32 v68, v68
    v_mfma_f32_32x32x16_bf16 v[48:63], v[104:107], v[8:11], 0
    v_exp_f32 v69, v69
    v_exp_f32 v70, v70
    v_exp_f32 v71, v71
    v_exp_f32 v72, v72
    v_exp_f32 v73, v73
    v_smfmac_f32_32x32x32_bf16 v[32:47], v[120:123], v[64:71], v4
    s_cmp_lg_u32 s40, 0
    s_cbranch_scc1 L_only_48
    s_add_u32 m0, s89, 7168
    s_add_u32 s50, s88, 86016
    buffer_load_dwordx4 v5, s[4:7], s50 offen sc1 lds
L_only_48:
    s_add_u32 s50, s68, 16384
    buffer_load_dwordx4 v[240:243], v7, s[4:7], s50 offen offset:1024 sc1
    v_exp_f32 v74, v74
    v_exp_f32 v75, v75
    v_exp_f32 v76, v76
    v_exp_f32 v77, v77
    v_exp_f32 v78, v78
    v_exp_f32 v79, v79
    v_exp_f32 v48, v48
    v_exp_f32 v49, v49
    v_smfmac_f32_32x32x32_bf16 v[32:47], v[124:127], v[72:79], v4
    s_waitcnt vmcnt(11)
    s_mov_b64 exec, s[54:55]
    ds_read_b128 v[120:123], v3 offset:7168
    ds_read_b128 v[124:127], v3 offset:7680
    s_mov_b64 exec, -1
    v_exp_f32 v50, v50
    v_exp_f32 v51, v51
    v_exp_f32 v52, v52
    v_mfma_f32_32x32x16_bf16 v[64:79], v[104:107], v[12:15], 0
    s_waitcnt lgkmcnt(2)
    v_exp_f32 v53, v53
    v_exp_f32 v54, v54
    v_exp_f32 v55, v55
    v_exp_f32 v56, v56
    v_exp_f32 v57, v57
    v_smfmac_f32_32x32x32_bf16 v[16:31], v[112:115], v[48:55], v4
    s_add_u32 s50, s68, 24576
    buffer_load_dwordx4 v[104:107], v7, s[4:7], s50 offen offset:2048 sc1
    v_exp_f32 v58, v58
    v_exp_f32 v59, v59
    v_exp_f32 v60, v60
    v_exp_f32 v61, v61
    v_exp_f32 v62, v62
    v_exp_f32 v63, v63
    v_exp_f32 v64, v64
    v_exp_f32 v65, v65
    v_smfmac_f32_32x32x32_bf16 v[16:31], v[116:119], v[56:63], v4
    s_add_u32 s50, s68, 20480
    buffer_load_dwordx4 v[244:247], v7, s[4:7], s50 offen offset:1024 sc1
    v_exp_f32 v66, v66
    v_exp_f32 v67, v67
    v_exp_f32 v68, v68
    v_mfma_f32_32x32x16_bf16 v[48:63], v[108:111], v[8:11], 0
    v_exp_f32 v69, v69
    v_exp_f32 v70, v70
    v_exp_f32 v71, v71
    v_exp_f32 v72, v72
    v_exp_f32 v73, v73
    v_smfmac_f32_32x32x32_bf16 v[32:47], v[112:115], v[64:71], v4
    s_add_u32 s50, s68, 24576
    buffer_load_dwordx4 v[248:251], v7, s[4:7], s50 offen offset:1024 sc1
    v_exp_f32 v74, v74
    v_exp_f32 v75, v75
    v_exp_f32 v76, v76
    v_exp_f32 v77, v77
    v_exp_f32 v78, v78
    v_exp_f32 v79, v79
    v_exp_f32 v48, v48
    v_exp_f32 v49, v49
    v_smfmac_f32_32x32x32_bf16 v[32:47], v[116:119], v[72:79], v4
    v_exp_f32 v50, v50
    v_exp_f32 v51, v51
    v_exp_f32 v52, v52
    v_mfma_f32_32x32x16_bf16 v[64:79], v[108:111], v[12:15], 0
    s_waitcnt lgkmcnt(0)
    v_exp_f32 v53, v53
    v_exp_f32 v54, v54
    v_exp_f32 v55, v55
    v_exp_f32 v56, v56
    v_exp_f32 v57, v57
    v_smfmac_f32_32x32x32_bf16 v[16:31], v[120:123], v[48:55], v4
    s_add_u32 s50, s68, 28672
    buffer_load_dwordx4 v[108:111], v7, s[4:7], s50 offen offset:2048 sc1
    v_exp_f32 v58, v58
    v_exp_f32 v59, v59
    v_exp_f32 v60, v60
    v_exp_f32 v61, v61
    v_exp_f32 v62, v62
    v_exp_f32 v63, v63
    v_exp_f32 v64, v64
    v_exp_f32 v65, v65
    v_smfmac_f32_32x32x32_bf16 v[16:31], v[124:127], v[56:63], v4
    v_exp_f32 v66, v66
    v_exp_f32 v67, v67
    v_exp_f32 v68, v68
    v_exp_f32 v69, v69
    v_exp_f32 v70, v70
    v_exp_f32 v71, v71
    v_exp_f32 v72, v72
    v_exp_f32 v73, v73
    v_smfmac_f32_32x32x32_bf16 v[32:47], v[120:123], v[64:71], v4
    s_setprio 0
    s_add_u32 s50, s68, 28672
    buffer_load_dwordx4 v[252:255], v7, s[4:7], s50 offen offset:1024 sc1
    v_exp_f32 v74, v74
    v_exp_f32 v75, v75
    v_exp_f32 v76, v76
    v_exp_f32 v77, v77
    v_exp_f32 v78, v78
    v_exp_f32 v79, v79
    s_add_u32 s48, s81, 5888
    s_add_u32 s49, s81, 38656
    v_smfmac_f32_32x32x32_bf16 v[32:47], v[124:127], v[72:79], v4
    v_add_u32 v48, s48, v2
    v_lshlrev_b32 v51, 2, v0
    v_add_u32 v49, s48, v51
    v_add_u32 v50, s49, v2
    v_add_u32 v51, s49, v51
    s_lshl_b32 s48, s43, 5
    s_lshl_b32 s47, s44, 2
    s_add_u32 s48, s48, s47
    s_and_b32 s47, s40, 3
    s_add_u32 s48, s48, s47
    s_lshl_b32 s48, s48, 11
    s_add_u32 s48, s48, 5242880
    ds_write_b128 v48, v[32:35]
    ds_write_b128 v48, v[36:39] offset:1024
    ds_write_b32 v49, v40 offset:2048
    s_waitcnt lgkmcnt(0)
    s_barrier
    ds_read_b32 v40, v51 offset:2048
    ds_read_b128 v[32:35], v50
    ds_read_b128 v[36:39], v50 offset:1024
    s_mov_b32 s46, 0x5d800000
    s_waitcnt lgkmcnt(2)
    v_add_f32 v24, v24, v40
    v_cmp_nle_f32 vcc, 0x21800000, v24
    v_cmp_nge_f32 s[98:99], s46, v24
    s_waitcnt lgkmcnt(0)
    v_pk_add_f32 v[16:17], v[16:17], v[32:33]
    v_pk_add_f32 v[18:19], v[18:19], v[34:35]
    v_pk_add_f32 v[20:21], v[20:21], v[36:37]
    v_pk_add_f32 v[22:23], v[22:23], v[38:39]
    s_or_b64 vcc, vcc, s[98:99]
    s_cbranch_vccz L_fast_49
    v_subrev_u32 v3, s81, v3
    s_waitcnt vmcnt(0)
    s_sub_u32 s46, s56, 0
    s_mov_b32 s47, 64
    v_mov_b32 v72, 0xff800000
L_slow1_50:
    buffer_load_dwordx4 v[12:15], v2, s[4:7], s46 offen sc1
    s_add_u32 s46, s46, 2048
    s_waitcnt vmcnt(0)
    v_mfma_f32_32x32x16_bf16 v[48:63], v[12:15], v[8:11], 0
    s_nop 11
    v_max3_f32 v72, v72, v48, v49
    v_max3_f32 v72, v72, v50, v51
    v_max3_f32 v72, v72, v52, v53
    v_max3_f32 v72, v72, v54, v55
    v_max3_f32 v72, v72, v56, v57
    v_max3_f32 v72, v72, v58, v59
    v_max3_f32 v72, v72, v60, v61
    v_max3_f32 v72, v72, v62, v63
    s_sub_u32 s47, s47, 1
    s_cmp_lg_u32 s47, 0
    s_cbranch_scc1 L_slow1_50
    v_mov_b32 v73, v72
    s_nop 1
    v_permlane32_swap_b32 v72, v73
    v_max_f32 v72, v72, v73
    v_sub_f32 v32, 0, v72
    v_mov_b32 v16, 0
    v_sub_f32 v33, 0, v72
    v_mov_b32 v17, 0
    v_sub_f32 v34, 0, v72
    v_mov_b32 v18, 0
    v_sub_f32 v35, 0, v72
    v_mov_b32 v19, 0
    v_sub_f32 v36, 0, v72
    v_mov_b32 v20, 0
    v_sub_f32 v37, 0, v72
    v_mov_b32 v21, 0
    v_sub_f32 v38, 0, v72
    v_mov_b32 v22, 0
    v_sub_f32 v39, 0, v72
    v_mov_b32 v23, 0
    v_sub_f32 v40, 0, v72
    v_mov_b32 v24, 0
    v_sub_f32 v41, 0, v72
    v_mov_b32 v25, 0
    v_sub_f32 v42, 0, v72
    v_mov_b32 v26, 0
    v_sub_f32 v43, 0, v72
    v_mov_b32 v27, 0
    v_sub_f32 v44, 0, v72
    v_mov_b32 v28, 0
    v_sub_f32 v45, 0, v72
    v_mov_b32 v29, 0
    v_sub_f32 v46, 0, v72
    v_mov_b32 v30, 0
    v_sub_f32 v47, 0, v72
    v_mov_b32 v31, 0
    v_mov_b32 v64, 0x3f803f80
    v_mov_b32 v65, 0x3f803f80
    v_mov_b32 v66, 0x3f803f80
    v_mov_b32 v67, 0x3f803f80
    v_mov_b32 v68, 0x3f803f80
    v_mov_b32 v69, 0x3f803f80
    v_mov_b32 v70, 0x3f803f80
    v_mov_b32 v71, 0x3f803f80
    s_sub_u32 s46, s56, 0
    s_mov_b32 s47, 64
L_slow2_51:
    buffer_load_dwordx4 v[12:15], v2, s[4:7], s46 offen sc1
    s_mov_b64 exec, s[54:55]
    buffer_load_dwordx4 v[64:67], v3, s[4:7], s46 offen offset:1024 sc1
    buffer_load_dwordx4 v[68:71], v3, s[4:7], s46 offen offset:1536 sc1
    s_mov_b64 exec, -1
    s_add_u32 s46, s46, 2048
    s_waitcnt vmcnt(0)
    v_mfma_f32_32x32x16_bf16 v[48:63], v[12:15], v[8:11], v[32:47]
    s_nop 11
    v_exp_f32 v48, v48
    v_exp_f32 v49, v49
    v_exp_f32 v50, v50
    v_exp_f32 v51, v51
    v_exp_f32 v52, v52
    v_exp_f32 v53, v53
    v_exp_f32 v54, v54
    v_exp_f32 v55, v55
    v_exp_f32 v56, v56
    v_exp_f32 v57, v57
    v_exp_f32 v58, v58
    v_exp_f32 v59, v59
    v_exp_f32 v60, v60
    v_exp_f32 v61, v61
    v_exp_f32 v62, v62
    v_exp_f32 v63, v63
    v_smfmac_f32_32x32x32_bf16 v[16:31], v[64:67], v[48:55], v4
    s_nop 0
    v_smfmac_f32_32x32x32_bf16 v[16:31], v[68:71], v[56:63], v4
    s_sub_u32 s47, s47, 1
    s_cmp_lg_u32 s47, 0
    s_nop 7
    s_cbranch_scc1 L_slow2_51
    s_nop 7
    s_nop 7
    s_branch L_fast_49
L_kvw_9:
    s_mov_b32 s52, 400000
L_rp_kv_52:
    buffer_load_dword v254, v252, s[4:7], s70 offen sc1
    s_sub_u32 s52, s52, 1
    s_cmp_eq_u32 s52, 0
    s_waitcnt vmcnt(0)
    s_cbranch_scc1 L_rpd_kv_53
    v_cmp_ne_u32 vcc, s45, v254
    s_nop 0
    s_mov_b32 s71, vcc_lo
    s_and_b32 s50, vcc_lo, 0x10
    s_cbranch_scc1 L_rp_kv_52
L_rpd_kv_53:
    s_branch L_kvb_10
L_kvw_11:
    s_mov_b32 s52, 400000
L_rp_kv_54:
    buffer_load_dword v254, v252, s[4:7], s70 offen sc1
    s_sub_u32 s52, s52, 1
    s_cmp_eq_u32 s52, 0
    s_waitcnt vmcnt(0)
    s_cbranch_scc1 L_rpd_kv_55
    v_cmp_ne_u32 vcc, s45, v254
    s_nop 0
    s_mov_b32 s71, vcc_lo
    s_and_b32 s50, vcc_lo, 0x20
    s_cbranch_scc1 L_rp_kv_54
L_rpd_kv_55:
    s_branch L_kvb_12
L_kvw_13:
    s_mov_b32 s52, 400000
L_rp_kv_56:
    buffer_load_dword v254, v252, s[4:7], s70 offen sc1
    s_sub_u32 s52, s52, 1
    s_cmp_eq_u32 s52, 0
    s_waitcnt vmcnt(0)
    s_cbranch_scc1 L_rpd_kv_57
    v_cmp_ne_u32 vcc, s45, v254
    s_nop 0
    s_mov_b32 s71, vcc_lo
    s_and_b32 s50, vcc_lo, 0x40
    s_cbranch_scc1 L_rp_kv_56
L_rpd_kv_57:
    s_branch L_kvb_14
L_kvw_15:
    s_mov_b32 s52, 400000
L_rp_kv_58:
    buffer_load_dword v254, v252, s[4:7], s70 offen sc1
    s_sub_u32 s52, s52, 1
    s_cmp_eq_u32 s52, 0
    s_waitcnt vmcnt(0)
    s_cbranch_scc1 L_rpd_kv_59
    v_cmp_ne_u32 vcc, s45, v254
    s_nop 0
    s_mov_b32 s71, vcc_lo
    s_and_b32 s50, vcc_lo, 0x80
    s_cbranch_scc1 L_rp_kv_58
L_rpd_kv_59:
    s_branch L_kvb_16
L_kvw_18:
    s_mov_b32 s52, 400000
L_rp_kv_60:
    buffer_load_dword v254, v252, s[4:7], s70 offen sc1
    s_sub_u32 s52, s52, 1
    s_cmp_eq_u32 s52, 0
    s_waitcnt vmcnt(0)
    s_cbranch_scc1 L_rpd_kv_61
    v_cmp_ne_u32 vcc, s45, v254
    s_nop 0
    s_mov_b32 s71, vcc_lo
    s_and_b32 s50, vcc_lo, 0x100
    s_cbranch_scc1 L_rp_kv_60
L_rpd_kv_61:
    s_branch L_kvb_19
L_kvw_20:
    s_mov_b32 s52, 400000
L_rp_kv_62:
    buffer_load_dword v254, v252, s[4:7], s70 offen sc1
    s_sub_u32 s52, s52, 1
    s_cmp_eq_u32 s52, 0
    s_waitcnt vmcnt(0)
    s_cbranch_scc1 L_rpd_kv_63
    v_cmp_ne_u32 vcc, s45, v254
    s_nop 0
    s_mov_b32 s71, vcc_lo
    s_and_b32 s50, vcc_lo, 0x200
    s_cbranch_scc1 L_rp_kv_62
L_rpd_kv_63:
    s_branch L_kvb_21
L_kvw_23:
    s_mov_b32 s52, 400000
L_rp_kv_64:
    buffer_load_dword v254, v252, s[4:7], s70 offen sc1
    s_sub_u32 s52, s52, 1
    s_cmp_eq_u32 s52, 0
    s_waitcnt vmcnt(0)
    s_cbranch_scc1 L_rpd_kv_65
    v_cmp_ne_u32 vcc, s45, v254
    s_nop 0
    s_mov_b32 s71, vcc_lo
    s_and_b32 s50, vcc_lo, 0x400
    s_cbranch_scc1 L_rp_kv_64
L_rpd_kv_65:
    s_branch L_kvb_24
L_kvw_26:
    s_mov_b32 s52, 400000
L_rp_kv_66:
    buffer_load_dword v254, v252, s[4:7], s70 offen sc1
    s_sub_u32 s52, s52, 1
    s_cmp_eq_u32 s52, 0
    s_waitcnt vmcnt(0)
    s_cbranch_scc1 L_rpd_kv_67
    v_cmp_ne_u32 vcc, s45, v254
    s_nop 0
    s_mov_b32 s71, vcc_lo
    s_and_b32 s50, vcc_lo, 0x800
    s_cbranch_scc1 L_rp_kv_66
L_rpd_kv_67:
    s_branch L_kvb_27
L_kvw_29:
    s_mov_b32 s52, 400000
L_rp_kv_68:
    buffer_load_dword v254, v252, s[4:7], s70 offen sc1
    s_sub_u32 s52, s52, 1
    s_cmp_eq_u32 s52, 0
    s_waitcnt vmcnt(0)
    s_cbranch_scc1 L_rpd_kv_69
    v_cmp_ne_u32 vcc, s45, v254
    s_nop 0
    s_mov_b32 s71, vcc_lo
    s_and_b32 s50, vcc_lo, 0xfffff000
    s_cbranch_scc1 L_rp_kv_68
L_rpd_kv_69:
    s_branch L_kvb_30
L_fast_49:
    v_rcp_f32 v24, v24
    s_nop 0
    v_pk_mul_f32 v[16:17], v[16:17], v[24:25] op_sel_hi:[1,0]
    v_pk_mul_f32 v[18:19], v[18:19], v[24:25] op_sel_hi:[1,0]
    v_pk_mul_f32 v[20:21], v[20:21], v[24:25] op_sel_hi:[1,0]
    v_pk_mul_f32 v[22:23], v[22:23], v[24:25] op_sel_hi:[1,0]
    v_cvt_pk_bf16_f32 v52, v16, v17
    v_cvt_pk_bf16_f32 v53, v18, v19
    v_cvt_pk_bf16_f32 v54, v20, v21
    v_cvt_pk_bf16_f32 v55, v22, v23
    buffer_store_dwordx4 v[52:55], v2, s[4:7], s48 offen sc1
    s_lshl_b32 s47, s40, 10
    v_add_u32 v4, s47, v2
    ds_read_b128 v[56:59], v4 offset:16384
    s_cmp_lg_u32 s40, 0
    s_cbranch_scc1 L_only_70
    s_waitcnt vmcnt(7)
    v_add_u32 v3, s89, v2
    ds_read_b128 v[16:19], v3 offset:0
    ds_read_b128 v[20:23], v3 offset:1024
    ds_read_b128 v[24:27], v3 offset:2048
    ds_read_b128 v[28:31], v3 offset:3072
    ds_read_b128 v[32:35], v3 offset:4096
    ds_read_b128 v[36:39], v3 offset:5120
    ds_read_b128 v[40:43], v3 offset:6144
    ds_read_b128 v[44:47], v3 offset:7168
    s_waitcnt lgkmcnt(0)
    s_mov_b32 s52, 400000
L_g_gg_71:
    v_xor_b32 v17, s3, v17
    v_xor_b32 v19, s3, v19
    v_or_b32 v48, v17, v19
    v_xor_b32 v21, s3, v21
    v_xor_b32 v23, s3, v23
    v_or3_b32 v48, v48, v21, v23
    v_pk_add_f32 v[16:17], v[16:17], v[20:21]
    v_pk_add_f32 v[18:19], v[18:19], v[22:23]
    v_xor_b32 v25, s3, v25
    v_xor_b32 v27, s3, v27
    v_or3_b32 v48, v48, v25, v27
    v_pk_add_f32 v[16:17], v[16:17], v[24:25]
    v_pk_add_f32 v[18:19], v[18:19], v[26:27]
    v_xor_b32 v29, s3, v29
    v_xor_b32 v31, s3, v31
    v_or3_b32 v48, v48, v29, v31
    v_pk_add_f32 v[16:17], v[16:17], v[28:29]
    v_pk_add_f32 v[18:19], v[18:19], v[30:31]
    v_xor_b32 v33, s3, v33
    v_xor_b32 v35, s3, v35
    v_or3_b32 v48, v48, v33, v35
    v_pk_add_f32 v[16:17], v[16:17], v[32:33]
    v_pk_add_f32 v[18:19], v[18:19], v[34:35]
    v_xor_b32 v37, s3, v37
    v_xor_b32 v39, s3, v39
    v_or3_b32 v48, v48, v37, v39
    v_pk_add_f32 v[16:17], v[16:17], v[36:37]
    v_pk_add_f32 v[18:19], v[18:19], v[38:39]
    v_xor_b32 v41, s3, v41
    v_xor_b32 v43, s3, v43
    v_or3_b32 v48, v48, v41, v43
    v_pk_add_f32 v[16:17], v[16:17], v[40:41]
    v_pk_add_f32 v[18:19], v[18:19], v[42:43]
    v_xor_b32 v45, s3, v45
    v_xor_b32 v47, s3, v47
    v_or3_b32 v48, v48, v45, v47
    v_pk_add_f32 v[16:17], v[16:17], v[44:45]
    v_pk_add_f32 v[18:19], v[18:19], v[46:47]
    v_and_b32 v48, 0xff, v48
    v_cmp_ne_u32 vcc, 0, v48
    s_sub_u32 s52, s52, 1
    s_cmp_eq_u32 s52, 0
    s_cbranch_scc1 L_gd_gg_72
    s_cbranch_vccz L_gd_gg_72
    s_mov_b32 s50, s88
    buffer_load_dwordx4 v[16:19], v5, s[4:7], s50 offen sc1
    s_add_u32 s50, s50, 12288
    buffer_load_dwordx4 v[20:23], v5, s[4:7], s50 offen sc1
    s_add_u32 s50, s50, 12288
    buffer_load_dwordx4 v[24:27], v5, s[4:7], s50 offen sc1
    s_add_u32 s50, s50, 12288
    buffer_load_dwordx4 v[28:31], v5, s[4:7], s50 offen sc1
    s_add_u32 s50, s50, 12288
    buffer_load_dwordx4 v[32:35], v5, s[4:7], s50 offen sc1
    s_add_u32 s50, s50, 12288
    buffer_load_dwordx4 v[36:39], v5, s[4:7], s50 offen sc1
    s_add_u32 s50, s50, 12288
    buffer_load_dwordx4 v[40:43], v5, s[4:7], s50 offen sc1
    s_add_u32 s50, s50, 12288
    buffer_load_dwordx4 v[44:47], v5, s[4:7], s50 offen sc1
    s_waitcnt vmcnt(0)
    s_branch L_g_gg_71
L_gd_gg_72:
    v_cvt_pk_bf16_f32 v20, v16, v17
    v_cvt_pk_bf16_f32 v21, v18, v19
    v_and_b32 v4, 31, v0
    v_lshlrev_b32 v4, 3, v4
    v_add_u32 v4, 157696, v4
    ds_write_b64 v4, v[20:21]
L_only_70:
    s_waitcnt lgkmcnt(0)
    v_and_b32 v9, 0xffff0000, v56
    v_lshlrev_b32 v8, 16, v56
    v_and_b32 v11, 0xffff0000, v57
    v_lshlrev_b32 v10, 16, v57
    v_and_b32 v13, 0xffff0000, v58
    v_lshlrev_b32 v12, 16, v58
    v_and_b32 v15, 0xffff0000, v59
    v_lshlrev_b32 v14, 16, v59
    v_mov_b32 v5, s45
    v_lshlrev_b32 v4, 2, v0
    s_add_u32 s46, s83, 32768
    s_cmp_lg_u32 s40, 0
    s_waitcnt vmcnt(0)
    s_barrier
    s_cbranch_scc1 L_noflag_73
    s_mov_b32 exec_hi, 0
    buffer_store_dword v5, v4, s[4:7], s85 offen offset:1024
    buffer_store_dword v5, v4, s[4:7], s46 offen sc1
    s_mov_b64 exec, -1
L_noflag_73:
    v_lshrrev_b32 v120, 4, v0
    v_lshlrev_b32 v5, 4, v120
    v_and_b32 v120, 1, v0
    v_xor_b32 v120, 1, v120
    v_lshl_add_u32 v5, v120, 10, v5
    v_add_u32 v5, 147456, v5
    ds_read_b128 v[16:19], v5 offset:0
    ds_read_b128 v[20:23], v5 offset:64
    ds_read_b128 v[24:27], v5 offset:128
    ds_read_b128 v[28:31], v5 offset:192
    ds_read_b128 v[32:35], v5 offset:256
    ds_read_b128 v[36:39], v5 offset:320
    ds_read_b128 v[40:43], v5 offset:384
    ds_read_b128 v[44:47], v5 offset:448
    ds_read_b128 v[48:51], v5 offset:512
    ds_read_b128 v[52:55], v5 offset:576
    ds_read_b128 v[56:59], v5 offset:640
    ds_read_b128 v[60:63], v5 offset:704
    s_waitcnt lgkmcnt(11)
    v_mfma_f32_16x16x32_bf16 v[120:123], v[16:19], v[128:131], 0
    ds_read_b128 v[16:19], v5 offset:768
    s_waitcnt lgkmcnt(11)
    v_mfma_f32_16x16x32_bf16 v[124:127], v[20:23], v[132:135], 0
    ds_read_b128 v[20:23], v5 offset:832
    s_waitcnt lgkmcnt(11)
    v_mfma_f32_16x16x32_bf16 v[120:123], v[24:27], v[136:139], v[120:123]
    ds_read_b128 v[24:27], v5 offset:896
    s_waitcnt lgkmcnt(11)
    v_mfma_f32_16x16x32_bf16 v[124:127], v[28:31], v[140:143], v[124:127]
    ds_read_b128 v[28:31], v5 offset:960
    s_waitcnt lgkmcnt(11)
    v_mfma_f32_16x16x32_bf16 v[120:123], v[32:35], v[144:147], v[120:123]
    s_waitcnt lgkmcnt(10)
    v_mfma_f32_16x16x32_bf16 v[124:127], v[36:39], v[148:151], v[124:127]
    s_waitcnt lgkmcnt(9)
    v_mfma_f32_16x16x32_bf16 v[120:123], v[40:43], v[152:155], v[120:123]
    s_waitcnt lgkmcnt(8)
    v_mfma_f32_16x16x32_bf16 v[124:127], v[44:47], v[156:159], v[124:127]
    s_waitcnt lgkmcnt(7)
    v_mfma_f32_16x16x32_bf16 v[120:123], v[48:51], v[160:163], v[120:123]
    s_waitcnt lgkmcnt(6)
    v_mfma_f32_16x16x32_bf16 v[124:127], v[52:55], v[164:167], v[124:127]
    s_waitcnt lgkmcnt(5)
    v_mfma_f32_16x16x32_bf16 v[120:123], v[56:59], v[168:171], v[120:123]
    s_waitcnt lgkmcnt(4)
    v_mfma_f32_16x16x32_bf16 v[124:127], v[60:63], v[172:175], v[124:127]
    s_waitcnt lgkmcnt(3)
    v_mfma_f32_16x16x32_bf16 v[120:123], v[16:19], v[176:179], v[120:123]
    s_waitcnt lgkmcnt(2)
    v_mfma_f32_16x16x32_bf16 v[124:127], v[20:23], v[180:183], v[124:127]
    s_waitcnt lgkmcnt(1)
    v_mfma_f32_16x16x32_bf16 v[120:123], v[24:27], v[184:187], v[120:123]
    s_waitcnt lgkmcnt(0)
    v_mfma_f32_16x16x32_bf16 v[124:127], v[28:31], v[188:191], v[124:127]
    v_cmp_gt_u32 vcc, 16, v0
    s_nop 6
    v_add_f32 v124, v124, v120
    v_add_f32 v125, v125, v121
    v_cndmask_b32 v124, 0, v124, vcc
    v_cndmask_b32 v125, 0, v125, vcc
    v_cvt_pk_bf16_f32 v113, v124, v125
    v_and_b32 v127, 0xffff0000, v113
    v_lshlrev_b32 v126, 16, v113
    v_sub_f32 v124, v124, v126
    v_sub_f32 v125, v125, v127
    v_cvt_pk_bf16_f32 v112, v126, v124
    v_cvt_pk_bf16_f32 v114, v125, v127
    v_mov_b32 v115, 0
    s_and_b32 s51, s40, 1
    s_lshl_b32 s51, s51, 1
    s_lshr_b32 s47, s40, 2
    s_add_u32 s51, s51, s47
    s_lshl_b32 s47, s44, 2
    s_add_u32 s47, s47, s51
    s_lshl_b32 s48, s43, 5
    s_add_u32 s47, s47, s48
    s_lshl_b32 s47, s47, 1
    s_bfe_u32 s48, s40, 0x10001
    s_add_u32 s47, s47, s48
    s_lshl_b32 s47, s47, 10
    s_add_u32 s47, s47, 7340032
    s_lshl_b32 s51, s51, 10
    s_lshl_b32 s49, s48, 8
    s_add_u32 s51, s51, s49
    s_add_u32 s51, s51, 149504
    s_lshl_b32 s48, s48, 10
    v_add_u32 v3, s48, v2
    s_and_b32 s46, s40, 3
    s_lshl_b32 s46, s46, 12
    s_add_u32 s46, s46, 65536
    v_add_u32 v4, s46, v2
    v_lshrrev_b32 v120, 5, v0
    v_lshlrev_b32 v120, 4, v120
    s_add_u32 s46, s65, 157696
    v_add_u32 v120, s46, v120
    s_lshl_b32 s49, s44, 7
    v_lshrrev_b32 v124, 5, v0
    v_lshlrev_b32 v124, 4, v124
    s_add_u32 s46, s65, 148480
    s_add_u32 s46, s46, s49
    v_add_u32 v124, s46, v124
    ds_read_b128 v[120:123], v120
    ds_read_b128 v[124:127], v124
    s_waitcnt lgkmcnt(0)
    v_and_b32 v65, 0xffff0000, v120
    v_lshlrev_b32 v64, 16, v120
    v_and_b32 v67, 0xffff0000, v121
    v_lshlrev_b32 v66, 16, v121
    v_and_b32 v69, 0xffff0000, v122
    v_lshlrev_b32 v68, 16, v122
    v_and_b32 v71, 0xffff0000, v123
    v_lshlrev_b32 v70, 16, v123
    v_and_b32 v73, 0xffff0000, v124
    v_lshlrev_b32 v72, 16, v124
    v_and_b32 v75, 0xffff0000, v125
    v_lshlrev_b32 v74, 16, v125
    v_and_b32 v77, 0xffff0000, v126
    v_lshlrev_b32 v76, 16, v126
    v_and_b32 v79, 0xffff0000, v127
    v_lshlrev_b32 v78, 16, v127
    s_barrier
    ds_read_b128 v[32:35], v3 offset:0
    ds_read_b128 v[36:39], v3 offset:8192
    ds_read_b128 v[40:43], v3 offset:16384
    ds_read_b128 v[44:47], v3 offset:24576
    ds_read_b128 v[48:51], v3 offset:32768
    ds_read_b128 v[52:55], v3 offset:40960
    ds_read_b128 v[56:59], v3 offset:49152
    ds_read_b128 v[60:63], v3 offset:57344
    s_waitcnt lgkmcnt(7)
    v_mfma_f32_32x32x16_bf16 v[16:31], v[192:195], v[32:35], 0
    s_waitcnt lgkmcnt(6)
    v_mfma_f32_32x32x16_bf16 v[16:31], v[196:199], v[36:39], v[16:31]
    s_waitcnt lgkmcnt(5)
    v_mfma_f32_32x32x16_bf16 v[16:31], v[200:203], v[40:43], v[16:31]
    s_waitcnt lgkmcnt(4)
    v_mfma_f32_32x32x16_bf16 v[16:31], v[204:207], v[44:47], v[16:31]
    s_barrier
    ds_read_b128 v[32:35], v3 offset:2048
    s_waitcnt lgkmcnt(4)
    v_mfma_f32_32x32x16_bf16 v[16:31], v[208:211], v[48:51], v[16:31]
    ds_read_b128 v[48:51], v3 offset:34816
    ds_read_b128 v[36:39], v3 offset:10240
    s_waitcnt lgkmcnt(5)
    v_mfma_f32_32x32x16_bf16 v[16:31], v[212:215], v[52:55], v[16:31]
    ds_read_b128 v[52:55], v3 offset:43008
    ds_read_b128 v[40:43], v3 offset:18432
    s_waitcnt lgkmcnt(6)
    v_mfma_f32_32x32x16_bf16 v[16:31], v[216:219], v[56:59], v[16:31]
    ds_read_b128 v[56:59], v3 offset:51200
    ds_read_b128 v[44:47], v3 offset:26624
    s_waitcnt lgkmcnt(7)
    v_mfma_f32_32x32x16_bf16 v[16:31], v[220:223], v[60:63], v[16:31]
    ds_read_b128 v[60:63], v3 offset:59392
    s_waitcnt lgkmcnt(7)
    v_mfma_f32_32x32x16_bf16 v[16:31], v[224:227], v[32:35], v[16:31]
    s_waitcnt lgkmcnt(5)
    v_mfma_f32_32x32x16_bf16 v[16:31], v[228:231], v[36:39], v[16:31]
    s_waitcnt lgkmcnt(3)
    v_mfma_f32_32x32x16_bf16 v[16:31], v[232:235], v[40:43], v[16:31]
    s_waitcnt lgkmcnt(1)
    v_mfma_f32_32x32x16_bf16 v[16:31], v[236:239], v[44:47], v[16:31]
    s_barrier
    ds_read_b128 v[32:35], v3 offset:4096
    v_mfma_f32_32x32x16_bf16 v[16:31], v[240:243], v[48:51], v[16:31]
    ds_read_b128 v[48:51], v3 offset:36864
    ds_read_b128 v[36:39], v3 offset:12288
    v_mfma_f32_32x32x16_bf16 v[16:31], v[244:247], v[52:55], v[16:31]
    ds_read_b128 v[52:55], v3 offset:45056
    ds_read_b128 v[40:43], v3 offset:20480
    v_mfma_f32_32x32x16_bf16 v[16:31], v[248:251], v[56:59], v[16:31]
    ds_read_b128 v[56:59], v3 offset:53248
    ds_read_b128 v[44:47], v3 offset:28672
    s_waitcnt lgkmcnt(7)
    v_mfma_f32_32x32x16_bf16 v[16:31], v[252:255], v[60:63], v[16:31]
    ds_read_b128 v[60:63], v3 offset:61440
    s_waitcnt lgkmcnt(7)
    v_mfma_f32_32x32x16_bf16 v[16:31], v[80:83], v[32:35], v[16:31]
    s_waitcnt lgkmcnt(5)
    v_mfma_f32_32x32x16_bf16 v[16:31], v[84:87], v[36:39], v[16:31]
    s_waitcnt lgkmcnt(3)
    v_mfma_f32_32x32x16_bf16 v[16:31], v[88:91], v[40:43], v[16:31]
    s_waitcnt lgkmcnt(1)
    v_mfma_f32_32x32x16_bf16 v[16:31], v[92:95], v[44:47], v[16:31]
    s_barrier
    v_mfma_f32_32x32x16_bf16 v[16:31], v[96:99], v[48:51], v[16:31]
    v_mfma_f32_32x32x16_bf16 v[16:31], v[100:103], v[52:55], v[16:31]
    v_mfma_f32_32x32x16_bf16 v[16:31], v[104:107], v[56:59], v[16:31]
    s_waitcnt lgkmcnt(0)
    v_mfma_f32_32x32x16_bf16 v[16:31], v[108:111], v[60:63], v[16:31]
    s_add_u32 s46, s40, s2
    s_cmp_lg_u32 s46, 0
    s_cbranch_scc1 L_noep_74
    v_mov_b32 v5, s45
    s_mov_b64 exec, 1
    buffer_store_dword v5, off, s[4:7], 0 offset:0 sc1
    s_mov_b64 exec, -1
L_noep_74:
    s_add_u32 s50, s66, 0
    buffer_load_dwordx4 v[192:195], v2, s[4:7], s50 offen offset:0 sc1
    s_add_u32 s50, s66, 22528
    buffer_load_dwordx4 v[196:199], v2, s[4:7], s50 offen offset:0 sc1
    s_add_u32 s50, s66, 45056
    buffer_load_dwordx4 v[200:203], v2, s[4:7], s50 offen offset:0 sc1
    s_add_u32 s50, s66, 67584
    buffer_load_dwordx4 v[204:207], v2, s[4:7], s50 offen offset:0 sc1
    s_nop 1
    ds_write_b128 v4, v[24:27] offset:0
    ds_write_b128 v4, v[28:31] offset:1024
    s_add_u32 s50, s66, 0
    buffer_load_dwordx4 v[208:211], v2, s[4:7], s50 offen offset:1024 sc1
    s_add_u32 s50, s66, 22528
    buffer_load_dwordx4 v[212:215], v2, s[4:7], s50 offen offset:1024 sc1
    s_add_u32 s50, s66, 45056
    buffer_load_dwordx4 v[216:219], v2, s[4:7], s50 offen offset:1024 sc1
    s_add_u32 s50, s66, 67584
    buffer_load_dwordx4 v[220:223], v2, s[4:7], s50 offen offset:1024 sc1
    s_add_u32 s50, s66, 0
    buffer_load_dwordx4 v[224:227], v2, s[4:7], s50 offen offset:2048 sc1
    s_add_u32 s50, s66, 22528
    buffer_load_dwordx4 v[228:231], v2, s[4:7], s50 offen offset:2048 sc1
    s_add_u32 s50, s66, 45056
    buffer_load_dwordx4 v[232:235], v2, s[4:7], s50 offen offset:2048 sc1
    s_add_u32 s50, s66, 67584
    buffer_load_dwordx4 v[236:239], v2, s[4:7], s50 offen offset:2048 sc1
    s_waitcnt lgkmcnt(0)
    s_barrier
    ds_read_b128 v[104:107], v4 offset:2048
    ds_read_b128 v[108:111], v4 offset:3072
    s_waitcnt lgkmcnt(0)
    v_pk_add_f32 v[16:17], v[16:17], v[104:105]
    v_pk_add_f32 v[18:19], v[18:19], v[106:107]
    v_pk_add_f32 v[20:21], v[20:21], v[108:109]
    v_pk_add_f32 v[22:23], v[22:23], v[110:111]
    v_pk_fma_f32 v[8:9], v[16:17], v[64:65], v[8:9]
    v_pk_fma_f32 v[10:11], v[18:19], v[66:67], v[10:11]
    v_pk_fma_f32 v[12:13], v[20:21], v[68:69], v[12:13]
    v_pk_fma_f32 v[14:15], v[22:23], v[70:71], v[14:15]
    v_pk_mul_f32 v[72:73], v[72:73], v[8:9]
    v_pk_mul_f32 v[74:75], v[74:75], v[10:11]
    v_pk_mul_f32 v[76:77], v[76:77], v[12:13]
    v_pk_mul_f32 v[78:79], v[78:79], v[14:15]
    v_cvt_pk_bf16_f32 v72, v72, v73
    v_cvt_pk_bf16_f32 v73, v74, v75
    v_cvt_pk_bf16_f32 v74, v76, v77
    v_cvt_pk_bf16_f32 v75, v78, v79
    buffer_store_dwordx4 v[72:75], v2, s[4:7], s47 offen sc1
    v_pk_add_f32 v[64:65], v[8:9], v[10:11]
    v_pk_mul_f32 v[66:67], v[8:9], v[8:9]
    v_pk_add_f32 v[64:65], v[64:65], v[12:13]
    v_pk_fma_f32 v[66:67], v[10:11], v[10:11], v[66:67]
    v_pk_add_f32 v[64:65], v[64:65], v[14:15]
    v_pk_fma_f32 v[66:67], v[12:13], v[12:13], v[66:67]
    v_add_f32 v64, v64, v65
    v_pk_fma_f32 v[66:67], v[14:15], v[14:15], v[66:67]
    v_add_f32 v65, v66, v67
    v_lshrrev_b32 v66, 5, v0
    v_lshlrev_b32 v66, 8, v66
    v_lshl_add_u32 v66, v0, 3, v66
    v_add_u32 v66, s51, v66
    ds_write_b64 v66, v[64:65]
    s_waitcnt lgkmcnt(0)
    s_barrier
    s_cmp_lg_u32 s40, 4
    s_cbranch_scc1 L_nost_75
    v_lshlrev_b32 v66, 3, v0
    v_add_u32 v66, 149504, v66
    ds_read_b64 v[16:17], v66 offset:0
    ds_read_b64 v[18:19], v66 offset:512
    ds_read_b64 v[20:21], v66 offset:1024
    ds_read_b64 v[22:23], v66 offset:1536
    ds_read_b64 v[24:25], v66 offset:2048
    ds_read_b64 v[26:27], v66 offset:2560
    ds_read_b64 v[28:29], v66 offset:3072
    ds_read_b64 v[30:31], v66 offset:3584
    s_lshl_b32 s46, s83, 3
    s_add_u32 s46, s46, 262144
    s_waitcnt lgkmcnt(0)
    v_pk_add_f32 v[16:17], v[16:17], v[18:19]
    v_pk_add_f32 v[20:21], v[20:21], v[22:23]
    v_pk_add_f32 v[24:25], v[24:25], v[26:27]
    v_pk_add_f32 v[28:29], v[28:29], v[30:31]
    v_pk_add_f32 v[16:17], v[16:17], v[20:21]
    v_pk_add_f32 v[24:25], v[24:25], v[28:29]
    v_pk_add_f32 v[16:17], v[16:17], v[24:25]
    v_mov_b32 v104, v16
    v_mov_b32 v106, v17
    v_mov_b32 v105, s45
    v_mov_b32 v107, s45
    buffer_store_dwordx4 v[104:107], v2, s[4:7], s46 offen sc1
    s_waitcnt vmcnt(1)
    s_branch L_stj_76
L_nost_75:
    s_and_b32 s48, s40, 3
    s_lshl_b32 s48, s48, 13
    s_lshl_b32 s49, s43, 16
    s_add_u32 s49, s49, s48
    s_add_u32 s49, s49, 7340032
    v_mul_u32_u24 v16, 512, v0
    v_mul_u32_u24 v17, 5120, v0
    s_add_u32 s46, s84, 18644992
    s_add_u32 s51, s86, 896
    s_waitcnt vmcnt(0)
L_stj_76:
    s_barrier
    s_mov_b64 exec, 3
    s_mov_b32 s52, 400000
L_pp_x_77:
    s_and_b32 s50, s52, 7
    s_cmp_eq_u32 s50, 1
    s_cbranch_scc1 L_ppg_78
    buffer_load_dword v5, v17, s[4:7], s51 offen sc1
    s_branch L_ppc_79
L_ppg_78:
    buffer_load_dword v5, v16, s[4:7], s46 offen sc1
L_ppc_79:
    s_sub_u32 s52, s52, 1
    s_cmp_eq_u32 s52, 0
    s_waitcnt vmcnt(0)
    s_cbranch_scc1 L_ppd_80
    v_cmp_ne_u32 vcc, s45, v5
    s_nop 0
    s_cbranch_vccnz L_pp_x_77
L_ppd_80:
    s_mov_b64 exec, -1
    s_setprio 1
    s_add_u32 m0, s48, 0
    s_add_u32 s50, s49, 0
    buffer_load_dwordx4 v2, s[4:7], s50 offen offset:0 sc1 lds
    buffer_load_dwordx4 v2, s[4:7], s50 offen offset:1024 sc1 lds
    buffer_load_dwordx4 v2, s[4:7], s50 offen offset:2048 sc1 lds
    buffer_load_dwordx4 v2, s[4:7], s50 offen offset:3072 sc1 lds
    s_add_u32 m0, s48, 32768
    s_add_u32 s50, s49, 32768
    buffer_load_dwordx4 v2, s[4:7], s50 offen offset:0 sc1 lds
    buffer_load_dwordx4 v2, s[4:7], s50 offen offset:1024 sc1 lds
    buffer_load_dwordx4 v2, s[4:7], s50 offen offset:2048 sc1 lds
    buffer_load_dwordx4 v2, s[4:7], s50 offen offset:3072 sc1 lds
    s_setprio 0
    s_add_u32 m0, s48, 4096
    s_add_u32 s50, s49, 4096
    buffer_load_dwordx4 v2, s[4:7], s50 offen offset:0 sc1 lds
    buffer_load_dwordx4 v2, s[4:7], s50 offen offset:1024 sc1 lds
    buffer_load_dwordx4 v2, s[4:7], s50 offen offset:2048 sc1 lds
    buffer_load_dwordx4 v2, s[4:7], s50 offen offset:3072 sc1 lds
    s_add_u32 m0, s48, 36864
    s_add_u32 s50, s49, 36864
    buffer_load_dwordx4 v2, s[4:7], s50 offen offset:0 sc1 lds
    buffer_load_dwordx4 v2, s[4:7], s50 offen offset:1024 sc1 lds
    buffer_load_dwordx4 v2, s[4:7], s50 offen offset:2048 sc1 lds
    buffer_load_dwordx4 v2, s[4:7], s50 offen offset:3072 sc1 lds
    v_lshrrev_b32 v5, 4, v0
    v_lshrrev_b32 v3, 5, v0
    v_lshlrev_b32 v3, 11, v3
    v_and_b32 v5, 1, v5
    v_lshl_add_u32 v3, v5, 9, v3
    v_and_b32 v5, 15, v0
    v_lshl_add_u32 v3, v5, 4, v3
    v_lshlrev_b32 v111, 4, v5
    v_add_u32 v111, 157952, v111
    s_waitcnt lgkmcnt(0)
    s_mul_i32 s46, s43, 180224
    s_lshl_b32 s47, s58, 11
    s_add_u32 s46, s46, s47
    s_add_u32 s46, s46, 9437184
    s_add_u32 s47, s46, 8192
    s_cmp_eq_u32 s40, 3
    s_cbranch_scc1 L_p4idle_81
    s_waitcnt vmcnt(8)
    s_barrier
    s_setprio 1
    ds_read_b128 v[48:51], v3 offset:0
    ds_read_b128 v[52:55], v3 offset:256
    ds_read_b128 v[56:59], v3 offset:1024
    ds_read_b128 v[60:63], v3 offset:1280
    ds_read_b128 v[64:67], v3 offset:8192
    ds_read_b128 v[68:71], v3 offset:8448
    ds_read_b128 v[72:75], v3 offset:9216
    ds_read_b128 v[76:79], v3 offset:9472
    s_waitcnt lgkmcnt(6)
    v_mfma_f32_16x16x32_bf16 v[16:19], v[128:131], v[48:51], 0
    ds_read_b128 v[80:83], v3 offset:16384
    v_mfma_f32_16x16x32_bf16 v[20:23], v[128:131], v[52:55], 0
    ds_read_b128 v[84:87], v3 offset:16640
    s_add_u32 s50, s66, 0
    buffer_load_dwordx4 v[240:243], v2, s[4:7], s50 offen offset:3072 sc1
    s_waitcnt lgkmcnt(6)
    v_mfma_f32_16x16x32_bf16 v[24:27], v[128:131], v[56:59], 0
    ds_read_b128 v[88:91], v3 offset:17408
    v_mfma_f32_16x16x32_bf16 v[28:31], v[128:131], v[60:63], 0
    ds_read_b128 v[92:95], v3 offset:17664
    s_add_u32 s50, s66, 22528
    buffer_load_dwordx4 v[244:247], v2, s[4:7], s50 offen offset:3072 sc1
    s_waitcnt lgkmcnt(6)
    v_mfma_f32_16x16x32_bf16 v[16:19], v[136:139], v[64:67], v[16:19]
    ds_read_b128 v[48:51], v3 offset:24576
    v_mfma_f32_16x16x32_bf16 v[20:23], v[136:139], v[68:71], v[20:23]
    ds_read_b128 v[52:55], v3 offset:24832
    s_add_u32 s50, s66, 45056
    buffer_load_dwordx4 v[248:251], v2, s[4:7], s50 offen offset:3072 sc1
    s_waitcnt lgkmcnt(6)
    v_mfma_f32_16x16x32_bf16 v[24:27], v[136:139], v[72:75], v[24:27]
    ds_read_b128 v[56:59], v3 offset:25600
    v_mfma_f32_16x16x32_bf16 v[28:31], v[136:139], v[76:79], v[28:31]
    ds_read_b128 v[60:63], v3 offset:25856
    s_add_u32 s50, s66, 67584
    buffer_load_dwordx4 v[252:255], v2, s[4:7], s50 offen offset:3072 sc1
    s_waitcnt lgkmcnt(6)
    v_mfma_f32_16x16x32_bf16 v[16:19], v[144:147], v[80:83], v[16:19]
    ds_read_b128 v[64:67], v3 offset:32768
    v_mfma_f32_16x16x32_bf16 v[20:23], v[144:147], v[84:87], v[20:23]
    ds_read_b128 v[68:71], v3 offset:33024
    s_add_u32 s50, s66, 4096
    buffer_load_dwordx4 v[96:99], v2, s[4:7], s50 offen offset:0 sc1
    s_waitcnt lgkmcnt(6)
    v_mfma_f32_16x16x32_bf16 v[24:27], v[144:147], v[88:91], v[24:27]
    ds_read_b128 v[72:75], v3 offset:33792
    v_mfma_f32_16x16x32_bf16 v[28:31], v[144:147], v[92:95], v[28:31]
    ds_read_b128 v[76:79], v3 offset:34048
    s_add_u32 s50, s66, 26624
    buffer_load_dwordx4 v[100:103], v2, s[4:7], s50 offen offset:0 sc1
    s_waitcnt lgkmcnt(6)
    v_mfma_f32_16x16x32_bf16 v[16:19], v[152:155], v[48:51], v[16:19]
    ds_read_b128 v[80:83], v3 offset:40960
    v_mfma_f32_16x16x32_bf16 v[20:23], v[152:155], v[52:55], v[20:23]
    ds_read_b128 v[84:87], v3 offset:41216
    s_add_u32 s50, s66, 49152
    buffer_load_dwordx4 v[116:119], v2, s[4:7], s50 offen offset:0 sc1
    s_waitcnt lgkmcnt(6)
    v_mfma_f32_16x16x32_bf16 v[24:27], v[152:155], v[56:59], v[24:27]
    ds_read_b128 v[88:91], v3 offset:41984
    v_mfma_f32_16x16x32_bf16 v[28:31], v[152:155], v[60:63], v[28:31]
    ds_read_b128 v[92:95], v3 offset:42240
    s_add_u32 s50, s66, 71680
    buffer_load_dwordx4 v[120:123], v2, s[4:7], s50 offen offset:0 sc1
    s_waitcnt vmcnt(8)
    s_barrier
    s_waitcnt lgkmcnt(6)
    v_mfma_f32_16x16x32_bf16 v[16:19], v[160:163], v[64:67], v[16:19]
    ds_read_b128 v[48:51], v3 offset:49152
    v_mfma_f32_16x16x32_bf16 v[20:23], v[160:163], v[68:71], v[20:23]
    ds_read_b128 v[52:55], v3 offset:49408
    s_add_u32 s50, s66, 4096
    buffer_load_dwordx4 v[124:127], v2, s[4:7], s50 offen offset:1024 sc1
    s_waitcnt lgkmcnt(6)
    v_mfma_f32_16x16x32_bf16 v[24:27], v[160:163], v[72:75], v[24:27]
    ds_read_b128 v[56:59], v3 offset:50176
    v_mfma_f32_16x16x32_bf16 v[28:31], v[160:163], v[76:79], v[28:31]
    ds_read_b128 v[60:63], v3 offset:50432
    s_add_u32 s50, s66, 26624
    buffer_load_dwordx4 v[128:131], v2, s[4:7], s50 offen offset:1024 sc1
    s_waitcnt lgkmcnt(6)
    v_mfma_f32_16x16x32_bf16 v[16:19], v[168:171], v[80:83], v[16:19]
    ds_read_b128 v[64:67], v3 offset:57344
    v_mfma_f32_16x16x32_bf16 v[20:23], v[168:171], v[84:87], v[20:23]
    ds_read_b128 v[68:71], v3 offset:57600
    s_add_u32 s50, s66, 49152
    buffer_load_dwordx4 v[136:139], v2, s[4:7], s50 offen offset:1024 sc1
    s_waitcnt lgkmcnt(6)
    v_mfma_f32_16x16x32_bf16 v[24:27], v[168:171], v[88:91], v[24:27]
    ds_read_b128 v[72:75], v3 offset:58368
    v_mfma_f32_16x16x32_bf16 v[28:31], v[168:171], v[92:95], v[28:31]
    ds_read_b128 v[76:79], v3 offset:58624
    s_add_u32 s50, s66, 71680
    buffer_load_dwordx4 v[144:147], v2, s[4:7], s50 offen offset:1024 sc1
    s_waitcnt lgkmcnt(6)
    v_mfma_f32_16x16x32_bf16 v[16:19], v[176:179], v[48:51], v[16:19]
    ds_read_b128 v[80:83], v3 offset:4096
    v_mfma_f32_16x16x32_bf16 v[20:23], v[176:179], v[52:55], v[20:23]
    ds_read_b128 v[84:87], v3 offset:4352
    s_add_u32 s50, s66, 4096
    buffer_load_dwordx4 v[152:155], v2, s[4:7], s50 offen offset:2048 sc1
    s_waitcnt lgkmcnt(6)
    v_mfma_f32_16x16x32_bf16 v[24:27], v[176:179], v[56:59], v[24:27]
    ds_read_b128 v[88:91], v3 offset:5120
    v_mfma_f32_16x16x32_bf16 v[28:31], v[176:179], v[60:63], v[28:31]
    ds_read_b128 v[92:95], v3 offset:5376
    s_add_u32 s50, s66, 26624
    buffer_load_dwordx4 v[160:163], v2, s[4:7], s50 offen offset:2048 sc1
    s_waitcnt lgkmcnt(6)
    v_mfma_f32_16x16x32_bf16 v[16:19], v[184:187], v[64:67], v[16:19]
    ds_read_b128 v[48:51], v3 offset:12288
    v_mfma_f32_16x16x32_bf16 v[20:23], v[184:187], v[68:71], v[20:23]
    ds_read_b128 v[52:55], v3 offset:12544
    s_add_u32 s50, s66, 49152
    buffer_load_dwordx4 v[168:171], v2, s[4:7], s50 offen offset:2048 sc1
    s_waitcnt lgkmcnt(6)
    v_mfma_f32_16x16x32_bf16 v[24:27], v[184:187], v[72:75], v[24:27]
    ds_read_b128 v[56:59], v3 offset:13312
    v_mfma_f32_16x16x32_bf16 v[28:31], v[184:187], v[76:79], v[28:31]
    ds_read_b128 v[60:63], v3 offset:13568
    s_add_u32 s50, s66, 71680
    buffer_load_dwordx4 v[176:179], v2, s[4:7], s50 offen offset:2048 sc1
    s_waitcnt lgkmcnt(6)
    v_mfma_f32_16x16x32_bf16 v[16:19], v[132:135], v[80:83], v[16:19]
    ds_read_b128 v[64:67], v3 offset:20480
    v_mfma_f32_16x16x32_bf16 v[20:23], v[132:135], v[84:87], v[20:23]
    ds_read_b128 v[68:71], v3 offset:20736
    s_add_u32 s50, s66, 4096
    buffer_load_dwordx4 v[184:187], v2, s[4:7], s50 offen offset:3072 sc1
    s_waitcnt lgkmcnt(6)
    v_mfma_f32_16x16x32_bf16 v[24:27], v[132:135], v[88:91], v[24:27]
    ds_read_b128 v[72:75], v3 offset:21504
    v_mfma_f32_16x16x32_bf16 v[28:31], v[132:135], v[92:95], v[28:31]
    ds_read_b128 v[76:79], v3 offset:21760
    s_add_u32 s50, s66, 26624
    buffer_load_dwordx4 v[132:135], v2, s[4:7], s50 offen offset:3072 sc1
    s_waitcnt lgkmcnt(6)
    v_mfma_f32_16x16x32_bf16 v[16:19], v[140:143], v[48:51], v[16:19]
    ds_read_b128 v[80:83], v3 offset:28672
    v_mfma_f32_16x16x32_bf16 v[20:23], v[140:143], v[52:55], v[20:23]
    ds_read_b128 v[84:87], v3 offset:28928
    s_waitcnt lgkmcnt(6)
    v_mfma_f32_16x16x32_bf16 v[24:27], v[140:143], v[56:59], v[24:27]
    ds_read_b128 v[88:91], v3 offset:29696
    v_mfma_f32_16x16x32_bf16 v[28:31], v[140:143], v[60:63], v[28:31]
    ds_read_b128 v[92:95], v3 offset:29952
    s_add_u32 s50, s66, 49152
    buffer_load_dwordx4 v[140:143], v2, s[4:7], s50 offen offset:3072 sc1
    s_waitcnt lgkmcnt(6)
    v_mfma_f32_16x16x32_bf16 v[16:19], v[148:151], v[64:67], v[16:19]
    ds_read_b128 v[48:51], v3 offset:36864
    v_mfma_f32_16x16x32_bf16 v[20:23], v[148:151], v[68:71], v[20:23]
    ds_read_b128 v[52:55], v3 offset:37120
    s_waitcnt lgkmcnt(6)
    v_mfma_f32_16x16x32_bf16 v[24:27], v[148:151], v[72:75], v[24:27]
    ds_read_b128 v[56:59], v3 offset:37888
    v_mfma_f32_16x16x32_bf16 v[28:31], v[148:151], v[76:79], v[28:31]
    ds_read_b128 v[60:63], v3 offset:38144
    s_add_u32 s50, s66, 71680
    buffer_load_dwordx4 v[148:151], v2, s[4:7], s50 offen offset:3072 sc1
    s_barrier
    s_waitcnt lgkmcnt(6)
    v_mfma_f32_16x16x32_bf16 v[16:19], v[156:159], v[80:83], v[16:19]
    ds_read_b128 v[64:67], v3 offset:45056
    v_mfma_f32_16x16x32_bf16 v[20:23], v[156:159], v[84:87], v[20:23]
    ds_read_b128 v[68:71], v3 offset:45312
    s_waitcnt lgkmcnt(6)
    v_mfma_f32_16x16x32_bf16 v[24:27], v[156:159], v[88:91], v[24:27]
    ds_read_b128 v[72:75], v3 offset:46080
    v_mfma_f32_16x16x32_bf16 v[28:31], v[156:159], v[92:95], v[28:31]
    ds_read_b128 v[76:79], v3 offset:46336
    s_add_u32 s50, s66, 8192
    buffer_load_dwordx4 v[156:159], v2, s[4:7], s50 offen offset:0 sc1
    s_waitcnt lgkmcnt(6)
    v_mfma_f32_16x16x32_bf16 v[16:19], v[164:167], v[48:51], v[16:19]
    ds_read_b128 v[80:83], v3 offset:53248
    v_mfma_f32_16x16x32_bf16 v[20:23], v[164:167], v[52:55], v[20:23]
    ds_read_b128 v[84:87], v3 offset:53504
    s_waitcnt lgkmcnt(6)
    v_mfma_f32_16x16x32_bf16 v[24:27], v[164:167], v[56:59], v[24:27]
    ds_read_b128 v[88:91], v3 offset:54272
    v_mfma_f32_16x16x32_bf16 v[28:31], v[164:167], v[60:63], v[28:31]
    ds_read_b128 v[92:95], v3 offset:54528
    s_add_u32 s50, s66, 30720
    buffer_load_dwordx4 v[164:167], v2, s[4:7], s50 offen offset:0 sc1
    s_waitcnt lgkmcnt(6)
    v_mfma_f32_16x16x32_bf16 v[16:19], v[172:175], v[64:67], v[16:19]
    ds_read_b128 v[48:51], v3 offset:61440
    v_mfma_f32_16x16x32_bf16 v[20:23], v[172:175], v[68:71], v[20:23]
    ds_read_b128 v[52:55], v3 offset:61696
    s_waitcnt lgkmcnt(6)
    v_mfma_f32_16x16x32_bf16 v[24:27], v[172:175], v[72:75], v[24:27]
    ds_read_b128 v[56:59], v3 offset:62464
    v_mfma_f32_16x16x32_bf16 v[28:31], v[172:175], v[76:79], v[28:31]
    ds_read_b128 v[60:63], v3 offset:62720
    s_add_u32 s50, s66, 53248
    buffer_load_dwordx4 v[172:175], v2, s[4:7], s50 offen offset:0 sc1
    s_waitcnt lgkmcnt(6)
    v_mfma_f32_16x16x32_bf16 v[16:19], v[180:183], v[80:83], v[16:19]
    ds_read_b128 v[64:67], v111 offset:0
    v_mfma_f32_16x16x32_bf16 v[20:23], v[180:183], v[84:87], v[20:23]
    ds_read_b128 v[68:71], v111 offset:256
    s_waitcnt lgkmcnt(6)
    v_mfma_f32_16x16x32_bf16 v[24:27], v[180:183], v[88:91], v[24:27]
    ds_read_b128 v[72:75], v111 offset:512
    v_mfma_f32_16x16x32_bf16 v[28:31], v[180:183], v[92:95], v[28:31]
    ds_read_b128 v[76:79], v111 offset:768
    s_add_u32 s50, s66, 75776
    buffer_load_dwordx4 v[180:183], v2, s[4:7], s50 offen offset:0 sc1
    s_waitcnt lgkmcnt(6)
    v_mfma_f32_16x16x32_bf16 v[16:19], v[188:191], v[48:51], v[16:19]
    v_mfma_f32_16x16x32_bf16 v[20:23], v[188:191], v[52:55], v[20:23]
    s_waitcnt lgkmcnt(4)
    v_mfma_f32_16x16x32_bf16 v[24:27], v[188:191], v[56:59], v[24:27]
    v_mfma_f32_16x16x32_bf16 v[28:31], v[188:191], v[60:63], v[28:31]
    s_add_u32 s50, s66, 8192
    buffer_load_dwordx4 v[188:191], v2, s[4:7], s50 offen offset:1024 sc1
    s_waitcnt lgkmcnt(2)
    v_mfma_f32_16x16x32_bf16 v[16:19], v[112:115], v[64:67], v[16:19]
    v_mfma_f32_16x16x32_bf16 v[20:23], v[112:115], v[68:71], v[20:23]
    s_waitcnt lgkmcnt(0)
    v_mfma_f32_16x16x32_bf16 v[24:27], v[112:115], v[72:75], v[24:27]
    v_mfma_f32_16x16x32_bf16 v[28:31], v[112:115], v[76:79], v[28:31]
    s_nop 3
    v_cvt_pk_bf16_f32 v32, v16, v17
    v_cvt_pk_bf16_f32 v33, v18, v19
    v_cvt_pk_bf16_f32 v34, v20, v21
    v_cvt_pk_bf16_f32 v35, v22, v23
    v_pk_max_i16 v32, v32, 0
    v_pk_max_i16 v34, v34, 0
    v_pk_max_i16 v33, v33, 0
    v_pk_max_i16 v35, v35, 0
    v_permlane16_swap_b32 v32, v34
    s_nop 0
    v_permlane16_swap_b32 v33, v35
    buffer_store_dwordx4 v[32:35], v2, s[4:7], s46 offen offset:0 sc1
    v_cvt_pk_bf16_f32 v40, v24, v25
    v_cvt_pk_bf16_f32 v41, v26, v27
    v_cvt_pk_bf16_f32 v42, v28, v29
    v_cvt_pk_bf16_f32 v43, v30, v31
    v_pk_max_i16 v40, v40, 0
    v_pk_max_i16 v42, v42, 0
    v_pk_max_i16 v41, v41, 0
    v_pk_max_i16 v43, v43, 0
    v_permlane16_swap_b32 v40, v42
    s_nop 0
    v_permlane16_swap_b32 v41, v43
    buffer_store_dwordx4 v[40:43], v2, s[4:7], s46 offen offset:1024 sc1
    s_setprio 0
    s_add_u32 s50, s66, 30720
    buffer_load_dwordx4 v[80:83], v2, s[4:7], s50 offen offset:1024 sc1
    s_add_u32 s50, s66, 53248
    buffer_load_dwordx4 v[84:87], v2, s[4:7], s50 offen offset:1024 sc1
    s_add_u32 s50, s66, 75776
    buffer_load_dwordx4 v[88:91], v2, s[4:7], s50 offen offset:1024 sc1
    s_add_u32 s50, s66, 8192
    buffer_load_dwordx4 v[92:95], v2, s[4:7], s50 offen offset:2048 sc1
    s_add_u32 s50, s66, 30720
    buffer_load_dwordx4 v[104:107], v2, s[4:7], s50 offen offset:2048 sc1
    s_add_u32 s50, s66, 53248
    buffer_load_dwordx4 v[108:111], v2, s[4:7], s50 offen offset:2048 sc1
    s_add_u32 s50, s66, 75776
    buffer_load_dwordx4 v[112:115], v2, s[4:7], s50 offen offset:2048 sc1
    s_branch L_p4join_82
L_p4idle_81:
    s_lshl_b32 s48, s43, 13
    s_add_u32 s48, s48, 262144
    s_add_u32 s49, s48, 4096
    buffer_load_dwordx4 v[64:67], v2, s[4:7], s48 offen offset:0 sc1
    buffer_load_dwordx4 v[68:71], v2, s[4:7], s48 offen offset:1024 sc1
    buffer_load_dwordx4 v[72:75], v2, s[4:7], s48 offen offset:2048 sc1
    buffer_load_dwordx4 v[76:79], v2, s[4:7], s48 offen offset:3072 sc1
    buffer_load_dwordx4 v[80:83], v2, s[4:7], s49 offen offset:0 sc1
    buffer_load_dwordx4 v[84:87], v2, s[4:7], s49 offen offset:1024 sc1
    buffer_load_dwordx4 v[88:91], v2, s[4:7], s49 offen offset:2048 sc1
    buffer_load_dwordx4 v[92:95], v2, s[4:7], s49 offen offset:3072 sc1
    v_add_u32 v110, 157952, v2
    v_lshlrev_b32 v4, 2, v0
    v_add_u32 v4, 158976, v4
    s_setprio 2
    s_waitcnt vmcnt(16)
    s_barrier
    s_waitcnt vmcnt(8)
    s_barrier
    s_waitcnt vmcnt(0)
    v_and_b32 v5, v65, v67
    v_or_b32 v3, v65, v67
    v_bitop3_b32 v5, v5, v69, v71 bitop3:0x80
    v_or3_b32 v3, v3, v69, v71
    v_bitop3_b32 v5, v5, v73, v75 bitop3:0x80
    v_or3_b32 v3, v3, v73, v75
    v_bitop3_b32 v5, v5, v77, v79 bitop3:0x80
    v_or3_b32 v3, v3, v77, v79
    v_bitop3_b32 v5, v5, v81, v83 bitop3:0x80
    v_or3_b32 v3, v3, v81, v83
    v_bitop3_b32 v5, v5, v85, v87 bitop3:0x80
    v_or3_b32 v3, v3, v85, v87
    v_bitop3_b32 v5, v5, v89, v91 bitop3:0x80
    v_or3_b32 v3, v3, v89, v91
    v_bitop3_b32 v5, v5, v93, v95 bitop3:0x80
    v_or3_b32 v3, v3, v93, v95
    v_cmp_ne_u32 vcc, s45, v5
    v_cmp_ne_u32 s[98:99], v3, s45
    s_nop 0
    s_or_b64 vcc, vcc, s[98:99]
    s_cbranch_vccz L_stok_83
    s_mov_b32 s52, 400000
L_poll_st_84:
    buffer_load_dwordx4 v[64:67], v2, s[4:7], s48 offen offset:0 sc1
    buffer_load_dwordx4 v[68:71], v2, s[4:7], s48 offen offset:1024 sc1
    buffer_load_dwordx4 v[72:75], v2, s[4:7], s48 offen offset:2048 sc1
    buffer_load_dwordx4 v[76:79], v2, s[4:7], s48 offen offset:3072 sc1
    buffer_load_dwordx4 v[80:83], v2, s[4:7], s49 offen offset:0 sc1
    buffer_load_dwordx4 v[84:87], v2, s[4:7], s49 offen offset:1024 sc1
    buffer_load_dwordx4 v[88:91], v2, s[4:7], s49 offen offset:2048 sc1
    buffer_load_dwordx4 v[92:95], v2, s[4:7], s49 offen offset:3072 sc1
    s_sub_u32 s52, s52, 1
    s_cmp_eq_u32 s52, 0
    s_waitcnt vmcnt(0)
    s_cbranch_scc1 L_pdone_st_85
    v_cmp_ne_u32 vcc, s45, v65
    v_cmp_ne_u32 s[98:99], v67, s45
    s_nop 0
    s_or_b64 vcc, vcc, s[98:99]
    v_cmp_ne_u32 s[98:99], v69, s45
    s_nop 0
    s_or_b64 vcc, vcc, s[98:99]
    v_cmp_ne_u32 s[98:99], v71, s45
    s_nop 0
    s_or_b64 vcc, vcc, s[98:99]
    v_cmp_ne_u32 s[98:99], v73, s45
    s_nop 0
    s_or_b64 vcc, vcc, s[98:99]
    v_cmp_ne_u32 s[98:99], v75, s45
    s_nop 0
    s_or_b64 vcc, vcc, s[98:99]
    v_cmp_ne_u32 s[98:99], v77, s45
    s_nop 0
    s_or_b64 vcc, vcc, s[98:99]
    v_cmp_ne_u32 s[98:99], v79, s45
    s_nop 0
    s_or_b64 vcc, vcc, s[98:99]
    v_cmp_ne_u32 s[98:99], v81, s45
    s_nop 0
    s_or_b64 vcc, vcc, s[98:99]
    v_cmp_ne_u32 s[98:99], v83, s45
    s_nop 0
    s_or_b64 vcc, vcc, s[98:99]
    v_cmp_ne_u32 s[98:99], v85, s45
    s_nop 0
    s_or_b64 vcc, vcc, s[98:99]
    v_cmp_ne_u32 s[98:99], v87, s45
    s_nop 0
    s_or_b64 vcc, vcc, s[98:99]
    v_cmp_ne_u32 s[98:99], v89, s45
    s_nop 0
    s_or_b64 vcc, vcc, s[98:99]
    v_cmp_ne_u32 s[98:99], v91, s45
    s_nop 0
    s_or_b64 vcc, vcc, s[98:99]
    v_cmp_ne_u32 s[98:99], v93, s45
    s_nop 0
    s_or_b64 vcc, vcc, s[98:99]
    v_cmp_ne_u32 s[98:99], v95, s45
    s_nop 0
    s_or_b64 vcc, vcc, s[98:99]
    s_nop 0
    s_cbranch_vccnz L_poll_st_84
L_pdone_st_85:
L_stok_83:
    v_add_f32 v64, v64, v68
    v_add_f32 v66, v66, v70
    v_add_f32 v72, v72, v76
    v_add_f32 v74, v74, v78
    v_add_f32 v80, v80, v84
    v_add_f32 v82, v82, v86
    v_add_f32 v88, v88, v92
    v_add_f32 v90, v90, v94
    v_add_f32 v64, v64, v72
    v_add_f32 v66, v66, v74
    v_add_f32 v80, v80, v88
    v_add_f32 v82, v82, v90
    v_add_f32 v64, v64, v80
    v_add_f32 v66, v66, v82
    v_mov_b32 v65, v66
    v_mul_f32 v64, 0xbb000000, v64
    v_mul_f32 v65, 0x3b000000, v65
    v_fma_f32 v65, -v64, v64, v65
    v_max_f32 v65, 0, v65
    v_add_f32 v65, 0x3727c5ac, v65
    v_rsq_f32 v66, v65
    s_nop 0
    v_mul_f32 v65, v65, v66
    ds_write_b32 v4, v66
    v_cvt_pk_bf16_f32 v67, v64, v65
    v_and_b32 v69, 0xffff0000, v67
    v_lshlrev_b32 v68, 16, v67
    v_sub_f32 v64, v64, v68
    v_sub_f32 v65, v65, v69
    v_cvt_pk_bf16_f32 v72, v68, v68
    v_cvt_pk_bf16_f32 v73, v64, v69
    v_cvt_pk_bf16_f32 v74, v69, v65
    v_mov_b32 v75, 0
    ds_write_b128 v110, v[72:75]
    s_waitcnt lgkmcnt(0)
    s_setprio 0
    s_barrier
    s_add_u32 s50, s66, 0
    buffer_load_dwordx4 v[240:243], v2, s[4:7], s50 offen offset:3072 sc1
    s_waitcnt vmcnt(10)
    s_add_u32 s50, s66, 22528
    buffer_load_dwordx4 v[244:247], v2, s[4:7], s50 offen offset:3072 sc1
    s_waitcnt vmcnt(10)
    s_add_u32 s50, s66, 45056
    buffer_load_dwordx4 v[248:251], v2, s[4:7], s50 offen offset:3072 sc1
    s_waitcnt vmcnt(10)
    s_add_u32 s50, s66, 67584
    buffer_load_dwordx4 v[252:255], v2, s[4:7], s50 offen offset:3072 sc1
    s_waitcnt vmcnt(10)
    s_add_u32 s50, s66, 4096
    buffer_load_dwordx4 v[96:99], v2, s[4:7], s50 offen offset:0 sc1
    s_waitcnt vmcnt(10)
    s_add_u32 s50, s66, 26624
    buffer_load_dwordx4 v[100:103], v2, s[4:7], s50 offen offset:0 sc1
    s_waitcnt vmcnt(10)
    s_add_u32 s50, s66, 49152
    buffer_load_dwordx4 v[116:119], v2, s[4:7], s50 offen offset:0 sc1
    s_waitcnt vmcnt(10)
    s_add_u32 s50, s66, 71680
    buffer_load_dwordx4 v[120:123], v2, s[4:7], s50 offen offset:0 sc1
    s_waitcnt vmcnt(10)
    s_add_u32 s50, s66, 4096
    buffer_load_dwordx4 v[124:127], v2, s[4:7], s50 offen offset:1024 sc1
    s_waitcnt vmcnt(10)
    s_add_u32 s50, s66, 26624
    buffer_load_dwordx4 v[128:131], v2, s[4:7], s50 offen offset:1024 sc1
    s_waitcnt vmcnt(10)
    s_add_u32 s50, s66, 49152
    buffer_load_dwordx4 v[136:139], v2, s[4:7], s50 offen offset:1024 sc1
    s_waitcnt vmcnt(10)
    s_add_u32 s50, s66, 71680
    buffer_load_dwordx4 v[144:147], v2, s[4:7], s50 offen offset:1024 sc1
    s_waitcnt vmcnt(10)
    s_add_u32 s50, s66, 4096
    buffer_load_dwordx4 v[152:155], v2, s[4:7], s50 offen offset:2048 sc1
    s_waitcnt vmcnt(10)
    s_add_u32 s50, s66, 26624
    buffer_load_dwordx4 v[160:163], v2, s[4:7], s50 offen offset:2048 sc1
    s_waitcnt vmcnt(10)
    s_add_u32 s50, s66, 49152
    buffer_load_dwordx4 v[168:171], v2, s[4:7], s50 offen offset:2048 sc1
    s_waitcnt vmcnt(10)
    s_add_u32 s50, s66, 71680
    buffer_load_dwordx4 v[176:179], v2, s[4:7], s50 offen offset:2048 sc1
    s_waitcnt vmcnt(10)
    s_add_u32 s50, s66, 4096
    buffer_load_dwordx4 v[184:187], v2, s[4:7], s50 offen offset:3072 sc1
    s_waitcnt vmcnt(10)
    s_add_u32 s50, s66, 26624
    buffer_load_dwordx4 v[132:135], v2, s[4:7], s50 offen offset:3072 sc1
    s_waitcnt vmcnt(10)
    s_add_u32 s50, s66, 49152
    buffer_load_dwordx4 v[140:143], v2, s[4:7], s50 offen offset:3072 sc1
    s_waitcnt vmcnt(10)
    s_add_u32 s50, s66, 71680
    buffer_load_dwordx4 v[148:151], v2, s[4:7], s50 offen offset:3072 sc1
    s_waitcnt vmcnt(10)
    s_add_u32 s50, s66, 8192
    buffer_load_dwordx4 v[156:159], v2, s[4:7], s50 offen offset:0 sc1
    s_waitcnt vmcnt(10)
    s_add_u32 s50, s66, 30720
    buffer_load_dwordx4 v[164:167], v2, s[4:7], s50 offen offset:0 sc1
    s_waitcnt vmcnt(10)
    s_add_u32 s50, s66, 53248
    buffer_load_dwordx4 v[172:175], v2, s[4:7], s50 offen offset:0 sc1
    s_waitcnt vmcnt(10)
    s_add_u32 s50, s66, 75776
    buffer_load_dwordx4 v[180:183], v2, s[4:7], s50 offen offset:0 sc1
    s_waitcnt vmcnt(10)
    s_add_u32 s50, s66, 8192
    buffer_load_dwordx4 v[188:191], v2, s[4:7], s50 offen offset:1024 sc1
    s_waitcnt vmcnt(10)
    s_add_u32 s50, s66, 30720
    buffer_load_dwordx4 v[80:83], v2, s[4:7], s50 offen offset:1024 sc1
    s_waitcnt vmcnt(10)
    s_add_u32 s50, s66, 53248
    buffer_load_dwordx4 v[84:87], v2, s[4:7], s50 offen offset:1024 sc1
    s_waitcnt vmcnt(10)
    s_add_u32 s50, s66, 75776
    buffer_load_dwordx4 v[88:91], v2, s[4:7], s50 offen offset:1024 sc1
    s_waitcnt vmcnt(10)
    s_add_u32 s50, s66, 8192
    buffer_load_dwordx4 v[92:95], v2, s[4:7], s50 offen offset:2048 sc1
    s_waitcnt vmcnt(10)
    s_add_u32 s50, s66, 30720
    buffer_load_dwordx4 v[104:107], v2, s[4:7], s50 offen offset:2048 sc1
    s_waitcnt vmcnt(10)
    s_add_u32 s50, s66, 53248
    buffer_load_dwordx4 v[108:111], v2, s[4:7], s50 offen offset:2048 sc1
    s_waitcnt vmcnt(10)
    s_add_u32 s50, s66, 75776
    buffer_load_dwordx4 v[112:115], v2, s[4:7], s50 offen offset:2048 sc1
    s_waitcnt vmcnt(10)
L_p4join_82:
    v_mov_b32 v5, s45
    v_lshlrev_b32 v4, 2, v0
    s_add_u32 s46, s83, 65536
    s_cmp_lg_u32 s40, 0
    s_waitcnt vmcnt(7)
    s_barrier
    s_cbranch_scc1 L_noflag_86
    s_mov_b32 exec_hi, 0
    buffer_store_dword v5, v4, s[4:7], s85 offen offset:1152
    buffer_store_dword v5, v4, s[4:7], s46 offen sc1
    s_mov_b64 exec, -1
L_noflag_86:
    s_bfe_u32 s47, s40, 0x10001
    s_mul_i32 s48, s47, 3072
    v_add_u32 v3, s48, v2
    v_xor_b32 v4, 1024, v3
    v_add_u32 v5, 65536, v3
    v_add_u32 v7, 65536, v4
    s_lshl_b32 s47, s47, 7
    s_add_u32 s47, s47, 158976
    s_lshl_b32 s48, s40, 11
    s_add_u32 s48, s48, 131072
    s_lshl_b32 s49, s40, 12
    s_xor_b32 s51, s49, 8192
    s_add_u32 s49, s49, 65536
    s_add_u32 s51, s51, 65536
    s_barrier
    ds_read_b128 v[48:51], v3 offset:0
    ds_read_b128 v[52:55], v4 offset:0
    ds_read_b128 v[56:59], v3 offset:4096
    ds_read_b128 v[60:63], v4 offset:4096
    s_waitcnt lgkmcnt(2)
    v_mfma_f32_32x32x16_bf16 v[16:31], v[192:195], v[48:51], 0
    ds_read_b128 v[64:67], v3 offset:8192
    ds_read_b128 v[68:71], v4 offset:8192
    v_mfma_f32_32x32x16_bf16 v[32:47], v[192:195], v[52:55], 0
    s_waitcnt lgkmcnt(2)
    v_mfma_f32_32x32x16_bf16 v[16:31], v[196:199], v[56:59], v[16:31]
    ds_read_b128 v[72:75], v3 offset:12288
    ds_read_b128 v[76:79], v4 offset:12288
    v_mfma_f32_32x32x16_bf16 v[32:47], v[196:199], v[60:63], v[32:47]
    s_barrier
    s_waitcnt lgkmcnt(2)
    v_mfma_f32_32x32x16_bf16 v[16:31], v[200:203], v[64:67], v[16:31]
    ds_read_b128 v[48:51], v3 offset:16384
    ds_read_b128 v[52:55], v4 offset:16384
    v_mfma_f32_32x32x16_bf16 v[32:47], v[200:203], v[68:71], v[32:47]
    s_waitcnt lgkmcnt(2)
    v_mfma_f32_32x32x16_bf16 v[16:31], v[204:207], v[72:75], v[16:31]
    ds_read_b128 v[56:59], v3 offset:20480
    ds_read_b128 v[60:63], v4 offset:20480
    v_mfma_f32_32x32x16_bf16 v[32:47], v[204:207], v[76:79], v[32:47]
    s_waitcnt lgkmcnt(2)
    v_mfma_f32_32x32x16_bf16 v[16:31], v[208:211], v[48:51], v[16:31]
    ds_read_b128 v[64:67], v3 offset:24576
    ds_read_b128 v[68:71], v4 offset:24576
    v_mfma_f32_32x32x16_bf16 v[32:47], v[208:211], v[52:55], v[32:47]
    s_waitcnt lgkmcnt(2)
    v_mfma_f32_32x32x16_bf16 v[16:31], v[212:215], v[56:59], v[16:31]
    ds_read_b128 v[72:75], v3 offset:28672
    ds_read_b128 v[76:79], v4 offset:28672
    v_mfma_f32_32x32x16_bf16 v[32:47], v[212:215], v[60:63], v[32:47]
    s_barrier
    s_waitcnt lgkmcnt(2)
    v_mfma_f32_32x32x16_bf16 v[16:31], v[216:219], v[64:67], v[16:31]
    ds_read_b128 v[48:51], v3 offset:32768
    ds_read_b128 v[52:55], v4 offset:32768
    v_mfma_f32_32x32x16_bf16 v[32:47], v[216:219], v[68:71], v[32:47]
    s_waitcnt lgkmcnt(2)
    v_mfma_f32_32x32x16_bf16 v[16:31], v[220:223], v[72:75], v[16:31]
    ds_read_b128 v[56:59], v3 offset:36864
    ds_read_b128 v[60:63], v4 offset:36864
    v_mfma_f32_32x32x16_bf16 v[32:47], v[220:223], v[76:79], v[32:47]
    s_waitcnt lgkmcnt(2)
    v_mfma_f32_32x32x16_bf16 v[16:31], v[224:227], v[48:51], v[16:31]
    ds_read_b128 v[64:67], v3 offset:40960
    ds_read_b128 v[68:71], v4 offset:40960
    v_mfma_f32_32x32x16_bf16 v[32:47], v[224:227], v[52:55], v[32:47]
    s_waitcnt lgkmcnt(2)
    v_mfma_f32_32x32x16_bf16 v[16:31], v[228:231], v[56:59], v[16:31]
    ds_read_b128 v[72:75], v3 offset:45056
    ds_read_b128 v[76:79], v4 offset:45056
    v_mfma_f32_32x32x16_bf16 v[32:47], v[228:231], v[60:63], v[32:47]
    s_barrier
    s_waitcnt lgkmcnt(2)
    v_mfma_f32_32x32x16_bf16 v[16:31], v[232:235], v[64:67], v[16:31]
    ds_read_b128 v[48:51], v3 offset:49152
    ds_read_b128 v[52:55], v4 offset:49152
    v_mfma_f32_32x32x16_bf16 v[32:47], v[232:235], v[68:71], v[32:47]
    s_waitcnt lgkmcnt(2)
    v_mfma_f32_32x32x16_bf16 v[16:31], v[236:239], v[72:75], v[16:31]
    ds_read_b128 v[56:59], v3 offset:53248
    ds_read_b128 v[60:63], v4 offset:53248
    v_mfma_f32_32x32x16_bf16 v[32:47], v[236:239], v[76:79], v[32:47]
    s_waitcnt lgkmcnt(2)
    v_mfma_f32_32x32x16_bf16 v[16:31], v[240:243], v[48:51], v[16:31]
    ds_read_b128 v[64:67], v3 offset:57344
    ds_read_b128 v[68:71], v4 offset:57344
    v_mfma_f32_32x32x16_bf16 v[32:47], v[240:243], v[52:55], v[32:47]
    s_waitcnt lgkmcnt(2)
    v_mfma_f32_32x32x16_bf16 v[16:31], v[244:247], v[56:59], v[16:31]
    ds_read_b128 v[72:75], v3 offset:61440
    ds_read_b128 v[76:79], v4 offset:61440
    v_mfma_f32_32x32x16_bf16 v[32:47], v[244:247], v[60:63], v[32:47]
    s_barrier
    s_waitcnt lgkmcnt(2)
    v_mfma_f32_32x32x16_bf16 v[16:31], v[248:251], v[64:67], v[16:31]
    ds_read_b128 v[48:51], v5 offset:0
    ds_read_b128 v[52:55], v7 offset:0
    v_mfma_f32_32x32x16_bf16 v[32:47], v[248:251], v[68:71], v[32:47]
    s_waitcnt lgkmcnt(2)
    v_mfma_f32_32x32x16_bf16 v[16:31], v[252:255], v[72:75], v[16:31]
    ds_read_b128 v[56:59], v5 offset:4096
    ds_read_b128 v[60:63], v7 offset:4096
    v_mfma_f32_32x32x16_bf16 v[32:47], v[252:255], v[76:79], v[32:47]
    s_waitcnt lgkmcnt(2)
    v_mfma_f32_32x32x16_bf16 v[16:31], v[96:99], v[48:51], v[16:31]
    ds_read_b128 v[64:67], v5 offset:8192
    ds_read_b128 v[68:71], v7 offset:8192
    v_mfma_f32_32x32x16_bf16 v[32:47], v[96:99], v[52:55], v[32:47]
    v_lshrrev_b32 v225, 5, v0
    v_lshlrev_b32 v225, 4, v225
    s_add_u32 s46, s65, 157824
    s_waitcnt lgkmcnt(2)
    v_mfma_f32_32x32x16_bf16 v[16:31], v[100:103], v[56:59], v[16:31]
    ds_read_b128 v[72:75], v5 offset:12288
    ds_read_b128 v[76:79], v7 offset:12288
    v_mfma_f32_32x32x16_bf16 v[32:47], v[100:103], v[60:63], v[32:47]
    v_add_u32 v225, s46, v225
    v_and_b32 v226, 31, v0
    v_lshlrev_b32 v226, 2, v226
    s_barrier
    s_waitcnt lgkmcnt(2)
    v_mfma_f32_32x32x16_bf16 v[16:31], v[116:119], v[64:67], v[16:31]
    ds_read_b128 v[48:51], v5 offset:16384
    ds_read_b128 v[52:55], v7 offset:16384
    v_mfma_f32_32x32x16_bf16 v[32:47], v[116:119], v[68:71], v[32:47]
    v_add_u32 v226, s47, v226
    v_add_u32 v227, s48, v2
    ds_read_b128 v[192:195], v225
    s_waitcnt lgkmcnt(3)
    v_mfma_f32_32x32x16_bf16 v[16:31], v[120:123], v[72:75], v[16:31]
    ds_read_b128 v[56:59], v5 offset:20480
    ds_read_b128 v[60:63], v7 offset:20480
    v_mfma_f32_32x32x16_bf16 v[32:47], v[120:123], v[76:79], v[32:47]
    ds_read_b128 v[196:199], v225 offset:32
    ds_read_b32 v224, v226
    ds_read_b128 v[216:219], v227
    s_waitcnt lgkmcnt(6)
    v_mfma_f32_32x32x16_bf16 v[16:31], v[124:127], v[48:51], v[16:31]
    ds_read_b128 v[64:67], v5 offset:24576
    ds_read_b128 v[68:71], v7 offset:24576
    v_mfma_f32_32x32x16_bf16 v[32:47], v[124:127], v[52:55], v[32:47]
    ds_read_b128 v[220:223], v227 offset:1024
    v_add_u32 v228, s51, v2
    v_add_u32 v229, s49, v2
    s_waitcnt lgkmcnt(6)
    v_mfma_f32_32x32x16_bf16 v[16:31], v[128:131], v[56:59], v[16:31]
    ds_read_b128 v[72:75], v5 offset:28672
    ds_read_b128 v[76:79], v7 offset:28672
    v_mfma_f32_32x32x16_bf16 v[32:47], v[128:131], v[60:63], v[32:47]
    v_and_b32 v230, 0x3fff, v6
    v_bfe_u32 v231, v0, 4, 1
    v_lshl_add_u32 v230, v231, 5, v230
    s_barrier
    s_waitcnt lgkmcnt(3)
    v_mfma_f32_32x32x16_bf16 v[16:31], v[136:139], v[64:67], v[16:31]
    ds_read_b128 v[48:51], v5 offset:32768
    ds_read_b128 v[52:55], v7 offset:32768
    v_mfma_f32_32x32x16_bf16 v[32:47], v[136:139], v[68:71], v[32:47]
    s_waitcnt lgkmcnt(2)
    v_mfma_f32_32x32x16_bf16 v[16:31], v[144:147], v[72:75], v[16:31]
    ds_read_b128 v[56:59], v5 offset:36864
    ds_read_b128 v[60:63], v7 offset:36864
    v_mfma_f32_32x32x16_bf16 v[32:47], v[144:147], v[76:79], v[32:47]
    s_waitcnt lgkmcnt(2)
    v_mfma_f32_32x32x16_bf16 v[16:31], v[152:155], v[48:51], v[16:31]
    ds_read_b128 v[64:67], v5 offset:40960
    ds_read_b128 v[68:71], v7 offset:40960
    v_mfma_f32_32x32x16_bf16 v[32:47], v[152:155], v[52:55], v[32:47]
    v_and_b32 v201, 0xffff0000, v192
    v_lshlrev_b32 v200, 16, v192
    s_waitcnt lgkmcnt(2)
    v_mfma_f32_32x32x16_bf16 v[16:31], v[160:163], v[56:59], v[16:31]
    ds_read_b128 v[72:75], v5 offset:45056
    ds_read_b128 v[76:79], v7 offset:45056
    v_mfma_f32_32x32x16_bf16 v[32:47], v[160:163], v[60:63], v[32:47]
    v_and_b32 v203, 0xffff0000, v193
    v_lshlrev_b32 v202, 16, v193
    v_and_b32 v205, 0xffff0000, v194
    s_barrier
    s_waitcnt lgkmcnt(2)
    v_mfma_f32_32x32x16_bf16 v[16:31], v[168:171], v[64:67], v[16:31]
    ds_read_b128 v[48:51], v5 offset:49152
    ds_read_b128 v[52:55], v7 offset:49152
    v_mfma_f32_32x32x16_bf16 v[32:47], v[168:171], v[68:71], v[32:47]
    v_lshlrev_b32 v204, 16, v194
    v_and_b32 v207, 0xffff0000, v195
    v_lshlrev_b32 v206, 16, v195
    s_waitcnt lgkmcnt(2)
    v_mfma_f32_32x32x16_bf16 v[16:31], v[176:179], v[72:75], v[16:31]
    ds_read_b128 v[56:59], v5 offset:53248
    ds_read_b128 v[60:63], v7 offset:53248
    v_mfma_f32_32x32x16_bf16 v[32:47], v[176:179], v[76:79], v[32:47]
    v_and_b32 v209, 0xffff0000, v196
    v_lshlrev_b32 v208, 16, v196
    v_and_b32 v211, 0xffff0000, v197
    s_waitcnt lgkmcnt(2)
    v_mfma_f32_32x32x16_bf16 v[16:31], v[184:187], v[48:51], v[16:31]
    ds_read_b128 v[64:67], v5 offset:57344
    ds_read_b128 v[68:71], v7 offset:57344
    v_mfma_f32_32x32x16_bf16 v[32:47], v[184:187], v[52:55], v[32:47]
    v_lshlrev_b32 v210, 16, v197
    v_and_b32 v213, 0xffff0000, v198
    v_lshlrev_b32 v212, 16, v198
    s_waitcnt lgkmcnt(2)
    v_mfma_f32_32x32x16_bf16 v[16:31], v[132:135], v[56:59], v[16:31]
    ds_read_b128 v[72:75], v5 offset:61440
    ds_read_b128 v[76:79], v7 offset:61440
    v_mfma_f32_32x32x16_bf16 v[32:47], v[132:135], v[60:63], v[32:47]
    v_and_b32 v215, 0xffff0000, v199
    v_lshlrev_b32 v214, 16, v199
    v_mul_f32 v200, v200, v224
    s_barrier
    s_waitcnt lgkmcnt(2)
    v_mfma_f32_32x32x16_bf16 v[16:31], v[140:143], v[64:67], v[16:31]
    ds_read_b128 v[48:51], v3 offset:0
    ds_read_b128 v[52:55], v4 offset:0
    v_mfma_f32_32x32x16_bf16 v[32:47], v[140:143], v[68:71], v[32:47]
    v_mul_f32 v201, v201, v224
    v_mul_f32 v202, v202, v224
    v_mul_f32 v203, v203, v224
    s_waitcnt lgkmcnt(2)
    v_mfma_f32_32x32x16_bf16 v[16:31], v[148:151], v[72:75], v[16:31]
    ds_read_b128 v[56:59], v3 offset:4096
    ds_read_b128 v[60:63], v4 offset:4096
    v_mfma_f32_32x32x16_bf16 v[32:47], v[148:151], v[76:79], v[32:47]
    v_mul_f32 v204, v204, v224
    v_mul_f32 v205, v205, v224
    v_mul_f32 v206, v206, v224
    s_waitcnt lgkmcnt(2)
    v_mfma_f32_32x32x16_bf16 v[16:31], v[156:159], v[48:51], v[16:31]
    ds_read_b128 v[64:67], v3 offset:8192
    ds_read_b128 v[68:71], v4 offset:8192
    v_mfma_f32_32x32x16_bf16 v[32:47], v[156:159], v[52:55], v[32:47]
    v_mul_f32 v207, v207, v224
    v_mul_f32 v208, v208, v224
    v_mul_f32 v209, v209, v224
    s_waitcnt lgkmcnt(2)
    v_mfma_f32_32x32x16_bf16 v[16:31], v[164:167], v[56:59], v[16:31]
    ds_read_b128 v[72:75], v3 offset:12288
    ds_read_b128 v[76:79], v4 offset:12288
    v_mfma_f32_32x32x16_bf16 v[32:47], v[164:167], v[60:63], v[32:47]
    v_mul_f32 v210, v210, v224
    v_mul_f32 v211, v211, v224
    v_mul_f32 v212, v212, v224
    s_barrier
    s_waitcnt lgkmcnt(2)
    v_mfma_f32_32x32x16_bf16 v[16:31], v[172:175], v[64:67], v[16:31]
    ds_read_b128 v[48:51], v3 offset:16384
    ds_read_b128 v[52:55], v4 offset:16384
    v_mfma_f32_32x32x16_bf16 v[32:47], v[172:175], v[68:71], v[32:47]
    v_mul_f32 v213, v213, v224
    v_mul_f32 v214, v214, v224
    v_mul_f32 v215, v215, v224
    s_waitcnt lgkmcnt(2)
    v_mfma_f32_32x32x16_bf16 v[16:31], v[180:183], v[72:75], v[16:31]
    ds_read_b128 v[56:59], v3 offset:20480
    ds_read_b128 v[60:63], v4 offset:20480
    v_mfma_f32_32x32x16_bf16 v[32:47], v[180:183], v[76:79], v[32:47]
    s_waitcnt lgkmcnt(2)
    v_mfma_f32_32x32x16_bf16 v[16:31], v[188:191], v[48:51], v[16:31]
    ds_read_b128 v[64:67], v3 offset:24576
    ds_read_b128 v[68:71], v4 offset:24576
    v_mfma_f32_32x32x16_bf16 v[32:47], v[188:191], v[52:55], v[32:47]
    s_waitcnt lgkmcnt(2)
    s_waitcnt vmcnt(0)
    v_mfma_f32_32x32x16_bf16 v[16:31], v[80:83], v[56:59], v[16:31]
    ds_read_b128 v[72:75], v3 offset:28672
    ds_read_b128 v[76:79], v4 offset:28672
    v_mfma_f32_32x32x16_bf16 v[32:47], v[80:83], v[60:63], v[32:47]
    s_barrier
    s_waitcnt lgkmcnt(2)
    v_mfma_f32_32x32x16_bf16 v[16:31], v[84:87], v[64:67], v[16:31]
    ds_read_b128 v[48:51], v3 offset:32768
    ds_read_b128 v[52:55], v4 offset:32768
    v_mfma_f32_32x32x16_bf16 v[32:47], v[84:87], v[68:71], v[32:47]
    s_waitcnt lgkmcnt(2)
    v_mfma_f32_32x32x16_bf16 v[16:31], v[88:91], v[72:75], v[16:31]
    ds_read_b128 v[56:59], v3 offset:36864
    ds_read_b128 v[60:63], v4 offset:36864
    v_mfma_f32_32x32x16_bf16 v[32:47], v[88:91], v[76:79], v[32:47]
    s_waitcnt lgkmcnt(2)
    v_mfma_f32_32x32x16_bf16 v[16:31], v[92:95], v[48:51], v[16:31]
    ds_read_b128 v[64:67], v3 offset:40960
    ds_read_b128 v[68:71], v4 offset:40960
    v_mfma_f32_32x32x16_bf16 v[32:47], v[92:95], v[52:55], v[32:47]
    s_waitcnt lgkmcnt(2)
    v_mfma_f32_32x32x16_bf16 v[16:31], v[104:107], v[56:59], v[16:31]
    ds_read_b128 v[72:75], v3 offset:45056
    ds_read_b128 v[76:79], v4 offset:45056
    v_mfma_f32_32x32x16_bf16 v[32:47], v[104:107], v[60:63], v[32:47]
    s_waitcnt lgkmcnt(2)
    v_mfma_f32_32x32x16_bf16 v[16:31], v[108:111], v[64:67], v[16:31]
    v_mfma_f32_32x32x16_bf16 v[32:47], v[108:111], v[68:71], v[32:47]
    s_waitcnt lgkmcnt(0)
    v_mfma_f32_32x32x16_bf16 v[16:31], v[112:115], v[72:75], v[16:31]
    v_mfma_f32_32x32x16_bf16 v[32:47], v[112:115], v[76:79], v[32:47]
    s_nop 11
    ds_write_b128 v228, v[32:35] offset:0
    ds_write_b128 v228, v[36:39] offset:1024
    ds_write_b128 v228, v[40:43] offset:2048
    ds_write_b128 v228, v[44:47] offset:3072
    s_waitcnt lgkmcnt(0)
    s_barrier
    ds_read_b128 v[48:51], v229 offset:0
    ds_read_b128 v[52:55], v229 offset:1024
    ds_read_b128 v[56:59], v229 offset:2048
    ds_read_b128 v[60:63], v229 offset:3072
    s_waitcnt lgkmcnt(2)
    v_pk_add_f32 v[16:17], v[16:17], v[48:49]
    v_pk_add_f32 v[18:19], v[18:19], v[50:51]
    v_pk_add_f32 v[20:21], v[20:21], v[52:53]
    v_pk_add_f32 v[22:23], v[22:23], v[54:55]
    v_pk_fma_f32 v[8:9], v[16:17], v[200:201], v[8:9]
    v_pk_fma_f32 v[10:11], v[18:19], v[202:203], v[10:11]
    v_pk_fma_f32 v[12:13], v[20:21], v[204:205], v[12:13]
    v_pk_fma_f32 v[14:15], v[22:23], v[206:207], v[14:15]
    v_cvt_pk_bf16_f32 v8, v8, v9
    v_cvt_pk_bf16_f32 v9, v10, v11
    v_cvt_pk_bf16_f32 v10, v12, v13
    v_cvt_pk_bf16_f32 v11, v14, v15
    buffer_store_dwordx4 v[8:11], v6, s[28:31], s64 offen offset:0
    s_waitcnt lgkmcnt(0)
    v_pk_add_f32 v[24:25], v[24:25], v[56:57]
    v_pk_add_f32 v[26:27], v[26:27], v[58:59]
    v_pk_add_f32 v[28:29], v[28:29], v[60:61]
    v_pk_add_f32 v[30:31], v[30:31], v[62:63]
    v_pk_fma_f32 v[216:217], v[24:25], v[208:209], v[216:217]
    v_pk_fma_f32 v[218:219], v[26:27], v[210:211], v[218:219]
    v_pk_fma_f32 v[220:221], v[28:29], v[212:213], v[220:221]
    v_pk_fma_f32 v[222:223], v[30:31], v[214:215], v[222:223]
    v_cvt_pk_bf16_f32 v216, v216, v217
    v_cvt_pk_bf16_f32 v217, v218, v219
    v_cvt_pk_bf16_f32 v218, v220, v221
    v_cvt_pk_bf16_f32 v219, v222, v223
    buffer_store_dwordx4 v[216:219], v6, s[28:31], s64 offen offset:32
    s_endpgm
L_H:
    s_load_dwordx2 s[32:33], s[0:1], 16
    s_load_dwordx4 s[36:39], s[0:1], 32
    v_and_b32 v0, 63, v0
    s_lshr_b32 s46, s42, 3
    s_lshl_b32 s43, s41, 2
    s_add_u32 s43, s43, s46
    s_and_b32 s44, s42, 7
    s_add_u32 s53, s44, s41
    s_mov_b32 s10, 2097152
    s_mov_b32 s11, 0x20000
    s_sub_u32 s51, s40, 4
    s_lshl_b32 s47, s43, 16
    s_add_u32 s48, s53, s51
    s_and_b32 s48, s48, 7
    s_lshl_b32 s48, s48, 7
    v_lshrrev_b32 v4, 3, v0
    v_and_b32 v5, 7, v0
    v_lshlrev_b32 v48, 10, v4
    v_lshl_add_u32 v48, v5, 4, v48
    v_add_u32 v48, s48, v48
    v_xor_b32 v49, 512, v48
    v_add_u32 v56, 8192, v48
    v_add_u32 v57, 8192, v49
    s_lshl_b32 s81, s51, 1
    s_setprio 3
    s_add_u32 s46, s51, 0
    s_and_b32 s46, s46, 3
    s_lshl_b32 s46, s46, 14
    s_add_u32 s64, s46, s47
    s_add_u32 s46, s51, 1
    s_and_b32 s46, s46, 3
    s_lshl_b32 s46, s46, 14
    s_add_u32 s65, s46, s47
    s_add_u32 s46, s51, 2
    s_and_b32 s46, s46, 3
    s_lshl_b32 s46, s46, 14
    s_add_u32 s66, s46, s47
    s_add_u32 s46, s51, 3
    s_and_b32 s46, s46, 3
    s_lshl_b32 s46, s46, 14
    s_add_u32 s67, s46, s47
    s_waitcnt lgkmcnt(0)
    s_load_dword s45, s[4:5], 0
    buffer_load_dwordx4 v[64:67], v48, s[8:11], s64 offen
    buffer_load_dwordx4 v[72:75], v56, s[8:11], s64 offen
    buffer_load_dwordx4 v[80:83], v48, s[8:11], s65 offen
    buffer_load_dwordx4 v[88:91], v56, s[8:11], s65 offen
    s_barrier
    buffer_load_dwordx4 v[96:99], v48, s[8:11], s66 offen
    buffer_load_dwordx4 v[104:107], v56, s[8:11], s66 offen
    buffer_load_dwordx4 v[112:115], v48, s[8:11], s67 offen
    buffer_load_dwordx4 v[120:123], v56, s[8:11], s67 offen
    buffer_load_dwordx4 v[68:71], v49, s[8:11], s64 offen
    buffer_load_dwordx4 v[76:79], v57, s[8:11], s64 offen
    buffer_load_dwordx4 v[84:87], v49, s[8:11], s65 offen
    buffer_load_dwordx4 v[92:95], v57, s[8:11], s65 offen
    buffer_load_dwordx4 v[100:103], v49, s[8:11], s66 offen
    buffer_load_dwordx4 v[108:111], v57, s[8:11], s66 offen
    buffer_load_dwordx4 v[116:119], v49, s[8:11], s67 offen
    buffer_load_dwordx4 v[124:127], v57, s[8:11], s67 offen
    s_setprio 0
    s_mov_b32 s6, 18677760
    s_mov_b32 s7, 0x20000
    v_lshlrev_b32 v2, 4, v0
    s_mov_b32 s54, 0xffff
    s_mov_b32 s55, 0xffff
    v_lshrrev_b32 v6, 4, v0
    v_xor_b32 v6, v6, v5
    v_lshlrev_b32 v6, 4, v6
    v_lshl_add_u32 v6, v4, 7, v6
    s_lshl_b32 s49, s51, 13
    v_add_u32 v50, s49, v6
    v_xor_b32 v51, 64, v50
    s_lshl_b32 s48, s48, 1
    v_lshlrev_b32 v52, 5, v5
    v_add_u32 v52, s48, v52
    v_xor_b32 v53, 1024, v52
    s_lshl_b32 s49, s51, 3
    v_lshlrev_b32 v54, 5, v4
    v_and_b32 v6, 4, v5
    v_add3_u32 v54, v54, v6, s49
    s_lshl_b32 s49, s51, 9
    v_lshl_add_u32 v55, v4, 3, s49
    s_lshl_b32 s72, s51, 5
    s_add_u32 s72, s72, s43
    s_mov_b32 s27, 0x20000
    s_cmp_ge_u32 s72, 60
    s_cbranch_scc1 L_rl_w1_87
    s_cmp_ge_u32 s72, 16
    s_cselect_b32 s24, s38, s32
    s_cselect_b32 s25, s39, s33
    s_cselect_b32 s26, 1409024, 0
    s_cselect_b32 s46, 16, 0
    s_cselect_b32 s78, 88, 32
    s_cselect_b32 s74, 16121856, 0
    s_max_u32 s26, s26, 524288
    s_add_u32 s74, s74, 524288
    s_lshl_b32 s78, s78, 10
    s_sub_u32 s46, s72, s46
    s_mov_b32 s73, 8192
    s_lshl_b32 s79, s46, 15
    s_lshl_b32 s48, s44, 7
    s_add_u32 s79, s79, s48
    s_mul_i32 s48, s44, s78
    s_lshl_b32 s48, s48, 1
    s_add_u32 s74, s74, s48
    s_lshl_b32 s48, s46, 11
    s_add_u32 s74, s74, s48
    s_mov_b32 s77, 1024
    s_mov_b32 s75, 2048
    s_mov_b32 s76, 256
    s_mov_b32 s80, 4
    v_lshrrev_b32 v4, 5, v0
    v_bfe_u32 v5, v0, 2, 2
    v_lshl_add_u32 v4, v4, 2, v5
    v_mul_u32_u24 v8, 1024, v4
    v_bfe_u32 v4, v0, 4, 1
    v_lshl_add_u32 v8, v4, 6, v8
    v_and_b32 v4, 3, v0
    v_lshl_add_u32 v8, v4, 4, v8
    v_lshrrev_b32 v4, 5, v0
    v_lshlrev_b32 v9, 10, v4
    v_bfe_u32 v4, v0, 4, 1
    v_lshl_add_u32 v9, v4, 5, v9
    v_and_b32 v4, 1, v0
    v_lshl_add_u32 v9, v4, 4, v9
    v_bfe_u32 v4, v0, 1, 1
    v_lshl_add_u32 v9, v4, 3, v9
    s_branch L_rl_j_88
L_rl_w1_87:
    s_mov_b32 s24, s36
    s_mov_b32 s25, s37
    s_cmp_lt_u32 s72, 108
    s_cselect_b32 s26, 1409024, 0
    s_sub_u32 s46, s72, 60
    s_and_b32 s47, s46, 15
    s_lshr_b32 s46, s46, 4
    s_mov_b32 s73, 22016
    s_mul_i32 s49, s44, 11
    s_lshl_b32 s48, s46, 2
    s_add_u32 s49, s49, s48
    s_mul_i32 s79, s47, 88064
    s_lshl_b32 s48, s49, 5
    s_add_u32 s79, s79, s48
    s_lshl_b32 s74, s49, 14
    s_lshl_b32 s47, s47, 10
    s_add_u32 s74, s74, s47
    s_add_u32 s74, s74, 15204352
    s_mov_b32 s77, 32768
    s_mov_b32 s78, 16384
    s_mov_b32 s75, 256
    s_mov_b32 s76, 32
    s_cmp_eq_u32 s46, 2
    s_cselect_b32 s80, 3, 4
    s_sub_u32 s48, 2752, s48
    v_lshrrev_b32 v4, 5, v0
    v_bfe_u32 v5, v0, 2, 2
    v_lshl_add_u32 v4, v4, 2, v5
    v_mul_u32_u24 v8, 2752, v4
    v_bfe_u32 v4, v0, 4, 1
    v_lshl_add_u32 v8, v4, 6, v8
    v_and_b32 v4, 3, v0
    v_lshl_add_u32 v8, v4, 4, v8
    v_bfe_u32 v4, v0, 4, 1
    v_lshlrev_b32 v4, 6, v4
    v_and_b32 v5, 3, v0
    v_lshl_add_u32 v4, v5, 4, v4
    v_cmp_le_i32 vcc, s48, v4
    v_mov_b32 v4, 0x400000
    s_nop 0
    v_cndmask_b32 v8, v8, v4, vcc
    v_lshrrev_b32 v4, 4, v0
    v_lshlrev_b32 v9, 10, v4
    v_lshl_add_u32 v9, v5, 3, v9
L_rl_j_88:
    v_bfe_u32 v4, v0, 2, 2
    v_lshl_add_u32 v9, v4, 6, v9
    s_lshl_b32 s46, s51, 12
    s_add_u32 s62, s46, 0
    v_add_u32 v9, s62, v9
    v_add_u32 v10, s76, v9
    v_add_u32 v11, s75, v9
    v_add_u32 v12, s75, v10
    s_waitcnt vmcnt(15)
    v_and_b32 v129, 0xffff0000, v64
    v_lshlrev_b32 v128, 16, v64
    v_and_b32 v131, 0xffff0000, v65
    v_lshlrev_b32 v130, 16, v65
    v_and_b32 v133, 0xffff0000, v66
    v_lshlrev_b32 v132, 16, v66
    v_and_b32 v135, 0xffff0000, v67
    v_lshlrev_b32 v134, 16, v67
    v_pk_add_f32 v[16:17], v[128:129], v[130:131]
    v_pk_mul_f32 v[32:33], v[128:129], v[128:129]
    v_pk_fma_f32 v[32:33], v[130:131], v[130:131], v[32:33]
    v_pk_add_f32 v[16:17], v[16:17], v[132:133]
    v_pk_fma_f32 v[32:33], v[132:133], v[132:133], v[32:33]
    v_pk_add_f32 v[16:17], v[16:17], v[134:135]
    v_pk_fma_f32 v[32:33], v[134:135], v[134:135], v[32:33]
    s_waitcnt vmcnt(14)
    v_and_b32 v137, 0xffff0000, v72
    v_lshlrev_b32 v136, 16, v72
    v_and_b32 v139, 0xffff0000, v73
    v_lshlrev_b32 v138, 16, v73
    v_and_b32 v141, 0xffff0000, v74
    v_lshlrev_b32 v140, 16, v74
    v_and_b32 v143, 0xffff0000, v75
    v_lshlrev_b32 v142, 16, v75
    v_pk_add_f32 v[18:19], v[136:137], v[138:139]
    v_pk_mul_f32 v[34:35], v[136:137], v[136:137]
    v_pk_fma_f32 v[34:35], v[138:139], v[138:139], v[34:35]
    v_pk_add_f32 v[18:19], v[18:19], v[140:141]
    v_pk_fma_f32 v[34:35], v[140:141], v[140:141], v[34:35]
    v_pk_add_f32 v[18:19], v[18:19], v[142:143]
    v_pk_fma_f32 v[34:35], v[142:143], v[142:143], v[34:35]
    s_waitcnt vmcnt(13)
    v_and_b32 v145, 0xffff0000, v80
    v_lshlrev_b32 v144, 16, v80
    v_and_b32 v147, 0xffff0000, v81
    v_lshlrev_b32 v146, 16, v81
    v_and_b32 v149, 0xffff0000, v82
    v_lshlrev_b32 v148, 16, v82
    v_and_b32 v151, 0xffff0000, v83
    v_lshlrev_b32 v150, 16, v83
    v_pk_add_f32 v[20:21], v[144:145], v[146:147]
    v_pk_mul_f32 v[36:37], v[144:145], v[144:145]
    v_pk_fma_f32 v[36:37], v[146:147], v[146:147], v[36:37]
    v_pk_add_f32 v[20:21], v[20:21], v[148:149]
    v_pk_fma_f32 v[36:37], v[148:149], v[148:149], v[36:37]
    v_pk_add_f32 v[20:21], v[20:21], v[150:151]
    v_pk_fma_f32 v[36:37], v[150:151], v[150:151], v[36:37]
    s_waitcnt vmcnt(12)
    v_and_b32 v153, 0xffff0000, v88
    v_lshlrev_b32 v152, 16, v88
    v_and_b32 v155, 0xffff0000, v89
    v_lshlrev_b32 v154, 16, v89
    v_and_b32 v157, 0xffff0000, v90
    v_lshlrev_b32 v156, 16, v90
    v_and_b32 v159, 0xffff0000, v91
    v_lshlrev_b32 v158, 16, v91
    v_pk_add_f32 v[22:23], v[152:153], v[154:155]
    v_pk_mul_f32 v[38:39], v[152:153], v[152:153]
    v_pk_fma_f32 v[38:39], v[154:155], v[154:155], v[38:39]
    v_pk_add_f32 v[22:23], v[22:23], v[156:157]
    v_pk_fma_f32 v[38:39], v[156:157], v[156:157], v[38:39]
    v_pk_add_f32 v[22:23], v[22:23], v[158:159]
    v_pk_fma_f32 v[38:39], v[158:159], v[158:159], v[38:39]
    s_waitcnt vmcnt(11)
    v_and_b32 v161, 0xffff0000, v96
    v_lshlrev_b32 v160, 16, v96
    v_and_b32 v163, 0xffff0000, v97
    v_lshlrev_b32 v162, 16, v97
    v_and_b32 v165, 0xffff0000, v98
    v_lshlrev_b32 v164, 16, v98
    v_and_b32 v167, 0xffff0000, v99
    v_lshlrev_b32 v166, 16, v99
    v_pk_add_f32 v[24:25], v[160:161], v[162:163]
    v_pk_mul_f32 v[40:41], v[160:161], v[160:161]
    v_pk_fma_f32 v[40:41], v[162:163], v[162:163], v[40:41]
    v_pk_add_f32 v[24:25], v[24:25], v[164:165]
    v_pk_fma_f32 v[40:41], v[164:165], v[164:165], v[40:41]
    v_pk_add_f32 v[24:25], v[24:25], v[166:167]
    v_pk_fma_f32 v[40:41], v[166:167], v[166:167], v[40:41]
    s_waitcnt vmcnt(10)
    v_and_b32 v169, 0xffff0000, v104
    v_lshlrev_b32 v168, 16, v104
    v_and_b32 v171, 0xffff0000, v105
    v_lshlrev_b32 v170, 16, v105
    v_and_b32 v173, 0xffff0000, v106
    v_lshlrev_b32 v172, 16, v106
    v_and_b32 v175, 0xffff0000, v107
    v_lshlrev_b32 v174, 16, v107
    v_pk_add_f32 v[26:27], v[168:169], v[170:171]
    v_pk_mul_f32 v[42:43], v[168:169], v[168:169]
    v_pk_fma_f32 v[42:43], v[170:171], v[170:171], v[42:43]
    v_pk_add_f32 v[26:27], v[26:27], v[172:173]
    v_pk_fma_f32 v[42:43], v[172:173], v[172:173], v[42:43]
    v_pk_add_f32 v[26:27], v[26:27], v[174:175]
    v_pk_fma_f32 v[42:43], v[174:175], v[174:175], v[42:43]
    s_waitcnt vmcnt(9)
    v_and_b32 v177, 0xffff0000, v112
    v_lshlrev_b32 v176, 16, v112
    v_and_b32 v179, 0xffff0000, v113
    v_lshlrev_b32 v178, 16, v113
    v_and_b32 v181, 0xffff0000, v114
    v_lshlrev_b32 v180, 16, v114
    v_and_b32 v183, 0xffff0000, v115
    v_lshlrev_b32 v182, 16, v115
    v_pk_add_f32 v[28:29], v[176:177], v[178:179]
    v_pk_mul_f32 v[44:45], v[176:177], v[176:177]
    v_pk_fma_f32 v[44:45], v[178:179], v[178:179], v[44:45]
    v_pk_add_f32 v[28:29], v[28:29], v[180:181]
    v_pk_fma_f32 v[44:45], v[180:181], v[180:181], v[44:45]
    v_pk_add_f32 v[28:29], v[28:29], v[182:183]
    v_pk_fma_f32 v[44:45], v[182:183], v[182:183], v[44:45]
    s_waitcnt vmcnt(8)
    v_and_b32 v185, 0xffff0000, v120
    v_lshlrev_b32 v184, 16, v120
    v_and_b32 v187, 0xffff0000, v121
    v_lshlrev_b32 v186, 16, v121
    v_and_b32 v189, 0xffff0000, v122
    v_lshlrev_b32 v188, 16, v122
    v_and_b32 v191, 0xffff0000, v123
    v_lshlrev_b32 v190, 16, v123
    v_pk_add_f32 v[30:31], v[184:185], v[186:187]
    v_pk_mul_f32 v[46:47], v[184:185], v[184:185]
    v_pk_fma_f32 v[46:47], v[186:187], v[186:187], v[46:47]
    v_pk_add_f32 v[30:31], v[30:31], v[188:189]
    v_pk_fma_f32 v[46:47], v[188:189], v[188:189], v[46:47]
    v_pk_add_f32 v[30:31], v[30:31], v[190:191]
    v_pk_fma_f32 v[46:47], v[190:191], v[190:191], v[46:47]
    s_waitcnt vmcnt(7)
    v_and_b32 v193, 0xffff0000, v68
    v_lshlrev_b32 v192, 16, v68
    v_and_b32 v195, 0xffff0000, v69
    v_lshlrev_b32 v194, 16, v69
    v_and_b32 v197, 0xffff0000, v70
    v_lshlrev_b32 v196, 16, v70
    v_and_b32 v199, 0xffff0000, v71
    v_lshlrev_b32 v198, 16, v71
    v_pk_add_f32 v[16:17], v[16:17], v[192:193]
    v_pk_fma_f32 v[32:33], v[192:193], v[192:193], v[32:33]
    v_pk_add_f32 v[16:17], v[16:17], v[194:195]
    v_pk_fma_f32 v[32:33], v[194:195], v[194:195], v[32:33]
    v_pk_add_f32 v[16:17], v[16:17], v[196:197]
    v_pk_fma_f32 v[32:33], v[196:197], v[196:197], v[32:33]
    v_pk_add_f32 v[16:17], v[16:17], v[198:199]
    v_pk_fma_f32 v[32:33], v[198:199], v[198:199], v[32:33]
    s_waitcnt vmcnt(6)
    v_and_b32 v201, 0xffff0000, v76
    v_lshlrev_b32 v200, 16, v76
    v_and_b32 v203, 0xffff0000, v77
    v_lshlrev_b32 v202, 16, v77
    v_and_b32 v205, 0xffff0000, v78
    v_lshlrev_b32 v204, 16, v78
    v_and_b32 v207, 0xffff0000, v79
    v_lshlrev_b32 v206, 16, v79
    v_pk_add_f32 v[18:19], v[18:19], v[200:201]
    v_pk_fma_f32 v[34:35], v[200:201], v[200:201], v[34:35]
    v_pk_add_f32 v[18:19], v[18:19], v[202:203]
    v_pk_fma_f32 v[34:35], v[202:203], v[202:203], v[34:35]
    v_pk_add_f32 v[18:19], v[18:19], v[204:205]
    v_pk_fma_f32 v[34:35], v[204:205], v[204:205], v[34:35]
    v_pk_add_f32 v[18:19], v[18:19], v[206:207]
    v_pk_fma_f32 v[34:35], v[206:207], v[206:207], v[34:35]
    s_waitcnt vmcnt(5)
    v_and_b32 v209, 0xffff0000, v84
    v_lshlrev_b32 v208, 16, v84
    v_and_b32 v211, 0xffff0000, v85
    v_lshlrev_b32 v210, 16, v85
    v_and_b32 v213, 0xffff0000, v86
    v_lshlrev_b32 v212, 16, v86
    v_and_b32 v215, 0xffff0000, v87
    v_lshlrev_b32 v214, 16, v87
    v_pk_add_f32 v[20:21], v[20:21], v[208:209]
    v_pk_fma_f32 v[36:37], v[208:209], v[208:209], v[36:37]
    v_pk_add_f32 v[20:21], v[20:21], v[210:211]
    v_pk_fma_f32 v[36:37], v[210:211], v[210:211], v[36:37]
    v_pk_add_f32 v[20:21], v[20:21], v[212:213]
    v_pk_fma_f32 v[36:37], v[212:213], v[212:213], v[36:37]
    v_pk_add_f32 v[20:21], v[20:21], v[214:215]
    v_pk_fma_f32 v[36:37], v[214:215], v[214:215], v[36:37]
    s_waitcnt vmcnt(4)
    v_and_b32 v217, 0xffff0000, v92
    v_lshlrev_b32 v216, 16, v92
    v_and_b32 v219, 0xffff0000, v93
    v_lshlrev_b32 v218, 16, v93
    v_and_b32 v221, 0xffff0000, v94
    v_lshlrev_b32 v220, 16, v94
    v_and_b32 v223, 0xffff0000, v95
    v_lshlrev_b32 v222, 16, v95
    v_pk_add_f32 v[22:23], v[22:23], v[216:217]
    v_pk_fma_f32 v[38:39], v[216:217], v[216:217], v[38:39]
    v_pk_add_f32 v[22:23], v[22:23], v[218:219]
    v_pk_fma_f32 v[38:39], v[218:219], v[218:219], v[38:39]
    v_pk_add_f32 v[22:23], v[22:23], v[220:221]
    v_pk_fma_f32 v[38:39], v[220:221], v[220:221], v[38:39]
    v_pk_add_f32 v[22:23], v[22:23], v[222:223]
    v_pk_fma_f32 v[38:39], v[222:223], v[222:223], v[38:39]
    s_waitcnt vmcnt(3)
    v_and_b32 v225, 0xffff0000, v100
    v_lshlrev_b32 v224, 16, v100
    v_and_b32 v227, 0xffff0000, v101
    v_lshlrev_b32 v226, 16, v101
    v_and_b32 v229, 0xffff0000, v102
    v_lshlrev_b32 v228, 16, v102
    v_and_b32 v231, 0xffff0000, v103
    v_lshlrev_b32 v230, 16, v103
    v_pk_add_f32 v[24:25], v[24:25], v[224:225]
    v_pk_fma_f32 v[40:41], v[224:225], v[224:225], v[40:41]
    v_pk_add_f32 v[24:25], v[24:25], v[226:227]
    v_pk_fma_f32 v[40:41], v[226:227], v[226:227], v[40:41]
    v_pk_add_f32 v[24:25], v[24:25], v[228:229]
    v_pk_fma_f32 v[40:41], v[228:229], v[228:229], v[40:41]
    v_pk_add_f32 v[24:25], v[24:25], v[230:231]
    v_pk_fma_f32 v[40:41], v[230:231], v[230:231], v[40:41]
    s_waitcnt vmcnt(2)
    v_and_b32 v233, 0xffff0000, v108
    v_lshlrev_b32 v232, 16, v108
    v_and_b32 v235, 0xffff0000, v109
    v_lshlrev_b32 v234, 16, v109
    v_and_b32 v237, 0xffff0000, v110
    v_lshlrev_b32 v236, 16, v110
    v_and_b32 v239, 0xffff0000, v111
    v_lshlrev_b32 v238, 16, v111
    v_pk_add_f32 v[26:27], v[26:27], v[232:233]
    v_pk_fma_f32 v[42:43], v[232:233], v[232:233], v[42:43]
    v_pk_add_f32 v[26:27], v[26:27], v[234:235]
    v_pk_fma_f32 v[42:43], v[234:235], v[234:235], v[42:43]
    v_pk_add_f32 v[26:27], v[26:27], v[236:237]
    v_pk_fma_f32 v[42:43], v[236:237], v[236:237], v[42:43]
    v_pk_add_f32 v[26:27], v[26:27], v[238:239]
    v_pk_fma_f32 v[42:43], v[238:239], v[238:239], v[42:43]
    s_waitcnt vmcnt(1)
    v_and_b32 v241, 0xffff0000, v116
    v_lshlrev_b32 v240, 16, v116
    v_and_b32 v243, 0xffff0000, v117
    v_lshlrev_b32 v242, 16, v117
    v_and_b32 v245, 0xffff0000, v118
    v_lshlrev_b32 v244, 16, v118
    v_and_b32 v247, 0xffff0000, v119
    v_lshlrev_b32 v246, 16, v119
    v_pk_add_f32 v[28:29], v[28:29], v[240:241]
    v_pk_fma_f32 v[44:45], v[240:241], v[240:241], v[44:45]
    v_pk_add_f32 v[28:29], v[28:29], v[242:243]
    v_pk_fma_f32 v[44:45], v[242:243], v[242:243], v[44:45]
    v_pk_add_f32 v[28:29], v[28:29], v[244:245]
    v_pk_fma_f32 v[44:45], v[244:245], v[244:245], v[44:45]
    v_pk_add_f32 v[28:29], v[28:29], v[246:247]
    v_pk_fma_f32 v[44:45], v[246:247], v[246:247], v[44:45]
    s_waitcnt vmcnt(0)
    v_and_b32 v249, 0xffff0000, v124
    v_lshlrev_b32 v248, 16, v124
    v_and_b32 v251, 0xffff0000, v125
    v_lshlrev_b32 v250, 16, v125
    v_and_b32 v253, 0xffff0000, v126
    v_lshlrev_b32 v252, 16, v126
    v_and_b32 v255, 0xffff0000, v127
    v_lshlrev_b32 v254, 16, v127
    v_pk_add_f32 v[30:31], v[30:31], v[248:249]
    v_pk_fma_f32 v[46:47], v[248:249], v[248:249], v[46:47]
    v_pk_add_f32 v[30:31], v[30:31], v[250:251]
    v_pk_fma_f32 v[46:47], v[250:251], v[250:251], v[46:47]
    v_pk_add_f32 v[30:31], v[30:31], v[252:253]
    v_pk_fma_f32 v[46:47], v[252:253], v[252:253], v[46:47]
    v_pk_add_f32 v[30:31], v[30:31], v[254:255]
    v_pk_fma_f32 v[46:47], v[254:255], v[254:255], v[46:47]
    s_waitcnt lgkmcnt(0)
    s_add_u32 s45, s45, 0x9e3779b9
    s_and_b32 s3, s45, 0xff
    v_add_f32 v16, v16, v17
    v_add_f32 v32, v32, v33
    v_add_f32 v18, v18, v19
    v_add_f32 v34, v34, v35
    v_add_f32 v20, v20, v21
    v_add_f32 v36, v36, v37
    v_add_f32 v22, v22, v23
    v_add_f32 v38, v38, v39
    v_add_f32 v24, v24, v25
    v_add_f32 v40, v40, v41
    v_add_f32 v26, v26, v27
    v_add_f32 v42, v42, v43
    v_add_f32 v28, v28, v29
    v_add_f32 v44, v44, v45
    v_add_f32 v30, v30, v31
    v_add_f32 v46, v46, v47
    v_add_f32_dpp v56, v16, v16 row_half_mirror row_mask:0xf bank_mask:0x5
    v_add_f32_dpp v57, v18, v18 row_half_mirror row_mask:0xf bank_mask:0x5
    v_add_f32_dpp v58, v20, v20 row_half_mirror row_mask:0xf bank_mask:0x5
    v_add_f32_dpp v59, v22, v22 row_half_mirror row_mask:0xf bank_mask:0x5
    v_add_f32_dpp v60, v24, v24 row_half_mirror row_mask:0xf bank_mask:0x5
    v_add_f32_dpp v61, v26, v26 row_half_mirror row_mask:0xf bank_mask:0x5
    v_add_f32_dpp v62, v28, v28 row_half_mirror row_mask:0xf bank_mask:0x5
    v_add_f32_dpp v63, v30, v30 row_half_mirror row_mask:0xf bank_mask:0x5
    v_add_f32_dpp v56, v32, v32 row_half_mirror row_mask:0xf bank_mask:0xa
    v_add_f32_dpp v57, v34, v34 row_half_mirror row_mask:0xf bank_mask:0xa
    v_add_f32_dpp v58, v36, v36 row_half_mirror row_mask:0xf bank_mask:0xa
    v_add_f32_dpp v59, v38, v38 row_half_mirror row_mask:0xf bank_mask:0xa
    v_add_f32_dpp v60, v40, v40 row_half_mirror row_mask:0xf bank_mask:0xa
    v_add_f32_dpp v61, v42, v42 row_half_mirror row_mask:0xf bank_mask:0xa
    v_add_f32_dpp v62, v44, v44 row_half_mirror row_mask:0xf bank_mask:0xa
    v_add_f32_dpp v63, v46, v46 row_half_mirror row_mask:0xf bank_mask:0xa
    v_add_f32_dpp v56, v56, v56 quad_perm:[1,0,3,2] row_mask:0xf bank_mask:0xf
    v_add_f32_dpp v57, v57, v57 quad_perm:[1,0,3,2] row_mask:0xf bank_mask:0xf
    v_add_f32_dpp v58, v58, v58 quad_perm:[1,0,3,2] row_mask:0xf bank_mask:0xf
    v_add_f32_dpp v59, v59, v59 quad_perm:[1,0,3,2] row_mask:0xf bank_mask:0xf
    v_add_f32_dpp v60, v60, v60 quad_perm:[1,0,3,2] row_mask:0xf bank_mask:0xf
    v_add_f32_dpp v61, v61, v61 quad_perm:[1,0,3,2] row_mask:0xf bank_mask:0xf
    v_add_f32_dpp v62, v62, v62 quad_perm:[1,0,3,2] row_mask:0xf bank_mask:0xf
    v_add_f32_dpp v63, v63, v63 quad_perm:[1,0,3,2] row_mask:0xf bank_mask:0xf
    v_add_f32_dpp v56, v56, v56 quad_perm:[2,3,0,1] row_mask:0xf bank_mask:0xf
    v_add_f32_dpp v57, v57, v57 quad_perm:[2,3,0,1] row_mask:0xf bank_mask:0xf
    v_add_f32_dpp v58, v58, v58 quad_perm:[2,3,0,1] row_mask:0xf bank_mask:0xf
    v_add_f32_dpp v59, v59, v59 quad_perm:[2,3,0,1] row_mask:0xf bank_mask:0xf
    v_add_f32_dpp v60, v60, v60 quad_perm:[2,3,0,1] row_mask:0xf bank_mask:0xf
    v_add_f32_dpp v61, v61, v61 quad_perm:[2,3,0,1] row_mask:0xf bank_mask:0xf
    v_add_f32_dpp v62, v62, v62 quad_perm:[2,3,0,1] row_mask:0xf bank_mask:0xf
    v_add_f32_dpp v63, v63, v63 quad_perm:[2,3,0,1] row_mask:0xf bank_mask:0xf
    s_add_u32 s46, s81, 0
    s_and_b32 s46, s46, 7
    s_lshl_b32 s47, s46, 8
    s_lshl_b32 s46, s46, 10
    v_add_u32 v6, s47, v54
    ds_write_b32 v6, v56 offset:49152
    ds_write_b32 v6, v57 offset:49408
    v_add_u32 v40, s46, v50
    v_add_u32 v41, s46, v51
    s_add_u32 s46, s81, 2
    s_and_b32 s46, s46, 7
    s_lshl_b32 s47, s46, 8
    s_lshl_b32 s46, s46, 10
    v_add_u32 v6, s47, v54
    ds_write_b32 v6, v58 offset:49152
    ds_write_b32 v6, v59 offset:49408
    v_add_u32 v42, s46, v50
    v_add_u32 v43, s46, v51
    s_add_u32 s46, s81, 4
    s_and_b32 s46, s46, 7
    s_lshl_b32 s47, s46, 8
    s_lshl_b32 s46, s46, 10
    v_add_u32 v6, s47, v54
    ds_write_b32 v6, v60 offset:49152
    ds_write_b32 v6, v61 offset:49408
    v_add_u32 v44, s46, v50
    v_add_u32 v45, s46, v51
    s_add_u32 s46, s81, 6
    s_and_b32 s46, s46, 7
    s_lshl_b32 s47, s46, 8
    s_lshl_b32 s46, s46, 10
    v_add_u32 v6, s47, v54
    ds_write_b32 v6, v62 offset:49152
    ds_write_b32 v6, v63 offset:49408
    v_add_u32 v46, s46, v50
    v_add_u32 v47, s46, v51
    v_lshlrev_b32 v6, 5, v0
    s_waitcnt lgkmcnt(0)
    s_barrier
    ds_read_b128 v[32:35], v6 offset:49152
    ds_read_b128 v[36:39], v6 offset:49168
    s_waitcnt lgkmcnt(0)
    v_pk_add_f32 v[32:33], v[32:33], v[34:35]
    v_pk_add_f32 v[36:37], v[36:37], v[38:39]
    v_pk_add_f32 v[32:33], v[32:33], v[36:37]
    v_mul_f32 v32, 0xbb000000, v32
    v_mul_f32 v33, 0x3b000000, v33
    v_fma_f32 v33, -v32, v32, v33
    v_max_f32 v33, 0, v33
    v_add_f32 v33, 0x3727c5ac, v33
    v_rsq_f32 v34, v33
    s_nop 0
    v_mul_f32 v35, v32, v34
    s_lshl_b32 s46, s81, 3
    v_subrev_u32 v6, s46, v0
    v_and_b32 v6, 63, v6
    s_lshl_b32 s46, s51, 9
    v_lshl_add_u32 v6, v6, 3, s46
    ds_write_b64 v6, v[34:35] offset:51200
    ds_read_b64 v[16:17], v55 offset:51200
    ds_read_b64 v[18:19], v55 offset:51264
    ds_read_b64 v[20:21], v55 offset:51328
    ds_read_b64 v[22:23], v55 offset:51392
    ds_read_b64 v[24:25], v55 offset:51456
    ds_read_b64 v[26:27], v55 offset:51520
    ds_read_b64 v[28:29], v55 offset:51584
    ds_read_b64 v[30:31], v55 offset:51648
    s_barrier
    s_waitcnt lgkmcnt(7)
    v_pk_fma_f32 v[128:129], v[128:129], v[16:17], v[16:17] op_sel:[0,0,1] op_sel_hi:[1,0,1]
    v_pk_fma_f32 v[130:131], v[130:131], v[16:17], v[16:17] op_sel:[0,0,1] op_sel_hi:[1,0,1]
    v_pk_fma_f32 v[132:133], v[132:133], v[16:17], v[16:17] op_sel:[0,0,1] op_sel_hi:[1,0,1]
    v_pk_fma_f32 v[134:135], v[134:135], v[16:17], v[16:17] op_sel:[0,0,1] op_sel_hi:[1,0,1]
    v_pk_fma_f32 v[192:193], v[192:193], v[16:17], v[16:17] op_sel:[0,0,1] op_sel_hi:[1,0,1]
    v_pk_fma_f32 v[194:195], v[194:195], v[16:17], v[16:17] op_sel:[0,0,1] op_sel_hi:[1,0,1]
    v_pk_fma_f32 v[196:197], v[196:197], v[16:17], v[16:17] op_sel:[0,0,1] op_sel_hi:[1,0,1]
    v_pk_fma_f32 v[198:199], v[198:199], v[16:17], v[16:17] op_sel:[0,0,1] op_sel_hi:[1,0,1]
    s_waitcnt lgkmcnt(6)
    v_pk_fma_f32 v[136:137], v[136:137], v[18:19], v[18:19] op_sel:[0,0,1] op_sel_hi:[1,0,1]
    v_pk_fma_f32 v[138:139], v[138:139], v[18:19], v[18:19] op_sel:[0,0,1] op_sel_hi:[1,0,1]
    v_pk_fma_f32 v[140:141], v[140:141], v[18:19], v[18:19] op_sel:[0,0,1] op_sel_hi:[1,0,1]
    v_pk_fma_f32 v[142:143], v[142:143], v[18:19], v[18:19] op_sel:[0,0,1] op_sel_hi:[1,0,1]
    v_pk_fma_f32 v[200:201], v[200:201], v[18:19], v[18:19] op_sel:[0,0,1] op_sel_hi:[1,0,1]
    v_pk_fma_f32 v[202:203], v[202:203], v[18:19], v[18:19] op_sel:[0,0,1] op_sel_hi:[1,0,1]
    v_pk_fma_f32 v[204:205], v[204:205], v[18:19], v[18:19] op_sel:[0,0,1] op_sel_hi:[1,0,1]
    v_pk_fma_f32 v[206:207], v[206:207], v[18:19], v[18:19] op_sel:[0,0,1] op_sel_hi:[1,0,1]
    s_waitcnt lgkmcnt(5)
    v_pk_fma_f32 v[144:145], v[144:145], v[20:21], v[20:21] op_sel:[0,0,1] op_sel_hi:[1,0,1]
    v_pk_fma_f32 v[146:147], v[146:147], v[20:21], v[20:21] op_sel:[0,0,1] op_sel_hi:[1,0,1]
    v_pk_fma_f32 v[148:149], v[148:149], v[20:21], v[20:21] op_sel:[0,0,1] op_sel_hi:[1,0,1]
    v_pk_fma_f32 v[150:151], v[150:151], v[20:21], v[20:21] op_sel:[0,0,1] op_sel_hi:[1,0,1]
    v_pk_fma_f32 v[208:209], v[208:209], v[20:21], v[20:21] op_sel:[0,0,1] op_sel_hi:[1,0,1]
    v_pk_fma_f32 v[210:211], v[210:211], v[20:21], v[20:21] op_sel:[0,0,1] op_sel_hi:[1,0,1]
    v_pk_fma_f32 v[212:213], v[212:213], v[20:21], v[20:21] op_sel:[0,0,1] op_sel_hi:[1,0,1]
    v_pk_fma_f32 v[214:215], v[214:215], v[20:21], v[20:21] op_sel:[0,0,1] op_sel_hi:[1,0,1]
    s_waitcnt lgkmcnt(4)
    v_pk_fma_f32 v[152:153], v[152:153], v[22:23], v[22:23] op_sel:[0,0,1] op_sel_hi:[1,0,1]
    v_pk_fma_f32 v[154:155], v[154:155], v[22:23], v[22:23] op_sel:[0,0,1] op_sel_hi:[1,0,1]
    v_pk_fma_f32 v[156:157], v[156:157], v[22:23], v[22:23] op_sel:[0,0,1] op_sel_hi:[1,0,1]
    v_pk_fma_f32 v[158:159], v[158:159], v[22:23], v[22:23] op_sel:[0,0,1] op_sel_hi:[1,0,1]
    v_pk_fma_f32 v[216:217], v[216:217], v[22:23], v[22:23] op_sel:[0,0,1] op_sel_hi:[1,0,1]
    v_pk_fma_f32 v[218:219], v[218:219], v[22:23], v[22:23] op_sel:[0,0,1] op_sel_hi:[1,0,1]
    v_pk_fma_f32 v[220:221], v[220:221], v[22:23], v[22:23] op_sel:[0,0,1] op_sel_hi:[1,0,1]
    v_pk_fma_f32 v[222:223], v[222:223], v[22:23], v[22:23] op_sel:[0,0,1] op_sel_hi:[1,0,1]
    s_waitcnt lgkmcnt(3)
    v_pk_fma_f32 v[160:161], v[160:161], v[24:25], v[24:25] op_sel:[0,0,1] op_sel_hi:[1,0,1]
    v_pk_fma_f32 v[162:163], v[162:163], v[24:25], v[24:25] op_sel:[0,0,1] op_sel_hi:[1,0,1]
    v_pk_fma_f32 v[164:165], v[164:165], v[24:25], v[24:25] op_sel:[0,0,1] op_sel_hi:[1,0,1]
    v_pk_fma_f32 v[166:167], v[166:167], v[24:25], v[24:25] op_sel:[0,0,1] op_sel_hi:[1,0,1]
    v_pk_fma_f32 v[224:225], v[224:225], v[24:25], v[24:25] op_sel:[0,0,1] op_sel_hi:[1,0,1]
    v_pk_fma_f32 v[226:227], v[226:227], v[24:25], v[24:25] op_sel:[0,0,1] op_sel_hi:[1,0,1]
    v_pk_fma_f32 v[228:229], v[228:229], v[24:25], v[24:25] op_sel:[0,0,1] op_sel_hi:[1,0,1]
    v_pk_fma_f32 v[230:231], v[230:231], v[24:25], v[24:25] op_sel:[0,0,1] op_sel_hi:[1,0,1]
    s_waitcnt lgkmcnt(2)
    v_pk_fma_f32 v[168:169], v[168:169], v[26:27], v[26:27] op_sel:[0,0,1] op_sel_hi:[1,0,1]
    v_pk_fma_f32 v[170:171], v[170:171], v[26:27], v[26:27] op_sel:[0,0,1] op_sel_hi:[1,0,1]
    v_pk_fma_f32 v[172:173], v[172:173], v[26:27], v[26:27] op_sel:[0,0,1] op_sel_hi:[1,0,1]
    v_pk_fma_f32 v[174:175], v[174:175], v[26:27], v[26:27] op_sel:[0,0,1] op_sel_hi:[1,0,1]
    v_pk_fma_f32 v[232:233], v[232:233], v[26:27], v[26:27] op_sel:[0,0,1] op_sel_hi:[1,0,1]
    v_pk_fma_f32 v[234:235], v[234:235], v[26:27], v[26:27] op_sel:[0,0,1] op_sel_hi:[1,0,1]
    v_pk_fma_f32 v[236:237], v[236:237], v[26:27], v[26:27] op_sel:[0,0,1] op_sel_hi:[1,0,1]
    v_pk_fma_f32 v[238:239], v[238:239], v[26:27], v[26:27] op_sel:[0,0,1] op_sel_hi:[1,0,1]
    s_waitcnt lgkmcnt(1)
    v_pk_fma_f32 v[176:177], v[176:177], v[28:29], v[28:29] op_sel:[0,0,1] op_sel_hi:[1,0,1]
    v_pk_fma_f32 v[178:179], v[178:179], v[28:29], v[28:29] op_sel:[0,0,1] op_sel_hi:[1,0,1]
    v_pk_fma_f32 v[180:181], v[180:181], v[28:29], v[28:29] op_sel:[0,0,1] op_sel_hi:[1,0,1]
    v_pk_fma_f32 v[182:183], v[182:183], v[28:29], v[28:29] op_sel:[0,0,1] op_sel_hi:[1,0,1]
    v_pk_fma_f32 v[240:241], v[240:241], v[28:29], v[28:29] op_sel:[0,0,1] op_sel_hi:[1,0,1]
    v_pk_fma_f32 v[242:243], v[242:243], v[28:29], v[28:29] op_sel:[0,0,1] op_sel_hi:[1,0,1]
    v_pk_fma_f32 v[244:245], v[244:245], v[28:29], v[28:29] op_sel:[0,0,1] op_sel_hi:[1,0,1]
    v_pk_fma_f32 v[246:247], v[246:247], v[28:29], v[28:29] op_sel:[0,0,1] op_sel_hi:[1,0,1]
    s_waitcnt lgkmcnt(0)
    v_pk_fma_f32 v[184:185], v[184:185], v[30:31], v[30:31] op_sel:[0,0,1] op_sel_hi:[1,0,1]
    v_pk_fma_f32 v[186:187], v[186:187], v[30:31], v[30:31] op_sel:[0,0,1] op_sel_hi:[1,0,1]
    v_pk_fma_f32 v[188:189], v[188:189], v[30:31], v[30:31] op_sel:[0,0,1] op_sel_hi:[1,0,1]
    v_pk_fma_f32 v[190:191], v[190:191], v[30:31], v[30:31] op_sel:[0,0,1] op_sel_hi:[1,0,1]
    v_pk_fma_f32 v[248:249], v[248:249], v[30:31], v[30:31] op_sel:[0,0,1] op_sel_hi:[1,0,1]
    v_pk_fma_f32 v[250:251], v[250:251], v[30:31], v[30:31] op_sel:[0,0,1] op_sel_hi:[1,0,1]
    v_pk_fma_f32 v[252:253], v[252:253], v[30:31], v[30:31] op_sel:[0,0,1] op_sel_hi:[1,0,1]
    v_pk_fma_f32 v[254:255], v[254:255], v[30:31], v[30:31] op_sel:[0,0,1] op_sel_hi:[1,0,1]
    s_barrier
    ds_read_b128 v[64:67], v52 offset:57344
    ds_read_b128 v[68:71], v52 offset:57360
    ds_read_b128 v[72:75], v52 offset:59392
    ds_read_b128 v[76:79], v52 offset:59408
    ds_read_b128 v[80:83], v53 offset:57344
    ds_read_b128 v[84:87], v53 offset:57360
    ds_read_b128 v[88:91], v53 offset:59392
    ds_read_b128 v[92:95], v53 offset:59408
    s_waitcnt lgkmcnt(4)
    v_pk_fma_f32 v[128:129], v[128:129], v[72:73], v[64:65]
    v_pk_fma_f32 v[130:131], v[130:131], v[74:75], v[66:67]
    v_pk_fma_f32 v[132:133], v[132:133], v[76:77], v[68:69]
    v_pk_fma_f32 v[134:135], v[134:135], v[78:79], v[70:71]
    v_cvt_pk_bf16_f32 v128, v128, v129
    v_cvt_pk_bf16_f32 v129, v130, v131
    v_cvt_pk_bf16_f32 v130, v132, v133
    v_cvt_pk_bf16_f32 v131, v134, v135
    ds_write_b128 v40, v[128:131] offset:0
    v_pk_fma_f32 v[136:137], v[136:137], v[72:73], v[64:65]
    v_pk_fma_f32 v[138:139], v[138:139], v[74:75], v[66:67]
    v_pk_fma_f32 v[140:141], v[140:141], v[76:77], v[68:69]
    v_pk_fma_f32 v[142:143], v[142:143], v[78:79], v[70:71]
    v_cvt_pk_bf16_f32 v136, v136, v137
    v_cvt_pk_bf16_f32 v137, v138, v139
    v_cvt_pk_bf16_f32 v138, v140, v141
    v_cvt_pk_bf16_f32 v139, v142, v143
    ds_write_b128 v41, v[136:139] offset:1024
    v_pk_fma_f32 v[144:145], v[144:145], v[72:73], v[64:65]
    v_pk_fma_f32 v[146:147], v[146:147], v[74:75], v[66:67]
    v_pk_fma_f32 v[148:149], v[148:149], v[76:77], v[68:69]
    v_pk_fma_f32 v[150:151], v[150:151], v[78:79], v[70:71]
    v_cvt_pk_bf16_f32 v144, v144, v145
    v_cvt_pk_bf16_f32 v145, v146, v147
    v_cvt_pk_bf16_f32 v146, v148, v149
    v_cvt_pk_bf16_f32 v147, v150, v151
    ds_write_b128 v42, v[144:147] offset:0
    v_pk_fma_f32 v[152:153], v[152:153], v[72:73], v[64:65]
    v_pk_fma_f32 v[154:155], v[154:155], v[74:75], v[66:67]
    v_pk_fma_f32 v[156:157], v[156:157], v[76:77], v[68:69]
    v_pk_fma_f32 v[158:159], v[158:159], v[78:79], v[70:71]
    v_cvt_pk_bf16_f32 v152, v152, v153
    v_cvt_pk_bf16_f32 v153, v154, v155
    v_cvt_pk_bf16_f32 v154, v156, v157
    v_cvt_pk_bf16_f32 v155, v158, v159
    ds_write_b128 v43, v[152:155] offset:1024
    v_pk_fma_f32 v[160:161], v[160:161], v[72:73], v[64:65]
    v_pk_fma_f32 v[162:163], v[162:163], v[74:75], v[66:67]
    v_pk_fma_f32 v[164:165], v[164:165], v[76:77], v[68:69]
    v_pk_fma_f32 v[166:167], v[166:167], v[78:79], v[70:71]
    v_cvt_pk_bf16_f32 v160, v160, v161
    v_cvt_pk_bf16_f32 v161, v162, v163
    v_cvt_pk_bf16_f32 v162, v164, v165
    v_cvt_pk_bf16_f32 v163, v166, v167
    ds_write_b128 v44, v[160:163] offset:0
    v_pk_fma_f32 v[168:169], v[168:169], v[72:73], v[64:65]
    v_pk_fma_f32 v[170:171], v[170:171], v[74:75], v[66:67]
    v_pk_fma_f32 v[172:173], v[172:173], v[76:77], v[68:69]
    v_pk_fma_f32 v[174:175], v[174:175], v[78:79], v[70:71]
    v_cvt_pk_bf16_f32 v168, v168, v169
    v_cvt_pk_bf16_f32 v169, v170, v171
    v_cvt_pk_bf16_f32 v170, v172, v173
    v_cvt_pk_bf16_f32 v171, v174, v175
    ds_write_b128 v45, v[168:171] offset:1024
    v_pk_fma_f32 v[176:177], v[176:177], v[72:73], v[64:65]
    v_pk_fma_f32 v[178:179], v[178:179], v[74:75], v[66:67]
    v_pk_fma_f32 v[180:181], v[180:181], v[76:77], v[68:69]
    v_pk_fma_f32 v[182:183], v[182:183], v[78:79], v[70:71]
    v_cvt_pk_bf16_f32 v176, v176, v177
    v_cvt_pk_bf16_f32 v177, v178, v179
    v_cvt_pk_bf16_f32 v178, v180, v181
    v_cvt_pk_bf16_f32 v179, v182, v183
    ds_write_b128 v46, v[176:179] offset:0
    v_pk_fma_f32 v[184:185], v[184:185], v[72:73], v[64:65]
    v_pk_fma_f32 v[186:187], v[186:187], v[74:75], v[66:67]
    v_pk_fma_f32 v[188:189], v[188:189], v[76:77], v[68:69]
    v_pk_fma_f32 v[190:191], v[190:191], v[78:79], v[70:71]
    v_cvt_pk_bf16_f32 v184, v184, v185
    v_cvt_pk_bf16_f32 v185, v186, v187
    v_cvt_pk_bf16_f32 v186, v188, v189
    v_cvt_pk_bf16_f32 v187, v190, v191
    ds_write_b128 v47, v[184:187] offset:1024
    s_waitcnt lgkmcnt(0)
    s_barrier
    v_fma_f32 v192, v192, v88, v80
    v_fma_f32 v193, v193, v89, v81
    v_fma_f32 v194, v194, v90, v82
    v_fma_f32 v195, v195, v91, v83
    v_fma_f32 v196, v196, v92, v84
    v_fma_f32 v197, v197, v93, v85
    v_fma_f32 v198, v198, v94, v86
    v_fma_f32 v199, v199, v95, v87
    v_cvt_pk_bf16_f32 v192, v192, v193
    v_cvt_pk_bf16_f32 v193, v194, v195
    v_cvt_pk_bf16_f32 v194, v196, v197
    v_cvt_pk_bf16_f32 v195, v198, v199
    ds_write_b128 v40, v[192:195] offset:32768
    v_fma_f32 v200, v200, v88, v80
    v_fma_f32 v201, v201, v89, v81
    v_fma_f32 v202, v202, v90, v82
    v_fma_f32 v203, v203, v91, v83
    v_fma_f32 v204, v204, v92, v84
    v_fma_f32 v205, v205, v93, v85
    v_fma_f32 v206, v206, v94, v86
    v_fma_f32 v207, v207, v95, v87
    v_cvt_pk_bf16_f32 v200, v200, v201
    v_cvt_pk_bf16_f32 v201, v202, v203
    v_cvt_pk_bf16_f32 v202, v204, v205
    v_cvt_pk_bf16_f32 v203, v206, v207
    ds_write_b128 v41, v[200:203] offset:33792
    v_fma_f32 v208, v208, v88, v80
    v_fma_f32 v209, v209, v89, v81
    v_fma_f32 v210, v210, v90, v82
    v_fma_f32 v211, v211, v91, v83
    v_fma_f32 v212, v212, v92, v84
    v_fma_f32 v213, v213, v93, v85
    v_fma_f32 v214, v214, v94, v86
    v_fma_f32 v215, v215, v95, v87
    v_cvt_pk_bf16_f32 v208, v208, v209
    v_cvt_pk_bf16_f32 v209, v210, v211
    v_cvt_pk_bf16_f32 v210, v212, v213
    v_cvt_pk_bf16_f32 v211, v214, v215
    ds_write_b128 v42, v[208:211] offset:32768
    v_fma_f32 v216, v216, v88, v80
    v_fma_f32 v217, v217, v89, v81
    v_fma_f32 v218, v218, v90, v82
    v_fma_f32 v219, v219, v91, v83
    v_fma_f32 v220, v220, v92, v84
    v_fma_f32 v221, v221, v93, v85
    v_fma_f32 v222, v222, v94, v86
    v_fma_f32 v223, v223, v95, v87
    v_cvt_pk_bf16_f32 v216, v216, v217
    v_cvt_pk_bf16_f32 v217, v218, v219
    v_cvt_pk_bf16_f32 v218, v220, v221
    v_cvt_pk_bf16_f32 v219, v222, v223
    ds_write_b128 v43, v[216:219] offset:33792
    v_fma_f32 v224, v224, v88, v80
    v_fma_f32 v225, v225, v89, v81
    v_fma_f32 v226, v226, v90, v82
    v_fma_f32 v227, v227, v91, v83
    v_fma_f32 v228, v228, v92, v84
    v_fma_f32 v229, v229, v93, v85
    v_fma_f32 v230, v230, v94, v86
    v_fma_f32 v231, v231, v95, v87
    v_cvt_pk_bf16_f32 v224, v224, v225
    v_cvt_pk_bf16_f32 v225, v226, v227
    v_cvt_pk_bf16_f32 v226, v228, v229
    v_cvt_pk_bf16_f32 v227, v230, v231
    ds_write_b128 v44, v[224:227] offset:32768
    v_fma_f32 v232, v232, v88, v80
    v_fma_f32 v233, v233, v89, v81
    v_fma_f32 v234, v234, v90, v82
    v_fma_f32 v235, v235, v91, v83
    v_fma_f32 v236, v236, v92, v84
    v_fma_f32 v237, v237, v93, v85
    v_fma_f32 v238, v238, v94, v86
    v_fma_f32 v239, v239, v95, v87
    v_cvt_pk_bf16_f32 v232, v232, v233
    v_cvt_pk_bf16_f32 v233, v234, v235
    v_cvt_pk_bf16_f32 v234, v236, v237
    v_cvt_pk_bf16_f32 v235, v238, v239
    ds_write_b128 v45, v[232:235] offset:33792
    v_fma_f32 v240, v240, v88, v80
    v_fma_f32 v241, v241, v89, v81
    v_fma_f32 v242, v242, v90, v82
    v_fma_f32 v243, v243, v91, v83
    v_fma_f32 v244, v244, v92, v84
    v_fma_f32 v245, v245, v93, v85
    v_fma_f32 v246, v246, v94, v86
    v_fma_f32 v247, v247, v95, v87
    v_cvt_pk_bf16_f32 v240, v240, v241
    v_cvt_pk_bf16_f32 v241, v242, v243
    v_cvt_pk_bf16_f32 v242, v244, v245
    v_cvt_pk_bf16_f32 v243, v246, v247
    ds_write_b128 v46, v[240:243] offset:32768
    v_fma_f32 v248, v248, v88, v80
    v_fma_f32 v249, v249, v89, v81
    v_fma_f32 v250, v250, v90, v82
    v_fma_f32 v251, v251, v91, v83
    v_fma_f32 v252, v252, v92, v84
    v_fma_f32 v253, v253, v93, v85
    v_fma_f32 v254, v254, v94, v86
    v_fma_f32 v255, v255, v95, v87
    v_cvt_pk_bf16_f32 v248, v248, v249
    v_cvt_pk_bf16_f32 v249, v250, v251
    v_cvt_pk_bf16_f32 v250, v252, v253
    v_cvt_pk_bf16_f32 v251, v254, v255
    ds_write_b128 v47, v[248:251] offset:33792
    s_waitcnt lgkmcnt(0)
    s_barrier
    s_add_u32 m0, s62, 0
    s_nop 0
    buffer_load_dwordx4 v8, s[24:27], s79 offen lds
    s_add_u32 s79, s79, s73
    s_add_u32 m0, s62, 1024
    s_nop 0
    buffer_load_dwordx4 v8, s[24:27], s79 offen lds
    s_add_u32 s79, s79, s73
    s_add_u32 m0, s62, 2048
    s_nop 0
    buffer_load_dwordx4 v8, s[24:27], s79 offen lds
    s_add_u32 s79, s79, s73
    s_add_u32 m0, s62, 3072
    s_nop 0
    buffer_load_dwordx4 v8, s[24:27], s79 offen lds
    s_barrier
    v_mov_b32 v4, 65536
    v_mov_b32 v5, 0
    ds_write_b32 v4, v5
    s_waitcnt vmcnt(0)
    ds_read_b64_tr_b16 v[136:137], v9 offset:0
    ds_read_b64_tr_b16 v[138:139], v9 offset:512
    ds_read_b64_tr_b16 v[140:141], v10 offset:0
    ds_read_b64_tr_b16 v[142:143], v10 offset:512
    ds_read_b64_tr_b16 v[144:145], v11 offset:0
    ds_read_b64_tr_b16 v[146:147], v11 offset:512
    ds_read_b64_tr_b16 v[148:149], v12 offset:0
    ds_read_b64_tr_b16 v[150:151], v12 offset:512
    s_cmp_ge_u32 s72, 108
    s_cselect_b32 s74, 0x40000000, s74
    s_add_u32 s75, s74, s78
    s_add_u32 s76, s74, s77
    s_add_u32 s73, s75, s77
    s_cmp_eq_u32 s80, 3
    s_cselect_b32 s73, 0x40000000, s73
    s_waitcnt lgkmcnt(0)
    buffer_store_dwordx4 v[136:139], v2, s[4:7], s74 offen sc1
    buffer_store_dwordx4 v[140:143], v2, s[4:7], s75 offen sc1
    buffer_store_dwordx4 v[144:147], v2, s[4:7], s76 offen sc1
    buffer_store_dwordx4 v[148:151], v2, s[4:7], s73 offen sc1
    s_waitcnt lgkmcnt(0)
    s_lshl_b32 s48, s43, 3
    s_add_u32 s83, s48, s44
    s_lshl_b32 s83, s83, 7
    s_add_u32 s84, s48, s40
    s_lshl_b32 s84, s84, 7
    s_mul_i32 s85, s83, 10
    s_add_u32 s85, s85, 18186240
    s_mul_i32 s86, s84, 10
    s_add_u32 s86, s86, 18186240
    s_and_b32 s50, s40, 1
    s_lshl_b32 s65, s50, 6
    s_add_u32 s65, s65, 32
    s_lshl_b32 s64, s43, 1
    s_bfe_u32 s49, s40, 0x10001
    s_add_u32 s64, s64, s49
    s_lshl_b32 s64, s64, 15
    s_lshl_b32 s48, s44, 7
    s_add_u32 s64, s64, s48
    s_add_u32 s64, s64, s65
    s_lshl_b32 s48, s44, 1
    s_add_u32 s48, s48, s50
    s_lshl_b32 s68, s48, 15
    s_add_u32 s68, s68, 524288
    s_mul_i32 s66, s48, 90112
    s_mul_i32 s49, s49, 11264
    s_add_u32 s66, s66, s49
    s_add_u32 s66, s66, 16646144
    s_and_b32 s47, s40, 3
    s_lshl_b32 s46, s44, 2
    s_add_u32 s46, s46, s47
    s_lshl_b32 s56, s46, 17
    s_add_u32 s56, s56, 1050624
    s_lshl_b32 s70, s46, 12
    s_add_u32 s90, s70, 18513920
    s_add_u32 s70, s70, 131072
    s_lshl_b32 s81, s40, 13
    s_add_u32 s81, s81, 98304
    s_mul_i32 s58, s44, 11
    s_add_u32 s58, s58, s47
    s_lshl_b32 s59, s58, 14
    s_add_u32 s59, s59, 15204352
    s_and_b32 s57, s43, 28
    s_lshl_b32 s57, s57, 12
    s_and_b32 s46, s43, 28
    v_add_u32 v252, s46, v0
    v_and_b32 v252, 31, v252
    v_lshlrev_b32 v252, 7, v252
    v_xor_b32 v7, 256, v2
    v_lshrrev_b32 v5, 5, v0
    v_lshlrev_b32 v48, 4, v5
    v_and_b32 v6, 31, v0
    v_lshl_add_u32 v6, v6, 10, v48
    s_setprio 0
    s_lshl_b32 s47, s40, 10
    s_add_u32 m0, s47, 16384
    s_sub_u32 s48, s64, 32
    buffer_load_dwordx4 v6, s[8:11], s64 offen lds
    s_add_u32 m0, s47, 12288
    s_nop 0
    buffer_load_dwordx4 v6, s[8:11], s48 offen lds
    v_and_b32 v48, 15, v0
    v_lshlrev_b32 v48, 4, v48
    v_lshl_add_u32 v3, v5, 8, v48
    v_add_u32 v3, s81, v3
    v_mov_b32 v4, 0xdddddddd
    v_and_b32 v48, 27, v0
    v_cmp_eq_u32 vcc, 16, v48
    v_mov_b32 v48, 0x3f803f80
    s_nop 0
    v_cndmask_b32 v48, 0, v48, vcc
    v_mov_b32 v49, v48
    v_pk_mov_b32 v[112:113], v[48:49], v[48:49] op_sel:[0,1]
    v_pk_mov_b32 v[114:115], v[48:49], v[48:49] op_sel:[0,1]
    v_pk_mov_b32 v[116:117], v[48:49], v[48:49] op_sel:[0,1]
    v_pk_mov_b32 v[118:119], v[48:49], v[48:49] op_sel:[0,1]
    v_pk_mov_b32 v[120:121], v[48:49], v[48:49] op_sel:[0,1]
    v_pk_mov_b32 v[122:123], v[48:49], v[48:49] op_sel:[0,1]
    v_pk_mov_b32 v[124:125], v[48:49], v[48:49] op_sel:[0,1]
    v_pk_mov_b32 v[126:127], v[48:49], v[48:49] op_sel:[0,1]
    v_pk_mov_b32 v[16:17], 0, 0
    v_pk_mov_b32 v[18:19], 0, 0
    v_pk_mov_b32 v[20:21], 0, 0
    v_pk_mov_b32 v[22:23], 0, 0
    v_pk_mov_b32 v[24:25], 0, 0
    v_pk_mov_b32 v[26:27], 0, 0
    v_pk_mov_b32 v[28:29], 0, 0
    v_pk_mov_b32 v[30:31], 0, 0
    v_pk_mov_b32 v[32:33], 0, 0
    v_pk_mov_b32 v[34:35], 0, 0
    v_pk_mov_b32 v[36:37], 0, 0
    v_pk_mov_b32 v[38:39], 0, 0
    v_pk_mov_b32 v[40:41], 0, 0
    v_pk_mov_b32 v[42:43], 0, 0
    v_pk_mov_b32 v[44:45], 0, 0
    v_pk_mov_b32 v[46:47], 0, 0
    s_barrier
    s_and_b32 s48, s40, 3
    s_lshl_b32 s48, s48, 11
    s_add_u32 s48, s48, 66560
    v_add_u32 v5, s48, v2
    ds_read_b128 v[8:11], v5 offset:1024
    ds_read_b128 v[12:15], v5
    s_mov_b64 exec, 15
    s_mov_b32 s52, 400000
L_poll_kv0_89:
    s_and_b32 s50, s52, 7
    s_cmp_eq_u32 s50, 1
    s_cselect_b32 s50, s70, s90
    buffer_load_dword v254, v252, s[4:7], s50 offen sc1
    s_sub_u32 s52, s52, 1
    s_cmp_eq_u32 s52, 0
    s_waitcnt vmcnt(0)
    s_cbranch_scc1 L_pdone_kv0_90
    v_cmp_ne_u32 vcc, s45, v254
    s_nop 0
    s_cbranch_vccnz L_poll_kv0_89
L_pdone_kv0_90:
    s_mov_b64 exec, -1
    s_add_u32 s46, s43, 1
    s_and_b32 s46, s46, 3
    s_lshl_b32 s46, s46, 12
    s_add_u32 s46, s46, s57
    s_add_u32 s46, s46, s56
    buffer_load_dwordx4 v[84:87], v2, s[4:7], s46 offen sc1
    s_add_u32 m0, s81, 0
    s_nop 0
    buffer_load_dwordx4 v2, s[4:7], s46 offen offset:1024 sc1 lds
    s_add_u32 s46, s43, 2
    s_and_b32 s46, s46, 3
    s_lshl_b32 s46, s46, 12
    s_add_u32 s46, s46, s57
    s_add_u32 s46, s46, s56
    buffer_load_dwordx4 v[88:91], v2, s[4:7], s46 offen sc1
    s_add_u32 m0, s81, 1024
    s_nop 0
    buffer_load_dwordx4 v2, s[4:7], s46 offen offset:1024 sc1 lds
    s_add_u32 s46, s43, 3
    s_and_b32 s46, s46, 3
    s_lshl_b32 s46, s46, 12
    s_add_u32 s46, s46, s57
    s_add_u32 s46, s46, s56
    buffer_load_dwordx4 v[92:95], v2, s[4:7], s46 offen sc1
    s_add_u32 m0, s81, 2048
    s_nop 0
    buffer_load_dwordx4 v2, s[4:7], s46 offen offset:1024 sc1 lds
    s_add_u32 s57, s57, 16384
    s_and_b32 s57, s57, 0x1ffff
    buffer_load_dword v254, v252, s[4:7], s70 offen sc1
    v_mov_b32 v250, 65536
    v_mov_b32 v251, 1
    s_mov_b64 exec, 1
    ds_add_rtn_u32 v251, v250, v251
    s_mov_b64 exec, -1
    s_lshl_b32 s47, s44, 5
    s_add_u32 s47, s47, s43
    s_lshl_b32 s47, s47, 7
    s_add_u32 s47, s47, 98304
    s_waitcnt lgkmcnt(0)
    v_readfirstlane_b32 s48, v251
    s_nop 0
    s_cmp_lg_u32 s48, 3
    s_cbranch_scc1 L_notlast_91
    v_mov_b32 v5, s45
    v_lshlrev_b32 v253, 2, v0
    s_mov_b32 exec_hi, 0
    buffer_store_dword v5, v253, s[4:7], s47 offen sc1
    s_mov_b64 exec, -1
L_notlast_91:
    s_and_b32 s46, s40, 3
    s_mul_i32 s46, s46, 3072
    s_add_u32 s46, s46, 74752
    v_add_u32 v5, s46, v2
    ds_read_b128 v[224:227], v5
    s_sub_u32 s46, s46, s81
    v_add_u32 v5, s46, v3
    s_mov_b64 exec, s[54:55]
    ds_read_b128 v[112:115], v5 offset:2048
    ds_read_b128 v[116:119], v5 offset:2560
    s_mov_b64 exec, -1
    s_waitcnt lgkmcnt(2)
    v_mfma_f32_32x32x16_bf16 v[48:63], v[224:227], v[8:11], 0
    s_nop 11
    v_exp_f32 v48, v48
    v_exp_f32 v49, v49
    v_exp_f32 v50, v50
    v_exp_f32 v51, v51
    v_exp_f32 v52, v52
    v_mfma_f32_32x32x16_bf16 v[64:79], v[224:227], v[12:15], 0
    s_waitcnt lgkmcnt(0)
    v_exp_f32 v53, v53
    v_exp_f32 v54, v54
    v_exp_f32 v55, v55
    v_exp_f32 v56, v56
    v_exp_f32 v57, v57
    v_smfmac_f32_32x32x32_bf16 v[16:31], v[112:115], v[48:55], v4
    v_exp_f32 v58, v58
    v_exp_f32 v59, v59
    v_exp_f32 v60, v60
    v_exp_f32 v61, v61
    v_exp_f32 v62, v62
    v_exp_f32 v63, v63
    v_exp_f32 v64, v64
    v_exp_f32 v65, v65
    v_smfmac_f32_32x32x32_bf16 v[16:31], v[116:119], v[56:63], v4
    v_exp_f32 v66, v66
    v_exp_f32 v67, v67
    v_exp_f32 v68, v68
    v_exp_f32 v69, v69
    v_exp_f32 v70, v70
    v_exp_f32 v71, v71
    v_exp_f32 v72, v72
    v_exp_f32 v73, v73
    v_smfmac_f32_32x32x32_bf16 v[32:47], v[112:115], v[64:71], v4
    s_setprio 3
    v_exp_f32 v74, v74
    v_exp_f32 v75, v75
    v_exp_f32 v76, v76
    v_exp_f32 v77, v77
    v_exp_f32 v78, v78
    v_exp_f32 v79, v79
    s_waitcnt vmcnt(6)
    v_mfma_f32_32x32x16_bf16 v[48:63], v[84:87], v[8:11], 0
    s_waitcnt vmcnt(5)
    s_mov_b64 exec, s[54:55]
    ds_read_b128 v[120:123], v3 offset:1024
    ds_read_b128 v[124:127], v3 offset:1536
    s_mov_b64 exec, -1
    s_nop 6
    v_exp_f32 v48, v48
    v_exp_f32 v49, v49
    v_smfmac_f32_32x32x32_bf16 v[32:47], v[116:119], v[72:79], v4
    s_waitcnt vmcnt(3)
    s_mov_b64 exec, s[54:55]
    ds_read_b128 v[112:115], v3 offset:2048
    ds_read_b128 v[116:119], v3 offset:2560
    s_mov_b64 exec, -1
    v_exp_f32 v50, v50
    v_exp_f32 v51, v51
    v_exp_f32 v52, v52
    v_mfma_f32_32x32x16_bf16 v[64:79], v[84:87], v[12:15], 0
    s_waitcnt lgkmcnt(2)
    v_exp_f32 v53, v53
    v_exp_f32 v54, v54
    v_exp_f32 v55, v55
    v_exp_f32 v56, v56
    v_exp_f32 v57, v57
    v_smfmac_f32_32x32x32_bf16 v[16:31], v[120:123], v[48:55], v4
    s_waitcnt vmcnt(0)
    v_cmp_ne_u32 vcc, s45, v254
    s_nop 0
    s_mov_b32 s71, vcc_lo
    s_and_b32 s50, s71, 0x10
    s_cbranch_scc1 L_kvw_92
L_kvb_93:
    s_add_u32 s46, s56, s57
    buffer_load_dwordx4 v[96:99], v2, s[4:7], s46 offen sc1
    v_exp_f32 v58, v58
    v_exp_f32 v59, v59
    v_exp_f32 v60, v60
    v_exp_f32 v61, v61
    v_exp_f32 v62, v62
    v_exp_f32 v63, v63
    v_exp_f32 v64, v64
    v_exp_f32 v65, v65
    v_smfmac_f32_32x32x32_bf16 v[16:31], v[124:127], v[56:63], v4
    s_add_u32 m0, s81, 3072
    s_add_u32 s57, s57, 4096
    buffer_load_dwordx4 v2, s[4:7], s46 offen offset:1024 sc1 lds
    v_exp_f32 v66, v66
    v_exp_f32 v67, v67
    v_exp_f32 v68, v68
    v_mfma_f32_32x32x16_bf16 v[48:63], v[88:91], v[8:11], 0
    s_and_b32 s57, s57, 0x1ffff
    v_exp_f32 v69, v69
    v_exp_f32 v70, v70
    v_exp_f32 v71, v71
    v_exp_f32 v72, v72
    v_exp_f32 v73, v73
    v_smfmac_f32_32x32x32_bf16 v[32:47], v[120:123], v[64:71], v4
    s_and_b32 s50, s71, 0x20
    s_cbranch_scc1 L_kvw_94
L_kvb_95:
    s_add_u32 s46, s56, s57
    buffer_load_dwordx4 v[100:103], v2, s[4:7], s46 offen sc1
    s_add_u32 m0, s81, 4096
    s_add_u32 s57, s57, 4096
    buffer_load_dwordx4 v2, s[4:7], s46 offen offset:1024 sc1 lds
    s_and_b32 s57, s57, 0x1ffff
    v_exp_f32 v74, v74
    v_exp_f32 v75, v75
    v_exp_f32 v76, v76
    v_exp_f32 v77, v77
    v_exp_f32 v78, v78
    v_exp_f32 v79, v79
    v_exp_f32 v48, v48
    v_exp_f32 v49, v49
    v_smfmac_f32_32x32x32_bf16 v[32:47], v[124:127], v[72:79], v4
    s_mov_b64 exec, s[54:55]
    ds_read_b128 v[120:123], v3 offset:3072
    ds_read_b128 v[124:127], v3 offset:3584
    s_mov_b64 exec, -1
    v_exp_f32 v50, v50
    v_exp_f32 v51, v51
    v_exp_f32 v52, v52
    v_mfma_f32_32x32x16_bf16 v[64:79], v[88:91], v[12:15], 0
    s_waitcnt lgkmcnt(2)
    v_exp_f32 v53, v53
    v_exp_f32 v54, v54
    v_exp_f32 v55, v55
    v_exp_f32 v56, v56
    v_exp_f32 v57, v57
    v_smfmac_f32_32x32x32_bf16 v[16:31], v[112:115], v[48:55], v4
    s_and_b32 s50, s71, 0x40
    s_cbranch_scc1 L_kvw_96
L_kvb_97:
    s_add_u32 s46, s56, s57
    buffer_load_dwordx4 v[104:107], v2, s[4:7], s46 offen sc1
    v_exp_f32 v58, v58
    v_exp_f32 v59, v59
    v_exp_f32 v60, v60
    v_exp_f32 v61, v61
    v_exp_f32 v62, v62
    v_exp_f32 v63, v63
    v_exp_f32 v64, v64
    v_exp_f32 v65, v65
    v_smfmac_f32_32x32x32_bf16 v[16:31], v[116:119], v[56:63], v4
    s_add_u32 m0, s81, 5120
    s_add_u32 s57, s57, 4096
    buffer_load_dwordx4 v2, s[4:7], s46 offen offset:1024 sc1 lds
    v_exp_f32 v66, v66
    v_exp_f32 v67, v67
    v_exp_f32 v68, v68
    v_mfma_f32_32x32x16_bf16 v[48:63], v[92:95], v[8:11], 0
    s_and_b32 s57, s57, 0x1ffff
    v_exp_f32 v69, v69
    v_exp_f32 v70, v70
    v_exp_f32 v71, v71
    v_exp_f32 v72, v72
    v_exp_f32 v73, v73
    v_smfmac_f32_32x32x32_bf16 v[32:47], v[112:115], v[64:71], v4
    s_and_b32 s50, s71, 0x80
    s_cbranch_scc1 L_kvw_98
L_kvb_99:
    s_add_u32 s46, s56, s57
    buffer_load_dwordx4 v[108:111], v2, s[4:7], s46 offen sc1
    s_add_u32 m0, s81, 6144
    s_add_u32 s57, s57, 4096
    buffer_load_dwordx4 v2, s[4:7], s46 offen offset:1024 sc1 lds
    s_and_b32 s57, s57, 0x1ffff
    v_exp_f32 v74, v74
    v_exp_f32 v75, v75
    v_exp_f32 v76, v76
    v_exp_f32 v77, v77
    v_exp_f32 v78, v78
    v_exp_f32 v79, v79
    v_exp_f32 v48, v48
    v_exp_f32 v49, v49
    v_smfmac_f32_32x32x32_bf16 v[32:47], v[116:119], v[72:79], v4
    s_waitcnt vmcnt(6)
    s_mov_b64 exec, s[54:55]
    ds_read_b128 v[112:115], v3 offset:4096
    ds_read_b128 v[116:119], v3 offset:4608
    s_mov_b64 exec, -1
    v_exp_f32 v50, v50
    v_exp_f32 v51, v51
    v_exp_f32 v52, v52
    v_mfma_f32_32x32x16_bf16 v[64:79], v[92:95], v[12:15], 0
    s_waitcnt lgkmcnt(2)
    v_exp_f32 v53, v53
    v_exp_f32 v54, v54
    v_exp_f32 v55, v55
    v_exp_f32 v56, v56
    v_exp_f32 v57, v57
    v_smfmac_f32_32x32x32_bf16 v[16:31], v[120:123], v[48:55], v4
    s_and_b32 s50, s71, 0x100
    s_cbranch_scc1 L_kvw_100
L_kvb_101:
    s_add_u32 s46, s56, s57
    buffer_load_dwordx4 v[80:83], v2, s[4:7], s46 offen sc1
    v_exp_f32 v58, v58
    v_exp_f32 v59, v59
    v_exp_f32 v60, v60
    v_exp_f32 v61, v61
    v_exp_f32 v62, v62
    v_exp_f32 v63, v63
    v_exp_f32 v64, v64
    v_exp_f32 v65, v65
    v_smfmac_f32_32x32x32_bf16 v[16:31], v[124:127], v[56:63], v4
    s_add_u32 m0, s81, -1024
    s_add_u32 s57, s57, 4096
    buffer_load_dwordx4 v2, s[4:7], s46 offen offset:1024 sc1 lds
    v_exp_f32 v66, v66
    v_exp_f32 v67, v67
    v_exp_f32 v68, v68
    v_mfma_f32_32x32x16_bf16 v[48:63], v[96:99], v[8:11], 0
    s_and_b32 s57, s57, 0x1ffff
    v_exp_f32 v69, v69
    v_exp_f32 v70, v70
    v_exp_f32 v71, v71
    v_exp_f32 v72, v72
    v_exp_f32 v73, v73
    v_smfmac_f32_32x32x32_bf16 v[32:47], v[120:123], v[64:71], v4
    s_and_b32 s50, s71, 0x200
    s_cbranch_scc1 L_kvw_102
L_kvb_103:
    s_add_u32 s46, s56, s57
    buffer_load_dwordx4 v[84:87], v2, s[4:7], s46 offen sc1
    s_add_u32 m0, s81, 0
    s_add_u32 s57, s57, 4096
    buffer_load_dwordx4 v2, s[4:7], s46 offen offset:1024 sc1 lds
    s_and_b32 s57, s57, 0x1ffff
    s_lshl_b32 s47, s44, 12
    s_add_u32 s47, s47, 98304
    buffer_load_dword v253, v252, s[4:7], s47 offen sc1
    v_exp_f32 v74, v74
    v_exp_f32 v75, v75
    v_exp_f32 v76, v76
    v_exp_f32 v77, v77
    v_exp_f32 v78, v78
    v_exp_f32 v79, v79
    v_exp_f32 v48, v48
    v_exp_f32 v49, v49
    v_smfmac_f32_32x32x32_bf16 v[32:47], v[124:127], v[72:79], v4
    s_waitcnt vmcnt(9)
    s_mov_b64 exec, s[54:55]
    ds_read_b128 v[120:123], v3 offset:5120
    ds_read_b128 v[124:127], v3 offset:5632
    s_mov_b64 exec, -1
    v_exp_f32 v50, v50
    v_exp_f32 v51, v51
    v_exp_f32 v52, v52
    v_mfma_f32_32x32x16_bf16 v[64:79], v[96:99], v[12:15], 0
    s_waitcnt lgkmcnt(2)
    v_exp_f32 v53, v53
    v_exp_f32 v54, v54
    v_exp_f32 v55, v55
    v_exp_f32 v56, v56
    v_exp_f32 v57, v57
    v_smfmac_f32_32x32x32_bf16 v[16:31], v[112:115], v[48:55], v4
    s_and_b32 s50, s71, 0x400
    s_cbranch_scc1 L_kvw_104
L_kvb_105:
    s_add_u32 s46, s56, s57
    buffer_load_dwordx4 v[88:91], v2, s[4:7], s46 offen sc1
    v_exp_f32 v58, v58
    v_exp_f32 v59, v59
    v_exp_f32 v60, v60
    v_exp_f32 v61, v61
    v_exp_f32 v62, v62
    v_exp_f32 v63, v63
    v_exp_f32 v64, v64
    v_exp_f32 v65, v65
    v_smfmac_f32_32x32x32_bf16 v[16:31], v[116:119], v[56:63], v4
    s_add_u32 m0, s81, 1024
    s_add_u32 s57, s57, 4096
    buffer_load_dwordx4 v2, s[4:7], s46 offen offset:1024 sc1 lds
    v_exp_f32 v66, v66
    v_exp_f32 v67, v67
    v_exp_f32 v68, v68
    v_mfma_f32_32x32x16_bf16 v[48:63], v[100:103], v[8:11], 0
    s_and_b32 s57, s57, 0x1ffff
    v_exp_f32 v69, v69
    v_exp_f32 v70, v70
    v_exp_f32 v71, v71
    v_exp_f32 v72, v72
    v_exp_f32 v73, v73
    v_smfmac_f32_32x32x32_bf16 v[32:47], v[112:115], v[64:71], v4
    s_waitcnt vmcnt(2)
    v_cmp_ne_u32 vcc, s45, v253
    s_nop 0
    s_cbranch_vccz L_f1bok_106
    s_mov_b32 s52, 400000
L_poll_f1b_107:
    buffer_load_dword v253, v252, s[4:7], s47 offen sc1
    s_sub_u32 s52, s52, 1
    s_cmp_eq_u32 s52, 0
    s_waitcnt vmcnt(0)
    s_cbranch_scc1 L_pdone_f1b_108
    v_cmp_ne_u32 vcc, s45, v253
    s_nop 0
    s_cbranch_vccnz L_poll_f1b_107
L_pdone_f1b_108:
L_f1bok_106:
    v_exp_f32 v74, v74
    v_exp_f32 v75, v75
    v_exp_f32 v76, v76
    v_exp_f32 v77, v77
    v_exp_f32 v78, v78
    v_exp_f32 v79, v79
    v_exp_f32 v48, v48
    v_exp_f32 v49, v49
    v_smfmac_f32_32x32x32_bf16 v[32:47], v[116:119], v[72:79], v4
    s_mov_b64 exec, s[54:55]
    ds_read_b128 v[112:115], v3 offset:6144
    ds_read_b128 v[116:119], v3 offset:6656
    s_mov_b64 exec, -1
    v_exp_f32 v50, v50
    v_exp_f32 v51, v51
    v_exp_f32 v52, v52
    v_mfma_f32_32x32x16_bf16 v[64:79], v[100:103], v[12:15], 0
    s_waitcnt lgkmcnt(2)
    v_exp_f32 v53, v53
    v_exp_f32 v54, v54
    v_exp_f32 v55, v55
    v_exp_f32 v56, v56
    v_exp_f32 v57, v57
    v_smfmac_f32_32x32x32_bf16 v[16:31], v[120:123], v[48:55], v4
    s_and_b32 s50, s71, 0x800
    s_cbranch_scc1 L_kvw_109
L_kvb_110:
    s_add_u32 s46, s56, s57
    buffer_load_dwordx4 v[92:95], v2, s[4:7], s46 offen sc1
    v_exp_f32 v58, v58
    v_exp_f32 v59, v59
    v_exp_f32 v60, v60
    v_exp_f32 v61, v61
    v_exp_f32 v62, v62
    v_exp_f32 v63, v63
    v_exp_f32 v64, v64
    v_exp_f32 v65, v65
    v_smfmac_f32_32x32x32_bf16 v[16:31], v[124:127], v[56:63], v4
    s_add_u32 m0, s81, 2048
    s_add_u32 s57, s57, 4096
    buffer_load_dwordx4 v2, s[4:7], s46 offen offset:1024 sc1 lds
    v_exp_f32 v66, v66
    v_exp_f32 v67, v67
    v_exp_f32 v68, v68
    v_mfma_f32_32x32x16_bf16 v[48:63], v[104:107], v[8:11], 0
    s_and_b32 s57, s57, 0x1ffff
    v_exp_f32 v69, v69
    v_exp_f32 v70, v70
    v_exp_f32 v71, v71
    v_exp_f32 v72, v72
    v_exp_f32 v73, v73
    v_smfmac_f32_32x32x32_bf16 v[32:47], v[120:123], v[64:71], v4
    buffer_load_dwordx4 v[128:131], v2, s[4:7], s59 offen offset:0 sc1
    buffer_load_dwordx4 v[132:135], v2, s[4:7], s59 offen offset:1024 sc1
    v_exp_f32 v74, v74
    v_exp_f32 v75, v75
    v_exp_f32 v76, v76
    v_exp_f32 v77, v77
    v_exp_f32 v78, v78
    v_exp_f32 v79, v79
    v_exp_f32 v48, v48
    v_exp_f32 v49, v49
    v_smfmac_f32_32x32x32_bf16 v[32:47], v[124:127], v[72:79], v4
    s_mov_b64 exec, s[54:55]
    ds_read_b128 v[120:123], v3 offset:7168
    ds_read_b128 v[124:127], v3 offset:7680
    s_mov_b64 exec, -1
    v_exp_f32 v50, v50
    v_exp_f32 v51, v51
    v_exp_f32 v52, v52
    v_mfma_f32_32x32x16_bf16 v[64:79], v[104:107], v[12:15], 0
    s_waitcnt lgkmcnt(2)
    v_exp_f32 v53, v53
    v_exp_f32 v54, v54
    v_exp_f32 v55, v55
    v_exp_f32 v56, v56
    v_exp_f32 v57, v57
    v_smfmac_f32_32x32x32_bf16 v[16:31], v[112:115], v[48:55], v4
    s_and_b32 s50, s71, 0xfffff000
    s_cbranch_scc1 L_kvw_111
L_kvb_112:
    s_add_u32 s46, s56, s57
    buffer_load_dwordx4 v[96:99], v2, s[4:7], s46 offen sc1
    v_exp_f32 v58, v58
    v_exp_f32 v59, v59
    v_exp_f32 v60, v60
    v_exp_f32 v61, v61
    v_exp_f32 v62, v62
    v_exp_f32 v63, v63
    v_exp_f32 v64, v64
    v_exp_f32 v65, v65
    v_smfmac_f32_32x32x32_bf16 v[16:31], v[116:119], v[56:63], v4
    s_add_u32 m0, s81, 3072
    s_add_u32 s57, s57, 4096
    buffer_load_dwordx4 v2, s[4:7], s46 offen offset:1024 sc1 lds
    v_exp_f32 v66, v66
    v_exp_f32 v67, v67
    v_exp_f32 v68, v68
    v_mfma_f32_32x32x16_bf16 v[48:63], v[108:111], v[8:11], 0
    s_and_b32 s57, s57, 0x1ffff
    v_exp_f32 v69, v69
    v_exp_f32 v70, v70
    v_exp_f32 v71, v71
    v_exp_f32 v72, v72
    v_exp_f32 v73, v73
    v_smfmac_f32_32x32x32_bf16 v[32:47], v[112:115], v[64:71], v4
    buffer_load_dwordx4 v[136:139], v2, s[4:7], s59 offen offset:2048 sc1
    v_exp_f32 v74, v74
    v_exp_f32 v75, v75
    v_exp_f32 v76, v76
    v_exp_f32 v77, v77
    v_exp_f32 v78, v78
    v_exp_f32 v79, v79
    v_exp_f32 v48, v48
    v_exp_f32 v49, v49
    v_smfmac_f32_32x32x32_bf16 v[32:47], v[116:119], v[72:79], v4
    s_mov_b64 exec, s[54:55]
    ds_read_b128 v[112:115], v3 offset:0
    ds_read_b128 v[116:119], v3 offset:512
    s_mov_b64 exec, -1
    v_exp_f32 v50, v50
    v_exp_f32 v51, v51
    v_exp_f32 v52, v52
    v_mfma_f32_32x32x16_bf16 v[64:79], v[108:111], v[12:15], 0
    s_waitcnt lgkmcnt(2)
    v_exp_f32 v53, v53
    v_exp_f32 v54, v54
    v_exp_f32 v55, v55
    v_exp_f32 v56, v56
    v_exp_f32 v57, v57
    v_smfmac_f32_32x32x32_bf16 v[16:31], v[120:123], v[48:55], v4
    s_add_u32 s46, s56, s57
    buffer_load_dwordx4 v[100:103], v2, s[4:7], s46 offen sc1
    v_exp_f32 v58, v58
    v_exp_f32 v59, v59
    v_exp_f32 v60, v60
    v_exp_f32 v61, v61
    v_exp_f32 v62, v62
    v_exp_f32 v63, v63
    v_exp_f32 v64, v64
    v_exp_f32 v65, v65
    v_smfmac_f32_32x32x32_bf16 v[16:31], v[124:127], v[56:63], v4
    s_add_u32 m0, s81, 4096
    s_add_u32 s57, s57, 4096
    buffer_load_dwordx4 v2, s[4:7], s46 offen offset:1024 sc1 lds
    v_exp_f32 v66, v66
    v_exp_f32 v67, v67
    v_exp_f32 v68, v68
    v_mfma_f32_32x32x16_bf16 v[48:63], v[80:83], v[8:11], 0
    s_and_b32 s57, s57, 0x1ffff
    v_exp_f32 v69, v69
    v_exp_f32 v70, v70
    v_exp_f32 v71, v71
    v_exp_f32 v72, v72
    v_exp_f32 v73, v73
    v_smfmac_f32_32x32x32_bf16 v[32:47], v[120:123], v[64:71], v4
    buffer_load_dwordx4 v[140:143], v2, s[4:7], s59 offen offset:3072 sc1
    v_exp_f32 v74, v74
    v_exp_f32 v75, v75
    v_exp_f32 v76, v76
    v_exp_f32 v77, v77
    v_exp_f32 v78, v78
    v_exp_f32 v79, v79
    v_exp_f32 v48, v48
    v_exp_f32 v49, v49
    v_smfmac_f32_32x32x32_bf16 v[32:47], v[124:127], v[72:79], v4
    s_mov_b64 exec, s[54:55]
    ds_read_b128 v[120:123], v3 offset:1024
    ds_read_b128 v[124:127], v3 offset:1536
    s_mov_b64 exec, -1
    v_exp_f32 v50, v50
    v_exp_f32 v51, v51
    v_exp_f32 v52, v52
    v_mfma_f32_32x32x16_bf16 v[64:79], v[80:83], v[12:15], 0
    s_waitcnt lgkmcnt(2)
    v_exp_f32 v53, v53
    v_exp_f32 v54, v54
    v_exp_f32 v55, v55
    v_exp_f32 v56, v56
    v_exp_f32 v57, v57
    v_smfmac_f32_32x32x32_bf16 v[16:31], v[112:115], v[48:55], v4
    s_add_u32 s46, s56, s57
    buffer_load_dwordx4 v[104:107], v2, s[4:7], s46 offen sc1
    v_exp_f32 v58, v58
    v_exp_f32 v59, v59
    v_exp_f32 v60, v60
    v_exp_f32 v61, v61
    v_exp_f32 v62, v62
    v_exp_f32 v63, v63
    v_exp_f32 v64, v64
    v_exp_f32 v65, v65
    v_smfmac_f32_32x32x32_bf16 v[16:31], v[116:119], v[56:63], v4
    s_add_u32 m0, s81, 5120
    s_add_u32 s57, s57, 4096
    buffer_load_dwordx4 v2, s[4:7], s46 offen offset:1024 sc1 lds
    v_exp_f32 v66, v66
    v_exp_f32 v67, v67
    v_exp_f32 v68, v68
    v_mfma_f32_32x32x16_bf16 v[48:63], v[84:87], v[8:11], 0
    s_and_b32 s57, s57, 0x1ffff
    v_exp_f32 v69, v69
    v_exp_f32 v70, v70
    v_exp_f32 v71, v71
    v_exp_f32 v72, v72
    v_exp_f32 v73, v73
    v_smfmac_f32_32x32x32_bf16 v[32:47], v[112:115], v[64:71], v4
    s_add_u32 s59, s59, 4096
    buffer_load_dwordx4 v[144:147], v2, s[4:7], s59 offen offset:0 sc1
    v_exp_f32 v74, v74
    v_exp_f32 v75, v75
    v_exp_f32 v76, v76
    v_exp_f32 v77, v77
    v_exp_f32 v78, v78
    v_exp_f32 v79, v79
    v_exp_f32 v48, v48
    v_exp_f32 v49, v49
    v_smfmac_f32_32x32x32_bf16 v[32:47], v[116:119], v[72:79], v4
    s_waitcnt vmcnt(13)
    s_mov_b64 exec, s[54:55]
    ds_read_b128 v[112:115], v3 offset:2048
    ds_read_b128 v[116:119], v3 offset:2560
    s_mov_b64 exec, -1
    v_exp_f32 v50, v50
    v_exp_f32 v51, v51
    v_exp_f32 v52, v52
    v_mfma_f32_32x32x16_bf16 v[64:79], v[84:87], v[12:15], 0
    s_waitcnt lgkmcnt(2)
    v_exp_f32 v53, v53
    v_exp_f32 v54, v54
    v_exp_f32 v55, v55
    v_exp_f32 v56, v56
    v_exp_f32 v57, v57
    v_smfmac_f32_32x32x32_bf16 v[16:31], v[120:123], v[48:55], v4
    s_add_u32 s46, s56, s57
    buffer_load_dwordx4 v[108:111], v2, s[4:7], s46 offen sc1
    v_exp_f32 v58, v58
    v_exp_f32 v59, v59
    v_exp_f32 v60, v60
    v_exp_f32 v61, v61
    v_exp_f32 v62, v62
    v_exp_f32 v63, v63
    v_exp_f32 v64, v64
    v_exp_f32 v65, v65
    v_smfmac_f32_32x32x32_bf16 v[16:31], v[124:127], v[56:63], v4
    s_add_u32 m0, s81, 6144
    s_add_u32 s57, s57, 4096
    buffer_load_dwordx4 v2, s[4:7], s46 offen offset:1024 sc1 lds
    v_exp_f32 v66, v66
    v_exp_f32 v67, v67
    v_exp_f32 v68, v68
    v_mfma_f32_32x32x16_bf16 v[48:63], v[88:91], v[8:11], 0
    s_and_b32 s57, s57, 0x1ffff
    v_exp_f32 v69, v69
    v_exp_f32 v70, v70
    v_exp_f32 v71, v71
    v_exp_f32 v72, v72
    v_exp_f32 v73, v73
    v_smfmac_f32_32x32x32_bf16 v[32:47], v[120:123], v[64:71], v4
    buffer_load_dwordx4 v[148:151], v2, s[4:7], s59 offen offset:1024 sc1
    v_exp_f32 v74, v74
    v_exp_f32 v75, v75
    v_exp_f32 v76, v76
    v_exp_f32 v77, v77
    v_exp_f32 v78, v78
    v_exp_f32 v79, v79
    v_exp_f32 v48, v48
    v_exp_f32 v49, v49
    v_smfmac_f32_32x32x32_bf16 v[32:47], v[124:127], v[72:79], v4
    s_waitcnt vmcnt(14)
    s_mov_b64 exec, s[54:55]
    ds_read_b128 v[120:123], v3 offset:3072
    ds_read_b128 v[124:127], v3 offset:3584
    s_mov_b64 exec, -1
    v_exp_f32 v50, v50
    v_exp_f32 v51, v51
    v_exp_f32 v52, v52
    v_mfma_f32_32x32x16_bf16 v[64:79], v[88:91], v[12:15], 0
    s_waitcnt lgkmcnt(2)
    v_exp_f32 v53, v53
    v_exp_f32 v54, v54
    v_exp_f32 v55, v55
    v_exp_f32 v56, v56
    v_exp_f32 v57, v57
    v_smfmac_f32_32x32x32_bf16 v[16:31], v[112:115], v[48:55], v4
    s_add_u32 s46, s56, s57
    buffer_load_dwordx4 v[80:83], v2, s[4:7], s46 offen sc1
    v_exp_f32 v58, v58
    v_exp_f32 v59, v59
    v_exp_f32 v60, v60
    v_exp_f32 v61, v61
    v_exp_f32 v62, v62
    v_exp_f32 v63, v63
    v_exp_f32 v64, v64
    v_exp_f32 v65, v65
    v_smfmac_f32_32x32x32_bf16 v[16:31], v[116:119], v[56:63], v4
    s_add_u32 m0, s81, -1024
    s_add_u32 s57, s57, 4096
    buffer_load_dwordx4 v2, s[4:7], s46 offen offset:1024 sc1 lds
    v_exp_f32 v66, v66
    v_exp_f32 v67, v67
    v_exp_f32 v68, v68
    v_mfma_f32_32x32x16_bf16 v[48:63], v[92:95], v[8:11], 0
    s_and_b32 s57, s57, 0x1ffff
    v_exp_f32 v69, v69
    v_exp_f32 v70, v70
    v_exp_f32 v71, v71
    v_exp_f32 v72, v72
    v_exp_f32 v73, v73
    v_smfmac_f32_32x32x32_bf16 v[32:47], v[112:115], v[64:71], v4
    buffer_load_dwordx4 v[152:155], v2, s[4:7], s59 offen offset:2048 sc1
    buffer_load_dwordx4 v[156:159], v2, s[4:7], s59 offen offset:3072 sc1
    v_exp_f32 v74, v74
    v_exp_f32 v75, v75
    v_exp_f32 v76, v76
    v_exp_f32 v77, v77
    v_exp_f32 v78, v78
    v_exp_f32 v79, v79
    v_exp_f32 v48, v48
    v_exp_f32 v49, v49
    v_smfmac_f32_32x32x32_bf16 v[32:47], v[116:119], v[72:79], v4
    s_waitcnt vmcnt(14)
    s_mov_b64 exec, s[54:55]
    ds_read_b128 v[112:115], v3 offset:4096
    ds_read_b128 v[116:119], v3 offset:4608
    s_mov_b64 exec, -1
    v_exp_f32 v50, v50
    v_exp_f32 v51, v51
    v_exp_f32 v52, v52
    v_mfma_f32_32x32x16_bf16 v[64:79], v[92:95], v[12:15], 0
    s_waitcnt lgkmcnt(2)
    v_exp_f32 v53, v53
    v_exp_f32 v54, v54
    v_exp_f32 v55, v55
    v_exp_f32 v56, v56
    v_exp_f32 v57, v57
    v_smfmac_f32_32x32x32_bf16 v[16:31], v[120:123], v[48:55], v4
    s_add_u32 s46, s56, s57
    buffer_load_dwordx4 v[84:87], v2, s[4:7], s46 offen sc1
    v_exp_f32 v58, v58
    v_exp_f32 v59, v59
    v_exp_f32 v60, v60
    v_exp_f32 v61, v61
    v_exp_f32 v62, v62
    v_exp_f32 v63, v63
    v_exp_f32 v64, v64
    v_exp_f32 v65, v65
    v_smfmac_f32_32x32x32_bf16 v[16:31], v[124:127], v[56:63], v4
    s_add_u32 m0, s81, 0
    s_add_u32 s57, s57, 4096
    buffer_load_dwordx4 v2, s[4:7], s46 offen offset:1024 sc1 lds
    v_exp_f32 v66, v66
    v_exp_f32 v67, v67
    v_exp_f32 v68, v68
    v_mfma_f32_32x32x16_bf16 v[48:63], v[96:99], v[8:11], 0
    s_and_b32 s57, s57, 0x1ffff
    v_exp_f32 v69, v69
    v_exp_f32 v70, v70
    v_exp_f32 v71, v71
    v_exp_f32 v72, v72
    v_exp_f32 v73, v73
    v_smfmac_f32_32x32x32_bf16 v[32:47], v[120:123], v[64:71], v4
    s_add_u32 s59, s59, 4096
    buffer_load_dwordx4 v[160:163], v2, s[4:7], s59 offen offset:0 sc1
    v_exp_f32 v74, v74
    v_exp_f32 v75, v75
    v_exp_f32 v76, v76
    v_exp_f32 v77, v77
    v_exp_f32 v78, v78
    v_exp_f32 v79, v79
    v_exp_f32 v48, v48
    v_exp_f32 v49, v49
    v_smfmac_f32_32x32x32_bf16 v[32:47], v[124:127], v[72:79], v4
    s_waitcnt vmcnt(14)
    s_mov_b64 exec, s[54:55]
    ds_read_b128 v[120:123], v3 offset:5120
    ds_read_b128 v[124:127], v3 offset:5632
    s_mov_b64 exec, -1
    v_exp_f32 v50, v50
    v_exp_f32 v51, v51
    v_exp_f32 v52, v52
    v_mfma_f32_32x32x16_bf16 v[64:79], v[96:99], v[12:15], 0
    s_waitcnt lgkmcnt(2)
    v_exp_f32 v53, v53
    v_exp_f32 v54, v54
    v_exp_f32 v55, v55
    v_exp_f32 v56, v56
    v_exp_f32 v57, v57
    v_smfmac_f32_32x32x32_bf16 v[16:31], v[112:115], v[48:55], v4
    s_add_u32 s46, s56, s57
    buffer_load_dwordx4 v[88:91], v2, s[4:7], s46 offen sc1
    v_exp_f32 v58, v58
    v_exp_f32 v59, v59
    v_exp_f32 v60, v60
    v_exp_f32 v61, v61
    v_exp_f32 v62, v62
    v_exp_f32 v63, v63
    v_exp_f32 v64, v64
    v_exp_f32 v65, v65
    v_smfmac_f32_32x32x32_bf16 v[16:31], v[116:119], v[56:63], v4
    s_add_u32 m0, s81, 1024
    s_add_u32 s57, s57, 4096
    buffer_load_dwordx4 v2, s[4:7], s46 offen offset:1024 sc1 lds
    v_exp_f32 v66, v66
    v_exp_f32 v67, v67
    v_exp_f32 v68, v68
    v_mfma_f32_32x32x16_bf16 v[48:63], v[100:103], v[8:11], 0
    s_and_b32 s57, s57, 0x1ffff
    v_exp_f32 v69, v69
    v_exp_f32 v70, v70
    v_exp_f32 v71, v71
    v_exp_f32 v72, v72
    v_exp_f32 v73, v73
    v_smfmac_f32_32x32x32_bf16 v[32:47], v[112:115], v[64:71], v4
    buffer_load_dwordx4 v[164:167], v2, s[4:7], s59 offen offset:1024 sc1
    v_exp_f32 v74, v74
    v_exp_f32 v75, v75
    v_exp_f32 v76, v76
    v_exp_f32 v77, v77
    v_exp_f32 v78, v78
    v_exp_f32 v79, v79
    v_exp_f32 v48, v48
    v_exp_f32 v49, v49
    v_smfmac_f32_32x32x32_bf16 v[32:47], v[116:119], v[72:79], v4
    s_waitcnt vmcnt(14)
    s_mov_b64 exec, s[54:55]
    ds_read_b128 v[112:115], v3 offset:6144
    ds_read_b128 v[116:119], v3 offset:6656
    s_mov_b64 exec, -1
    v_exp_f32 v50, v50
    v_exp_f32 v51, v51
    v_exp_f32 v52, v52
    v_mfma_f32_32x32x16_bf16 v[64:79], v[100:103], v[12:15], 0
    s_waitcnt lgkmcnt(2)
    v_exp_f32 v53, v53
    v_exp_f32 v54, v54
    v_exp_f32 v55, v55
    v_exp_f32 v56, v56
    v_exp_f32 v57, v57
    v_smfmac_f32_32x32x32_bf16 v[16:31], v[120:123], v[48:55], v4
    s_add_u32 s46, s56, s57
    buffer_load_dwordx4 v[92:95], v2, s[4:7], s46 offen sc1
    v_exp_f32 v58, v58
    v_exp_f32 v59, v59
    v_exp_f32 v60, v60
    v_exp_f32 v61, v61
    v_exp_f32 v62, v62
    v_exp_f32 v63, v63
    v_exp_f32 v64, v64
    v_exp_f32 v65, v65
    v_smfmac_f32_32x32x32_bf16 v[16:31], v[124:127], v[56:63], v4
    s_add_u32 m0, s81, 2048
    s_add_u32 s57, s57, 4096
    buffer_load_dwordx4 v2, s[4:7], s46 offen offset:1024 sc1 lds
    v_exp_f32 v66, v66
    v_exp_f32 v67, v67
    v_exp_f32 v68, v68
    v_mfma_f32_32x32x16_bf16 v[48:63], v[104:107], v[8:11], 0
    s_and_b32 s57, s57, 0x1ffff
    v_exp_f32 v69, v69
    v_exp_f32 v70, v70
    v_exp_f32 v71, v71
    v_exp_f32 v72, v72
    v_exp_f32 v73, v73
    v_smfmac_f32_32x32x32_bf16 v[32:47], v[120:123], v[64:71], v4
    buffer_load_dwordx4 v[168:171], v2, s[4:7], s59 offen offset:2048 sc1
    v_exp_f32 v74, v74
    v_exp_f32 v75, v75
    v_exp_f32 v76, v76
    v_exp_f32 v77, v77
    v_exp_f32 v78, v78
    v_exp_f32 v79, v79
    v_exp_f32 v48, v48
    v_exp_f32 v49, v49
    v_smfmac_f32_32x32x32_bf16 v[32:47], v[124:127], v[72:79], v4
    s_waitcnt vmcnt(14)
    s_mov_b64 exec, s[54:55]
    ds_read_b128 v[120:123], v3 offset:7168
    ds_read_b128 v[124:127], v3 offset:7680
    s_mov_b64 exec, -1
    v_exp_f32 v50, v50
    v_exp_f32 v51, v51
    v_exp_f32 v52, v52
    v_mfma_f32_32x32x16_bf16 v[64:79], v[104:107], v[12:15], 0
    s_waitcnt lgkmcnt(2)
    v_exp_f32 v53, v53
    v_exp_f32 v54, v54
    v_exp_f32 v55, v55
    v_exp_f32 v56, v56
    v_exp_f32 v57, v57
    v_smfmac_f32_32x32x32_bf16 v[16:31], v[112:115], v[48:55], v4
    s_add_u32 s46, s56, s57
    buffer_load_dwordx4 v[96:99], v2, s[4:7], s46 offen sc1
    v_exp_f32 v58, v58
    v_exp_f32 v59, v59
    v_exp_f32 v60, v60
    v_exp_f32 v61, v61
    v_exp_f32 v62, v62
    v_exp_f32 v63, v63
    v_exp_f32 v64, v64
    v_exp_f32 v65, v65
    v_smfmac_f32_32x32x32_bf16 v[16:31], v[116:119], v[56:63], v4
    s_add_u32 m0, s81, 3072
    s_add_u32 s57, s57, 4096
    buffer_load_dwordx4 v2, s[4:7], s46 offen offset:1024 sc1 lds
    v_exp_f32 v66, v66
    v_exp_f32 v67, v67
    v_exp_f32 v68, v68
    v_mfma_f32_32x32x16_bf16 v[48:63], v[108:111], v[8:11], 0
    s_and_b32 s57, s57, 0x1ffff
    v_exp_f32 v69, v69
    v_exp_f32 v70, v70
    v_exp_f32 v71, v71
    v_exp_f32 v72, v72
    v_exp_f32 v73, v73
    v_smfmac_f32_32x32x32_bf16 v[32:47], v[112:115], v[64:71], v4
    buffer_load_dwordx4 v[172:175], v2, s[4:7], s59 offen offset:3072 sc1
    v_exp_f32 v74, v74
    v_exp_f32 v75, v75
    v_exp_f32 v76, v76
    v_exp_f32 v77, v77
    v_exp_f32 v78, v78
    v_exp_f32 v79, v79
    v_exp_f32 v48, v48
    v_exp_f32 v49, v49
    v_smfmac_f32_32x32x32_bf16 v[32:47], v[116:119], v[72:79], v4
    s_waitcnt vmcnt(14)
    s_mov_b64 exec, s[54:55]
    ds_read_b128 v[112:115], v3 offset:0
    ds_read_b128 v[116:119], v3 offset:512
    s_mov_b64 exec, -1
    v_exp_f32 v50, v50
    v_exp_f32 v51, v51
    v_exp_f32 v52, v52
    v_mfma_f32_32x32x16_bf16 v[64:79], v[108:111], v[12:15], 0
    s_waitcnt lgkmcnt(2)
    v_exp_f32 v53, v53
    v_exp_f32 v54, v54
    v_exp_f32 v55, v55
    v_exp_f32 v56, v56
    v_exp_f32 v57, v57
    v_smfmac_f32_32x32x32_bf16 v[16:31], v[120:123], v[48:55], v4
    s_add_u32 s46, s56, s57
    buffer_load_dwordx4 v[100:103], v2, s[4:7], s46 offen sc1
    v_exp_f32 v58, v58
    v_exp_f32 v59, v59
    v_exp_f32 v60, v60
    v_exp_f32 v61, v61
    v_exp_f32 v62, v62
    v_exp_f32 v63, v63
    v_exp_f32 v64, v64
    v_exp_f32 v65, v65
    v_smfmac_f32_32x32x32_bf16 v[16:31], v[124:127], v[56:63], v4
    s_add_u32 m0, s81, 4096
    s_add_u32 s57, s57, 4096
    buffer_load_dwordx4 v2, s[4:7], s46 offen offset:1024 sc1 lds
    v_exp_f32 v66, v66
    v_exp_f32 v67, v67
    v_exp_f32 v68, v68
    v_mfma_f32_32x32x16_bf16 v[48:63], v[80:83], v[8:11], 0
    s_and_b32 s57, s57, 0x1ffff
    v_exp_f32 v69, v69
    v_exp_f32 v70, v70
    v_exp_f32 v71, v71
    v_exp_f32 v72, v72
    v_exp_f32 v73, v73
    v_smfmac_f32_32x32x32_bf16 v[32:47], v[120:123], v[64:71], v4
    s_add_u32 s59, s59, 4096
    buffer_load_dwordx4 v[176:179], v2, s[4:7], s59 offen offset:0 sc1
    buffer_load_dwordx4 v[180:183], v2, s[4:7], s59 offen offset:1024 sc1
    v_exp_f32 v74, v74
    v_exp_f32 v75, v75
    v_exp_f32 v76, v76
    v_exp_f32 v77, v77
    v_exp_f32 v78, v78
    v_exp_f32 v79, v79
    v_exp_f32 v48, v48
    v_exp_f32 v49, v49
    v_smfmac_f32_32x32x32_bf16 v[32:47], v[124:127], v[72:79], v4
    s_waitcnt vmcnt(14)
    s_mov_b64 exec, s[54:55]
    ds_read_b128 v[120:123], v3 offset:1024
    ds_read_b128 v[124:127], v3 offset:1536
    s_mov_b64 exec, -1
    v_exp_f32 v50, v50
    v_exp_f32 v51, v51
    v_exp_f32 v52, v52
    v_mfma_f32_32x32x16_bf16 v[64:79], v[80:83], v[12:15], 0
    s_waitcnt lgkmcnt(2)
    v_exp_f32 v53, v53
    v_exp_f32 v54, v54
    v_exp_f32 v55, v55
    v_exp_f32 v56, v56
    v_exp_f32 v57, v57
    v_smfmac_f32_32x32x32_bf16 v[16:31], v[112:115], v[48:55], v4
    s_add_u32 s46, s56, s57
    buffer_load_dwordx4 v[104:107], v2, s[4:7], s46 offen sc1
    v_exp_f32 v58, v58
    v_exp_f32 v59, v59
    v_exp_f32 v60, v60
    v_exp_f32 v61, v61
    v_exp_f32 v62, v62
    v_exp_f32 v63, v63
    v_exp_f32 v64, v64
    v_exp_f32 v65, v65
    v_smfmac_f32_32x32x32_bf16 v[16:31], v[116:119], v[56:63], v4
    s_add_u32 m0, s81, 5120
    s_add_u32 s57, s57, 4096
    buffer_load_dwordx4 v2, s[4:7], s46 offen offset:1024 sc1 lds
    v_exp_f32 v66, v66
    v_exp_f32 v67, v67
    v_exp_f32 v68, v68
    v_mfma_f32_32x32x16_bf16 v[48:63], v[84:87], v[8:11], 0
    s_and_b32 s57, s57, 0x1ffff
    v_exp_f32 v69, v69
    v_exp_f32 v70, v70
    v_exp_f32 v71, v71
    v_exp_f32 v72, v72
    v_exp_f32 v73, v73
    v_smfmac_f32_32x32x32_bf16 v[32:47], v[112:115], v[64:71], v4
    buffer_load_dwordx4 v[184:187], v2, s[4:7], s59 offen offset:2048 sc1
    v_exp_f32 v74, v74
    v_exp_f32 v75, v75
    v_exp_f32 v76, v76
    v_exp_f32 v77, v77
    v_exp_f32 v78, v78
    v_exp_f32 v79, v79
    v_exp_f32 v48, v48
    v_exp_f32 v49, v49
    v_smfmac_f32_32x32x32_bf16 v[32:47], v[116:119], v[72:79], v4
    s_waitcnt vmcnt(14)
    s_mov_b64 exec, s[54:55]
    ds_read_b128 v[112:115], v3 offset:2048
    ds_read_b128 v[116:119], v3 offset:2560
    s_mov_b64 exec, -1
    v_exp_f32 v50, v50
    v_exp_f32 v51, v51
    v_exp_f32 v52, v52
    v_mfma_f32_32x32x16_bf16 v[64:79], v[84:87], v[12:15], 0
    s_waitcnt lgkmcnt(2)
    v_exp_f32 v53, v53
    v_exp_f32 v54, v54
    v_exp_f32 v55, v55
    v_exp_f32 v56, v56
    v_exp_f32 v57, v57
    v_smfmac_f32_32x32x32_bf16 v[16:31], v[120:123], v[48:55], v4
    s_add_u32 s46, s56, s57
    buffer_load_dwordx4 v[108:111], v2, s[4:7], s46 offen sc1
    v_exp_f32 v58, v58
    v_exp_f32 v59, v59
    v_exp_f32 v60, v60
    v_exp_f32 v61, v61
    v_exp_f32 v62, v62
    v_exp_f32 v63, v63
    v_exp_f32 v64, v64
    v_exp_f32 v65, v65
    v_smfmac_f32_32x32x32_bf16 v[16:31], v[124:127], v[56:63], v4
    s_add_u32 m0, s81, 6144
    s_add_u32 s57, s57, 4096
    buffer_load_dwordx4 v2, s[4:7], s46 offen offset:1024 sc1 lds
    v_exp_f32 v66, v66
    v_exp_f32 v67, v67
    v_exp_f32 v68, v68
    v_mfma_f32_32x32x16_bf16 v[48:63], v[88:91], v[8:11], 0
    s_and_b32 s57, s57, 0x1ffff
    v_exp_f32 v69, v69
    v_exp_f32 v70, v70
    v_exp_f32 v71, v71
    v_exp_f32 v72, v72
    v_exp_f32 v73, v73
    v_smfmac_f32_32x32x32_bf16 v[32:47], v[120:123], v[64:71], v4
    buffer_load_dwordx4 v[188:191], v2, s[4:7], s59 offen offset:3072 sc1
    v_exp_f32 v74, v74
    v_exp_f32 v75, v75
    v_exp_f32 v76, v76
    v_exp_f32 v77, v77
    v_exp_f32 v78, v78
    v_exp_f32 v79, v79
    v_exp_f32 v48, v48
    v_exp_f32 v49, v49
    v_smfmac_f32_32x32x32_bf16 v[32:47], v[124:127], v[72:79], v4
    s_waitcnt vmcnt(14)
    s_mov_b64 exec, s[54:55]
    ds_read_b128 v[120:123], v3 offset:3072
    ds_read_b128 v[124:127], v3 offset:3584
    s_mov_b64 exec, -1
    v_exp_f32 v50, v50
    v_exp_f32 v51, v51
    v_exp_f32 v52, v52
    v_mfma_f32_32x32x16_bf16 v[64:79], v[88:91], v[12:15], 0
    s_waitcnt lgkmcnt(2)
    v_exp_f32 v53, v53
    v_exp_f32 v54, v54
    v_exp_f32 v55, v55
    v_exp_f32 v56, v56
    v_exp_f32 v57, v57
    v_smfmac_f32_32x32x32_bf16 v[16:31], v[112:115], v[48:55], v4
    s_add_u32 s46, s56, s57
    buffer_load_dwordx4 v[80:83], v2, s[4:7], s46 offen sc1
    v_exp_f32 v58, v58
    v_exp_f32 v59, v59
    v_exp_f32 v60, v60
    v_exp_f32 v61, v61
    v_exp_f32 v62, v62
    v_exp_f32 v63, v63
    v_exp_f32 v64, v64
    v_exp_f32 v65, v65
    v_smfmac_f32_32x32x32_bf16 v[16:31], v[116:119], v[56:63], v4
    s_add_u32 m0, s81, -1024
    s_add_u32 s57, s57, 4096
    buffer_load_dwordx4 v2, s[4:7], s46 offen offset:1024 sc1 lds
    v_exp_f32 v66, v66
    v_exp_f32 v67, v67
    v_exp_f32 v68, v68
    v_mfma_f32_32x32x16_bf16 v[48:63], v[92:95], v[8:11], 0
    s_and_b32 s57, s57, 0x1ffff
    v_exp_f32 v69, v69
    v_exp_f32 v70, v70
    v_exp_f32 v71, v71
    v_exp_f32 v72, v72
    v_exp_f32 v73, v73
    v_smfmac_f32_32x32x32_bf16 v[32:47], v[112:115], v[64:71], v4
    s_add_u32 s59, s59, 53248
    buffer_load_dwordx4 v[192:195], v2, s[4:7], s59 offen offset:0 sc1
    v_exp_f32 v74, v74
    v_exp_f32 v75, v75
    v_exp_f32 v76, v76
    v_exp_f32 v77, v77
    v_exp_f32 v78, v78
    v_exp_f32 v79, v79
    v_exp_f32 v48, v48
    v_exp_f32 v49, v49
    v_smfmac_f32_32x32x32_bf16 v[32:47], v[116:119], v[72:79], v4
    s_waitcnt vmcnt(14)
    s_mov_b64 exec, s[54:55]
    ds_read_b128 v[112:115], v3 offset:4096
    ds_read_b128 v[116:119], v3 offset:4608
    s_mov_b64 exec, -1
    v_exp_f32 v50, v50
    v_exp_f32 v51, v51
    v_exp_f32 v52, v52
    v_mfma_f32_32x32x16_bf16 v[64:79], v[92:95], v[12:15], 0
    s_waitcnt lgkmcnt(2)
    v_exp_f32 v53, v53
    v_exp_f32 v54, v54
    v_exp_f32 v55, v55
    v_exp_f32 v56, v56
    v_exp_f32 v57, v57
    v_smfmac_f32_32x32x32_bf16 v[16:31], v[120:123], v[48:55], v4
    s_add_u32 s46, s56, s57
    buffer_load_dwordx4 v[84:87], v2, s[4:7], s46 offen sc1
    v_exp_f32 v58, v58
    v_exp_f32 v59, v59
    v_exp_f32 v60, v60
    v_exp_f32 v61, v61
    v_exp_f32 v62, v62
    v_exp_f32 v63, v63
    v_exp_f32 v64, v64
    v_exp_f32 v65, v65
    v_smfmac_f32_32x32x32_bf16 v[16:31], v[124:127], v[56:63], v4
    s_add_u32 m0, s81, 0
    s_add_u32 s57, s57, 4096
    buffer_load_dwordx4 v2, s[4:7], s46 offen offset:1024 sc1 lds
    v_exp_f32 v66, v66
    v_exp_f32 v67, v67
    v_exp_f32 v68, v68
    v_mfma_f32_32x32x16_bf16 v[48:63], v[96:99], v[8:11], 0
    s_and_b32 s57, s57, 0x1ffff
    v_exp_f32 v69, v69
    v_exp_f32 v70, v70
    v_exp_f32 v71, v71
    v_exp_f32 v72, v72
    v_exp_f32 v73, v73
    v_smfmac_f32_32x32x32_bf16 v[32:47], v[120:123], v[64:71], v4
    buffer_load_dwordx4 v[196:199], v2, s[4:7], s59 offen offset:1024 sc1
    v_exp_f32 v74, v74
    v_exp_f32 v75, v75
    v_exp_f32 v76, v76
    v_exp_f32 v77, v77
    v_exp_f32 v78, v78
    v_exp_f32 v79, v79
    v_exp_f32 v48, v48
    v_exp_f32 v49, v49
    v_smfmac_f32_32x32x32_bf16 v[32:47], v[124:127], v[72:79], v4
    s_waitcnt vmcnt(14)
    s_mov_b64 exec, s[54:55]
    ds_read_b128 v[120:123], v3 offset:5120
    ds_read_b128 v[124:127], v3 offset:5632
    s_mov_b64 exec, -1
    v_exp_f32 v50, v50
    v_exp_f32 v51, v51
    v_exp_f32 v52, v52
    v_mfma_f32_32x32x16_bf16 v[64:79], v[96:99], v[12:15], 0
    s_waitcnt lgkmcnt(2)
    v_exp_f32 v53, v53
    v_exp_f32 v54, v54
    v_exp_f32 v55, v55
    v_exp_f32 v56, v56
    v_exp_f32 v57, v57
    v_smfmac_f32_32x32x32_bf16 v[16:31], v[112:115], v[48:55], v4
    s_add_u32 s46, s56, s57
    buffer_load_dwordx4 v[88:91], v2, s[4:7], s46 offen sc1
    v_exp_f32 v58, v58
    v_exp_f32 v59, v59
    v_exp_f32 v60, v60
    v_exp_f32 v61, v61
    v_exp_f32 v62, v62
    v_exp_f32 v63, v63
    v_exp_f32 v64, v64
    v_exp_f32 v65, v65
    v_smfmac_f32_32x32x32_bf16 v[16:31], v[116:119], v[56:63], v4
    s_add_u32 m0, s81, 1024
    s_add_u32 s57, s57, 4096
    buffer_load_dwordx4 v2, s[4:7], s46 offen offset:1024 sc1 lds
    v_exp_f32 v66, v66
    v_exp_f32 v67, v67
    v_exp_f32 v68, v68
    v_mfma_f32_32x32x16_bf16 v[48:63], v[100:103], v[8:11], 0
    s_and_b32 s57, s57, 0x1ffff
    v_exp_f32 v69, v69
    v_exp_f32 v70, v70
    v_exp_f32 v71, v71
    v_exp_f32 v72, v72
    v_exp_f32 v73, v73
    v_smfmac_f32_32x32x32_bf16 v[32:47], v[112:115], v[64:71], v4
    s_sub_u32 s49, s40, 4
    s_lshl_b32 s88, s49, 10
    s_add_u32 s88, s88, 18094080
    s_cmp_ge_u32 s40, 6
    s_cselect_b32 s82, 1.0, 0
    s_lshl_b32 s89, s49, 13
    s_add_u32 s89, s89, 24576
    s_add_u32 m0, s89, 0
    s_add_u32 s50, s88, 0
    buffer_load_dwordx4 v2, s[4:7], s50 offen sc1 lds
    buffer_load_dwordx4 v[200:203], v2, s[4:7], s59 offen offset:2048 sc1
    v_exp_f32 v74, v74
    v_exp_f32 v75, v75
    v_exp_f32 v76, v76
    v_exp_f32 v77, v77
    v_exp_f32 v78, v78
    v_exp_f32 v79, v79
    v_exp_f32 v48, v48
    v_exp_f32 v49, v49
    v_smfmac_f32_32x32x32_bf16 v[32:47], v[116:119], v[72:79], v4
    s_waitcnt vmcnt(14)
    s_mov_b64 exec, s[54:55]
    ds_read_b128 v[112:115], v3 offset:6144
    ds_read_b128 v[116:119], v3 offset:6656
    s_mov_b64 exec, -1
    v_exp_f32 v50, v50
    v_exp_f32 v51, v51
    v_exp_f32 v52, v52
    v_mfma_f32_32x32x16_bf16 v[64:79], v[100:103], v[12:15], 0
    s_waitcnt lgkmcnt(2)
    v_exp_f32 v53, v53
    v_exp_f32 v54, v54
    v_exp_f32 v55, v55
    v_exp_f32 v56, v56
    v_exp_f32 v57, v57
    v_smfmac_f32_32x32x32_bf16 v[16:31], v[120:123], v[48:55], v4
    s_add_u32 s46, s56, s57
    buffer_load_dwordx4 v[92:95], v2, s[4:7], s46 offen sc1
    v_exp_f32 v58, v58
    v_exp_f32 v59, v59
    v_exp_f32 v60, v60
    v_exp_f32 v61, v61
    v_exp_f32 v62, v62
    v_exp_f32 v63, v63
    v_exp_f32 v64, v64
    v_exp_f32 v65, v65
    v_smfmac_f32_32x32x32_bf16 v[16:31], v[124:127], v[56:63], v4
    s_add_u32 m0, s81, 2048
    s_add_u32 s57, s57, 4096
    buffer_load_dwordx4 v2, s[4:7], s46 offen offset:1024 sc1 lds
    v_exp_f32 v66, v66
    v_exp_f32 v67, v67
    v_exp_f32 v68, v68
    v_mfma_f32_32x32x16_bf16 v[48:63], v[104:107], v[8:11], 0
    s_and_b32 s57, s57, 0x1ffff
    v_exp_f32 v69, v69
    v_exp_f32 v70, v70
    v_exp_f32 v71, v71
    v_exp_f32 v72, v72
    v_exp_f32 v73, v73
    v_smfmac_f32_32x32x32_bf16 v[32:47], v[120:123], v[64:71], v4
    s_add_u32 m0, s89, 1024
    s_add_u32 s50, s88, 12288
    buffer_load_dwordx4 v2, s[4:7], s50 offen sc1 lds
    buffer_load_dwordx4 v[204:207], v2, s[4:7], s59 offen offset:3072 sc1
    s_add_u32 s59, s59, 4096
    buffer_load_dwordx4 v[208:211], v2, s[4:7], s59 offen offset:0 sc1
    v_exp_f32 v74, v74
    v_exp_f32 v75, v75
    v_exp_f32 v76, v76
    v_exp_f32 v77, v77
    v_exp_f32 v78, v78
    v_exp_f32 v79, v79
    v_exp_f32 v48, v48
    v_exp_f32 v49, v49
    v_smfmac_f32_32x32x32_bf16 v[32:47], v[124:127], v[72:79], v4
    s_waitcnt vmcnt(16)
    s_mov_b64 exec, s[54:55]
    ds_read_b128 v[120:123], v3 offset:7168
    ds_read_b128 v[124:127], v3 offset:7680
    s_mov_b64 exec, -1
    v_exp_f32 v50, v50
    v_exp_f32 v51, v51
    v_exp_f32 v52, v52
    v_mfma_f32_32x32x16_bf16 v[64:79], v[104:107], v[12:15], 0
    s_waitcnt lgkmcnt(2)
    v_exp_f32 v53, v53
    v_exp_f32 v54, v54
    v_exp_f32 v55, v55
    v_exp_f32 v56, v56
    v_exp_f32 v57, v57
    v_smfmac_f32_32x32x32_bf16 v[16:31], v[112:115], v[48:55], v4
    s_add_u32 s46, s56, s57
    buffer_load_dwordx4 v[96:99], v2, s[4:7], s46 offen sc1
    v_exp_f32 v58, v58
    v_exp_f32 v59, v59
    v_exp_f32 v60, v60
    v_exp_f32 v61, v61
    v_exp_f32 v62, v62
    v_exp_f32 v63, v63
    v_exp_f32 v64, v64
    v_exp_f32 v65, v65
    v_smfmac_f32_32x32x32_bf16 v[16:31], v[116:119], v[56:63], v4
    s_add_u32 m0, s81, 3072
    s_add_u32 s57, s57, 4096
    buffer_load_dwordx4 v2, s[4:7], s46 offen offset:1024 sc1 lds
    v_exp_f32 v66, v66
    v_exp_f32 v67, v67
    v_exp_f32 v68, v68
    v_mfma_f32_32x32x16_bf16 v[48:63], v[108:111], v[8:11], 0
    s_and_b32 s57, s57, 0x1ffff
    v_exp_f32 v69, v69
    v_exp_f32 v70, v70
    v_exp_f32 v71, v71
    v_exp_f32 v72, v72
    v_exp_f32 v73, v73
    v_smfmac_f32_32x32x32_bf16 v[32:47], v[112:115], v[64:71], v4
    s_setprio 2
    s_add_u32 m0, s89, 2048
    s_add_u32 s50, s88, 24576
    buffer_load_dwordx4 v2, s[4:7], s50 offen sc1 lds
    buffer_load_dwordx4 v[212:215], v2, s[4:7], s59 offen offset:1024 sc1
    v_exp_f32 v74, v74
    v_exp_f32 v75, v75
    v_exp_f32 v76, v76
    v_exp_f32 v77, v77
    v_exp_f32 v78, v78
    v_exp_f32 v79, v79
    v_exp_f32 v48, v48
    v_exp_f32 v49, v49
    v_smfmac_f32_32x32x32_bf16 v[32:47], v[116:119], v[72:79], v4
    s_waitcnt vmcnt(17)
    s_mov_b64 exec, s[54:55]
    ds_read_b128 v[112:115], v3 offset:0
    ds_read_b128 v[116:119], v3 offset:512
    s_mov_b64 exec, -1
    v_exp_f32 v50, v50
    v_exp_f32 v51, v51
    v_exp_f32 v52, v52
    v_mfma_f32_32x32x16_bf16 v[64:79], v[108:111], v[12:15], 0
    s_waitcnt lgkmcnt(2)
    v_exp_f32 v53, v53
    v_exp_f32 v54, v54
    v_exp_f32 v55, v55
    v_exp_f32 v56, v56
    v_exp_f32 v57, v57
    v_smfmac_f32_32x32x32_bf16 v[16:31], v[120:123], v[48:55], v4
    s_add_u32 s46, s56, s57
    buffer_load_dwordx4 v[100:103], v2, s[4:7], s46 offen sc1
    v_exp_f32 v58, v58
    v_exp_f32 v59, v59
    v_exp_f32 v60, v60
    v_exp_f32 v61, v61
    v_exp_f32 v62, v62
    v_exp_f32 v63, v63
    v_exp_f32 v64, v64
    v_exp_f32 v65, v65
    v_smfmac_f32_32x32x32_bf16 v[16:31], v[124:127], v[56:63], v4
    s_add_u32 m0, s81, 4096
    s_add_u32 s57, s57, 4096
    buffer_load_dwordx4 v2, s[4:7], s46 offen offset:1024 sc1 lds
    v_exp_f32 v66, v66
    v_exp_f32 v67, v67
    v_exp_f32 v68, v68
    v_mfma_f32_32x32x16_bf16 v[48:63], v[80:83], v[8:11], 0
    s_and_b32 s57, s57, 0x1ffff
    v_exp_f32 v69, v69
    v_exp_f32 v70, v70
    v_exp_f32 v71, v71
    v_exp_f32 v72, v72
    v_exp_f32 v73, v73
    v_smfmac_f32_32x32x32_bf16 v[32:47], v[120:123], v[64:71], v4
    s_add_u32 m0, s89, 3072
    s_add_u32 s50, s88, 36864
    buffer_load_dwordx4 v2, s[4:7], s50 offen sc1 lds
    buffer_load_dwordx4 v[216:219], v2, s[4:7], s59 offen offset:2048 sc1
    v_exp_f32 v74, v74
    v_exp_f32 v75, v75
    v_exp_f32 v76, v76
    v_exp_f32 v77, v77
    v_exp_f32 v78, v78
    v_exp_f32 v79, v79
    v_exp_f32 v48, v48
    v_exp_f32 v49, v49
    v_smfmac_f32_32x32x32_bf16 v[32:47], v[124:127], v[72:79], v4
    s_waitcnt vmcnt(18)
    s_mov_b64 exec, s[54:55]
    ds_read_b128 v[120:123], v3 offset:1024
    ds_read_b128 v[124:127], v3 offset:1536
    s_mov_b64 exec, -1
    v_exp_f32 v50, v50
    v_exp_f32 v51, v51
    v_exp_f32 v52, v52
    v_mfma_f32_32x32x16_bf16 v[64:79], v[80:83], v[12:15], 0
    s_waitcnt lgkmcnt(2)
    v_exp_f32 v53, v53
    v_exp_f32 v54, v54
    v_exp_f32 v55, v55
    v_exp_f32 v56, v56
    v_exp_f32 v57, v57
    v_smfmac_f32_32x32x32_bf16 v[16:31], v[112:115], v[48:55], v4
    s_add_u32 s46, s56, s57
    buffer_load_dwordx4 v[104:107], v2, s[4:7], s46 offen sc1
    s_add_u32 s50, s68, 0
    buffer_load_dwordx4 v[80:83], v7, s[4:7], s50 offen offset:3072 sc1
    v_exp_f32 v58, v58
    v_exp_f32 v59, v59
    v_exp_f32 v60, v60
    v_exp_f32 v61, v61
    v_exp_f32 v62, v62
    v_exp_f32 v63, v63
    v_exp_f32 v64, v64
    v_exp_f32 v65, v65
    v_smfmac_f32_32x32x32_bf16 v[16:31], v[116:119], v[56:63], v4
    s_add_u32 m0, s81, 5120
    s_add_u32 s57, s57, 4096
    buffer_load_dwordx4 v2, s[4:7], s46 offen offset:1024 sc1 lds
    v_exp_f32 v66, v66
    v_exp_f32 v67, v67
    v_exp_f32 v68, v68
    v_mfma_f32_32x32x16_bf16 v[48:63], v[84:87], v[8:11], 0
    s_and_b32 s57, s57, 0x1ffff
    v_exp_f32 v69, v69
    v_exp_f32 v70, v70
    v_exp_f32 v71, v71
    v_exp_f32 v72, v72
    v_exp_f32 v73, v73
    v_smfmac_f32_32x32x32_bf16 v[32:47], v[112:115], v[64:71], v4
    s_add_u32 m0, s89, 4096
    s_add_u32 s50, s88, 49152
    buffer_load_dwordx4 v2, s[4:7], s50 offen sc1 lds
    buffer_load_dwordx4 v[220:223], v2, s[4:7], s59 offen offset:3072 sc1
    v_exp_f32 v74, v74
    v_exp_f32 v75, v75
    v_exp_f32 v76, v76
    v_exp_f32 v77, v77
    v_exp_f32 v78, v78
    v_exp_f32 v79, v79
    v_exp_f32 v48, v48
    v_exp_f32 v49, v49
    v_smfmac_f32_32x32x32_bf16 v[32:47], v[116:119], v[72:79], v4
    s_waitcnt vmcnt(20)
    s_mov_b64 exec, s[54:55]
    ds_read_b128 v[112:115], v3 offset:2048
    ds_read_b128 v[116:119], v3 offset:2560
    s_mov_b64 exec, -1
    v_exp_f32 v50, v50
    v_exp_f32 v51, v51
    v_exp_f32 v52, v52
    v_mfma_f32_32x32x16_bf16 v[64:79], v[84:87], v[12:15], 0
    s_waitcnt lgkmcnt(2)
    v_exp_f32 v53, v53
    v_exp_f32 v54, v54
    v_exp_f32 v55, v55
    v_exp_f32 v56, v56
    v_exp_f32 v57, v57
    v_smfmac_f32_32x32x32_bf16 v[16:31], v[120:123], v[48:55], v4
    s_add_u32 s46, s56, s57
    buffer_load_dwordx4 v[108:111], v2, s[4:7], s46 offen sc1
    s_add_u32 s50, s68, 4096
    buffer_load_dwordx4 v[84:87], v7, s[4:7], s50 offen offset:3072 sc1
    v_exp_f32 v58, v58
    v_exp_f32 v59, v59
    v_exp_f32 v60, v60
    v_exp_f32 v61, v61
    v_exp_f32 v62, v62
    v_exp_f32 v63, v63
    v_exp_f32 v64, v64
    v_exp_f32 v65, v65
    v_smfmac_f32_32x32x32_bf16 v[16:31], v[124:127], v[56:63], v4
    s_add_u32 m0, s81, 6144
    s_add_u32 s57, s57, 4096
    buffer_load_dwordx4 v2, s[4:7], s46 offen offset:1024 sc1 lds
    v_exp_f32 v66, v66
    v_exp_f32 v67, v67
    v_exp_f32 v68, v68
    v_mfma_f32_32x32x16_bf16 v[48:63], v[88:91], v[8:11], 0
    s_and_b32 s57, s57, 0x1ffff
    v_exp_f32 v69, v69
    v_exp_f32 v70, v70
    v_exp_f32 v71, v71
    v_exp_f32 v72, v72
    v_exp_f32 v73, v73
    v_smfmac_f32_32x32x32_bf16 v[32:47], v[120:123], v[64:71], v4
    s_add_u32 m0, s89, 5120
    s_add_u32 s50, s88, 61440
    buffer_load_dwordx4 v2, s[4:7], s50 offen sc1 lds
    s_add_u32 s59, s59, 4096
    buffer_load_dwordx4 v[224:227], v2, s[4:7], s59 offen offset:0 sc1
    v_exp_f32 v74, v74
    v_exp_f32 v75, v75
    v_exp_f32 v76, v76
    v_exp_f32 v77, v77
    v_exp_f32 v78, v78
    v_exp_f32 v79, v79
    v_exp_f32 v48, v48
    v_exp_f32 v49, v49
    v_smfmac_f32_32x32x32_bf16 v[32:47], v[124:127], v[72:79], v4
    s_waitcnt vmcnt(21)
    s_mov_b64 exec, s[54:55]
    ds_read_b128 v[120:123], v3 offset:3072
    ds_read_b128 v[124:127], v3 offset:3584
    s_mov_b64 exec, -1
    v_exp_f32 v50, v50
    v_exp_f32 v51, v51
    v_exp_f32 v52, v52
    v_mfma_f32_32x32x16_bf16 v[64:79], v[88:91], v[12:15], 0
    s_waitcnt lgkmcnt(2)
    v_exp_f32 v53, v53
    v_exp_f32 v54, v54
    v_exp_f32 v55, v55
    v_exp_f32 v56, v56
    v_exp_f32 v57, v57
    v_smfmac_f32_32x32x32_bf16 v[16:31], v[112:115], v[48:55], v4
    s_add_u32 s50, s68, 8192
    buffer_load_dwordx4 v[88:91], v7, s[4:7], s50 offen offset:3072 sc1
    v_exp_f32 v58, v58
    v_exp_f32 v59, v59
    v_exp_f32 v60, v60
    v_exp_f32 v61, v61
    v_exp_f32 v62, v62
    v_exp_f32 v63, v63
    v_exp_f32 v64, v64
    v_exp_f32 v65, v65
    v_smfmac_f32_32x32x32_bf16 v[16:31], v[116:119], v[56:63], v4
    buffer_load_dwordx4 v[228:231], v2, s[4:7], s59 offen offset:1024 sc1
    v_exp_f32 v66, v66
    v_exp_f32 v67, v67
    v_exp_f32 v68, v68
    v_mfma_f32_32x32x16_bf16 v[48:63], v[92:95], v[8:11], 0
    v_exp_f32 v69, v69
    v_exp_f32 v70, v70
    v_exp_f32 v71, v71
    v_exp_f32 v72, v72
    v_exp_f32 v73, v73
    v_smfmac_f32_32x32x32_bf16 v[32:47], v[112:115], v[64:71], v4
    s_add_u32 m0, s89, 6144
    s_add_u32 s50, s88, 73728
    buffer_load_dwordx4 v2, s[4:7], s50 offen sc1 lds
    buffer_load_dwordx4 v[232:235], v2, s[4:7], s59 offen offset:2048 sc1
    v_exp_f32 v74, v74
    v_exp_f32 v75, v75
    v_exp_f32 v76, v76
    v_exp_f32 v77, v77
    v_exp_f32 v78, v78
    v_exp_f32 v79, v79
    v_exp_f32 v48, v48
    v_exp_f32 v49, v49
    v_smfmac_f32_32x32x32_bf16 v[32:47], v[116:119], v[72:79], v4
    s_waitcnt vmcnt(20)
    s_mov_b64 exec, s[54:55]
    ds_read_b128 v[112:115], v3 offset:4096
    ds_read_b128 v[116:119], v3 offset:4608
    s_mov_b64 exec, -1
    v_exp_f32 v50, v50
    v_exp_f32 v51, v51
    v_exp_f32 v52, v52
    v_mfma_f32_32x32x16_bf16 v[64:79], v[92:95], v[12:15], 0
    s_waitcnt lgkmcnt(2)
    v_exp_f32 v53, v53
    v_exp_f32 v54, v54
    v_exp_f32 v55, v55
    v_exp_f32 v56, v56
    v_exp_f32 v57, v57
    v_smfmac_f32_32x32x32_bf16 v[16:31], v[120:123], v[48:55], v4
    s_add_u32 s50, s68, 12288
    buffer_load_dwordx4 v[92:95], v7, s[4:7], s50 offen offset:3072 sc1
    v_exp_f32 v58, v58
    v_exp_f32 v59, v59
    v_exp_f32 v60, v60
    v_exp_f32 v61, v61
    v_exp_f32 v62, v62
    v_exp_f32 v63, v63
    v_exp_f32 v64, v64
    v_exp_f32 v65, v65
    v_smfmac_f32_32x32x32_bf16 v[16:31], v[124:127], v[56:63], v4
    v_exp_f32 v66, v66
    v_exp_f32 v67, v67
    v_exp_f32 v68, v68
    v_mfma_f32_32x32x16_bf16 v[48:63], v[96:99], v[8:11], 0
    v_exp_f32 v69, v69
    v_exp_f32 v70, v70
    v_exp_f32 v71, v71
    v_exp_f32 v72, v72
    v_exp_f32 v73, v73
    v_smfmac_f32_32x32x32_bf16 v[32:47], v[120:123], v[64:71], v4
    s_add_u32 m0, s89, 7168
    s_add_u32 s50, s88, 86016
    buffer_load_dwordx4 v2, s[4:7], s50 offen sc1 lds
    buffer_load_dwordx4 v[236:239], v2, s[4:7], s59 offen offset:3072 sc1
    v_exp_f32 v74, v74
    v_exp_f32 v75, v75
    v_exp_f32 v76, v76
    v_exp_f32 v77, v77
    v_exp_f32 v78, v78
    v_exp_f32 v79, v79
    v_exp_f32 v48, v48
    v_exp_f32 v49, v49
    v_smfmac_f32_32x32x32_bf16 v[32:47], v[124:127], v[72:79], v4
    s_waitcnt vmcnt(19)
    s_mov_b64 exec, s[54:55]
    ds_read_b128 v[120:123], v3 offset:5120
    ds_read_b128 v[124:127], v3 offset:5632
    s_mov_b64 exec, -1
    v_exp_f32 v50, v50
    v_exp_f32 v51, v51
    v_exp_f32 v52, v52
    v_mfma_f32_32x32x16_bf16 v[64:79], v[96:99], v[12:15], 0
    s_waitcnt lgkmcnt(2)
    v_exp_f32 v53, v53
    v_exp_f32 v54, v54
    v_exp_f32 v55, v55
    v_exp_f32 v56, v56
    v_exp_f32 v57, v57
    v_smfmac_f32_32x32x32_bf16 v[16:31], v[112:115], v[48:55], v4
    s_add_u32 s50, s68, 16384
    buffer_load_dwordx4 v[96:99], v7, s[4:7], s50 offen offset:3072 sc1
    v_exp_f32 v58, v58
    v_exp_f32 v59, v59
    v_exp_f32 v60, v60
    v_exp_f32 v61, v61
    v_exp_f32 v62, v62
    v_exp_f32 v63, v63
    v_exp_f32 v64, v64
    v_exp_f32 v65, v65
    v_smfmac_f32_32x32x32_bf16 v[16:31], v[116:119], v[56:63], v4
    v_exp_f32 v66, v66
    v_exp_f32 v67, v67
    v_exp_f32 v68, v68
    v_mfma_f32_32x32x16_bf16 v[48:63], v[100:103], v[8:11], 0
    v_exp_f32 v69, v69
    v_exp_f32 v70, v70
    v_exp_f32 v71, v71
    v_exp_f32 v72, v72
    v_exp_f32 v73, v73
    v_smfmac_f32_32x32x32_bf16 v[32:47], v[112:115], v[64:71], v4
    s_add_u32 s59, s59, 4096
    buffer_load_dwordx4 v[240:243], v2, s[4:7], s59 offen offset:0 sc1
    v_exp_f32 v74, v74
    v_exp_f32 v75, v75
    v_exp_f32 v76, v76
    v_exp_f32 v77, v77
    v_exp_f32 v78, v78
    v_exp_f32 v79, v79
    v_exp_f32 v48, v48
    v_exp_f32 v49, v49
    v_smfmac_f32_32x32x32_bf16 v[32:47], v[116:119], v[72:79], v4
    s_waitcnt vmcnt(16)
    s_mov_b64 exec, s[54:55]
    ds_read_b128 v[112:115], v3 offset:6144
    ds_read_b128 v[116:119], v3 offset:6656
    s_mov_b64 exec, -1
    v_exp_f32 v50, v50
    v_exp_f32 v51, v51
    v_exp_f32 v52, v52
    v_mfma_f32_32x32x16_bf16 v[64:79], v[100:103], v[12:15], 0
    s_waitcnt lgkmcnt(2)
    v_exp_f32 v53, v53
    v_exp_f32 v54, v54
    v_exp_f32 v55, v55
    v_exp_f32 v56, v56
    v_exp_f32 v57, v57
    v_smfmac_f32_32x32x32_bf16 v[16:31], v[120:123], v[48:55], v4
    s_add_u32 s50, s68, 20480
    buffer_load_dwordx4 v[100:103], v7, s[4:7], s50 offen offset:3072 sc1
    v_exp_f32 v58, v58
    v_exp_f32 v59, v59
    v_exp_f32 v60, v60
    v_exp_f32 v61, v61
    v_exp_f32 v62, v62
    v_exp_f32 v63, v63
    v_exp_f32 v64, v64
    v_exp_f32 v65, v65
    v_smfmac_f32_32x32x32_bf16 v[16:31], v[124:127], v[56:63], v4
    v_exp_f32 v66, v66
    v_exp_f32 v67, v67
    v_exp_f32 v68, v68
    v_mfma_f32_32x32x16_bf16 v[48:63], v[104:107], v[8:11], 0
    v_exp_f32 v69, v69
    v_exp_f32 v70, v70
    v_exp_f32 v71, v71
    v_exp_f32 v72, v72
    v_exp_f32 v73, v73
    v_smfmac_f32_32x32x32_bf16 v[32:47], v[120:123], v[64:71], v4
    s_setprio 1
    buffer_load_dwordx4 v[244:247], v2, s[4:7], s59 offen offset:1024 sc1
    v_exp_f32 v74, v74
    v_exp_f32 v75, v75
    v_exp_f32 v76, v76
    v_exp_f32 v77, v77
    v_exp_f32 v78, v78
    v_exp_f32 v79, v79
    v_exp_f32 v48, v48
    v_exp_f32 v49, v49
    v_smfmac_f32_32x32x32_bf16 v[32:47], v[124:127], v[72:79], v4
    s_waitcnt vmcnt(13)
    s_mov_b64 exec, s[54:55]
    ds_read_b128 v[120:123], v3 offset:7168
    ds_read_b128 v[124:127], v3 offset:7680
    s_mov_b64 exec, -1
    v_exp_f32 v50, v50
    v_exp_f32 v51, v51
    v_exp_f32 v52, v52
    v_mfma_f32_32x32x16_bf16 v[64:79], v[104:107], v[12:15], 0
    s_waitcnt lgkmcnt(2)
    v_exp_f32 v53, v53
    v_exp_f32 v54, v54
    v_exp_f32 v55, v55
    v_exp_f32 v56, v56
    v_exp_f32 v57, v57
    v_smfmac_f32_32x32x32_bf16 v[16:31], v[112:115], v[48:55], v4
    s_add_u32 s50, s68, 24576
    buffer_load_dwordx4 v[104:107], v7, s[4:7], s50 offen offset:3072 sc1
    v_exp_f32 v58, v58
    v_exp_f32 v59, v59
    v_exp_f32 v60, v60
    v_exp_f32 v61, v61
    v_exp_f32 v62, v62
    v_exp_f32 v63, v63
    v_exp_f32 v64, v64
    v_exp_f32 v65, v65
    v_smfmac_f32_32x32x32_bf16 v[16:31], v[116:119], v[56:63], v4
    v_exp_f32 v66, v66
    v_exp_f32 v67, v67
    v_exp_f32 v68, v68
    v_mfma_f32_32x32x16_bf16 v[48:63], v[108:111], v[8:11], 0
    v_exp_f32 v69, v69
    v_exp_f32 v70, v70
    v_exp_f32 v71, v71
    v_exp_f32 v72, v72
    v_exp_f32 v73, v73
    v_smfmac_f32_32x32x32_bf16 v[32:47], v[112:115], v[64:71], v4
    buffer_load_dwordx4 v[248:251], v2, s[4:7], s59 offen offset:2048 sc1
    v_exp_f32 v74, v74
    v_exp_f32 v75, v75
    v_exp_f32 v76, v76
    v_exp_f32 v77, v77
    v_exp_f32 v78, v78
    v_exp_f32 v79, v79
    v_exp_f32 v48, v48
    v_exp_f32 v49, v49
    v_smfmac_f32_32x32x32_bf16 v[32:47], v[116:119], v[72:79], v4
    v_exp_f32 v50, v50
    v_exp_f32 v51, v51
    v_exp_f32 v52, v52
    v_mfma_f32_32x32x16_bf16 v[64:79], v[108:111], v[12:15], 0
    s_waitcnt lgkmcnt(0)
    v_exp_f32 v53, v53
    v_exp_f32 v54, v54
    v_exp_f32 v55, v55
    v_exp_f32 v56, v56
    v_exp_f32 v57, v57
    v_smfmac_f32_32x32x32_bf16 v[16:31], v[120:123], v[48:55], v4
    s_add_u32 s50, s68, 28672
    buffer_load_dwordx4 v[108:111], v7, s[4:7], s50 offen offset:3072 sc1
    v_exp_f32 v58, v58
    v_exp_f32 v59, v59
    v_exp_f32 v60, v60
    v_exp_f32 v61, v61
    v_exp_f32 v62, v62
    v_exp_f32 v63, v63
    v_exp_f32 v64, v64
    v_exp_f32 v65, v65
    v_smfmac_f32_32x32x32_bf16 v[16:31], v[124:127], v[56:63], v4
    v_exp_f32 v66, v66
    v_exp_f32 v67, v67
    v_exp_f32 v68, v68
    v_exp_f32 v69, v69
    v_exp_f32 v70, v70
    v_exp_f32 v71, v71
    v_exp_f32 v72, v72
    v_exp_f32 v73, v73
    v_smfmac_f32_32x32x32_bf16 v[32:47], v[120:123], v[64:71], v4
    s_setprio 0
    buffer_load_dwordx4 v[252:255], v2, s[4:7], s59 offen offset:3072 sc1
    v_exp_f32 v74, v74
    v_exp_f32 v75, v75
    v_exp_f32 v76, v76
    v_exp_f32 v77, v77
    v_exp_f32 v78, v78
    v_exp_f32 v79, v79
    s_add_u32 s48, s81, 5888
    s_add_u32 s49, s81, -26880
    v_smfmac_f32_32x32x32_bf16 v[32:47], v[124:127], v[72:79], v4
    v_add_u32 v48, s48, v2
    v_lshlrev_b32 v51, 2, v0
    v_add_u32 v49, s48, v51
    v_add_u32 v50, s49, v2
    v_add_u32 v51, s49, v51
    s_lshl_b32 s48, s43, 5
    s_lshl_b32 s47, s44, 2
    s_add_u32 s48, s48, s47
    s_and_b32 s47, s40, 3
    s_add_u32 s48, s48, s47
    s_lshl_b32 s48, s48, 11
    s_add_u32 s48, s48, 5243904
    ds_write_b128 v48, v[32:35]
    ds_write_b128 v48, v[36:39] offset:1024
    ds_write_b32 v49, v40 offset:2048
    s_waitcnt lgkmcnt(0)
    s_barrier
    ds_read_b32 v40, v51 offset:2048
    ds_read_b128 v[32:35], v50
    ds_read_b128 v[36:39], v50 offset:1024
    s_mov_b32 s46, 0x5d800000
    s_waitcnt lgkmcnt(2)
    v_add_f32 v24, v24, v40
    v_cmp_nle_f32 vcc, 0x21800000, v24
    v_cmp_nge_f32 s[98:99], s46, v24
    s_waitcnt lgkmcnt(0)
    v_pk_add_f32 v[16:17], v[16:17], v[32:33]
    v_pk_add_f32 v[18:19], v[18:19], v[34:35]
    v_pk_add_f32 v[20:21], v[20:21], v[36:37]
    v_pk_add_f32 v[22:23], v[22:23], v[38:39]
    s_or_b64 vcc, vcc, s[98:99]
    s_cbranch_vccz L_fast_113
    v_subrev_u32 v3, s81, v3
    s_waitcnt vmcnt(0)
    s_sub_u32 s46, s56, 2048
    s_mov_b32 s47, 64
    v_mov_b32 v72, 0xff800000
L_slow1_114:
    buffer_load_dwordx4 v[12:15], v2, s[4:7], s46 offen sc1
    s_add_u32 s46, s46, 2048
    s_waitcnt vmcnt(0)
    v_mfma_f32_32x32x16_bf16 v[48:63], v[12:15], v[8:11], 0
    s_nop 11
    v_max3_f32 v72, v72, v48, v49
    v_max3_f32 v72, v72, v50, v51
    v_max3_f32 v72, v72, v52, v53
    v_max3_f32 v72, v72, v54, v55
    v_max3_f32 v72, v72, v56, v57
    v_max3_f32 v72, v72, v58, v59
    v_max3_f32 v72, v72, v60, v61
    v_max3_f32 v72, v72, v62, v63
    s_sub_u32 s47, s47, 1
    s_cmp_lg_u32 s47, 0
    s_cbranch_scc1 L_slow1_114
    v_mov_b32 v73, v72
    s_nop 1
    v_permlane32_swap_b32 v72, v73
    v_max_f32 v72, v72, v73
    v_sub_f32 v32, 0, v72
    v_mov_b32 v16, 0
    v_sub_f32 v33, 0, v72
    v_mov_b32 v17, 0
    v_sub_f32 v34, 0, v72
    v_mov_b32 v18, 0
    v_sub_f32 v35, 0, v72
    v_mov_b32 v19, 0
    v_sub_f32 v36, 0, v72
    v_mov_b32 v20, 0
    v_sub_f32 v37, 0, v72
    v_mov_b32 v21, 0
    v_sub_f32 v38, 0, v72
    v_mov_b32 v22, 0
    v_sub_f32 v39, 0, v72
    v_mov_b32 v23, 0
    v_sub_f32 v40, 0, v72
    v_mov_b32 v24, 0
    v_sub_f32 v41, 0, v72
    v_mov_b32 v25, 0
    v_sub_f32 v42, 0, v72
    v_mov_b32 v26, 0
    v_sub_f32 v43, 0, v72
    v_mov_b32 v27, 0
    v_sub_f32 v44, 0, v72
    v_mov_b32 v28, 0
    v_sub_f32 v45, 0, v72
    v_mov_b32 v29, 0
    v_sub_f32 v46, 0, v72
    v_mov_b32 v30, 0
    v_sub_f32 v47, 0, v72
    v_mov_b32 v31, 0
    v_mov_b32 v64, 0x3f803f80
    v_mov_b32 v65, 0x3f803f80
    v_mov_b32 v66, 0x3f803f80
    v_mov_b32 v67, 0x3f803f80
    v_mov_b32 v68, 0x3f803f80
    v_mov_b32 v69, 0x3f803f80
    v_mov_b32 v70, 0x3f803f80
    v_mov_b32 v71, 0x3f803f80
    s_sub_u32 s46, s56, 2048
    s_mov_b32 s47, 64
L_slow2_115:
    buffer_load_dwordx4 v[12:15], v2, s[4:7], s46 offen sc1
    s_mov_b64 exec, s[54:55]
    buffer_load_dwordx4 v[64:67], v3, s[4:7], s46 offen offset:1024 sc1
    buffer_load_dwordx4 v[68:71], v3, s[4:7], s46 offen offset:1536 sc1
    s_mov_b64 exec, -1
    s_add_u32 s46, s46, 2048
    s_waitcnt vmcnt(0)
    v_mfma_f32_32x32x16_bf16 v[48:63], v[12:15], v[8:11], v[32:47]
    s_nop 11
    v_exp_f32 v48, v48
    v_exp_f32 v49, v49
    v_exp_f32 v50, v50
    v_exp_f32 v51, v51
    v_exp_f32 v52, v52
    v_exp_f32 v53, v53
    v_exp_f32 v54, v54
    v_exp_f32 v55, v55
    v_exp_f32 v56, v56
    v_exp_f32 v57, v57
    v_exp_f32 v58, v58
    v_exp_f32 v59, v59
    v_exp_f32 v60, v60
    v_exp_f32 v61, v61
    v_exp_f32 v62, v62
    v_exp_f32 v63, v63
    v_smfmac_f32_32x32x32_bf16 v[16:31], v[64:67], v[48:55], v4
    s_nop 0
    v_smfmac_f32_32x32x32_bf16 v[16:31], v[68:71], v[56:63], v4
    s_sub_u32 s47, s47, 1
    s_cmp_lg_u32 s47, 0
    s_nop 7
    s_cbranch_scc1 L_slow2_115
    s_nop 7
    s_nop 7
    s_branch L_fast_113
L_kvw_92:
    s_mov_b32 s52, 400000
L_rp_kv_116:
    buffer_load_dword v254, v252, s[4:7], s70 offen sc1
    s_sub_u32 s52, s52, 1
    s_cmp_eq_u32 s52, 0
    s_waitcnt vmcnt(0)
    s_cbranch_scc1 L_rpd_kv_117
    v_cmp_ne_u32 vcc, s45, v254
    s_nop 0
    s_mov_b32 s71, vcc_lo
    s_and_b32 s50, vcc_lo, 0x10
    s_cbranch_scc1 L_rp_kv_116
L_rpd_kv_117:
    s_branch L_kvb_93
L_kvw_94:
    s_mov_b32 s52, 400000
L_rp_kv_118:
    buffer_load_dword v254, v252, s[4:7], s70 offen sc1
    s_sub_u32 s52, s52, 1
    s_cmp_eq_u32 s52, 0
    s_waitcnt vmcnt(0)
    s_cbranch_scc1 L_rpd_kv_119
    v_cmp_ne_u32 vcc, s45, v254
    s_nop 0
    s_mov_b32 s71, vcc_lo
    s_and_b32 s50, vcc_lo, 0x20
    s_cbranch_scc1 L_rp_kv_118
L_rpd_kv_119:
    s_branch L_kvb_95
L_kvw_96:
    s_mov_b32 s52, 400000
L_rp_kv_120:
    buffer_load_dword v254, v252, s[4:7], s70 offen sc1
    s_sub_u32 s52, s52, 1
    s_cmp_eq_u32 s52, 0
    s_waitcnt vmcnt(0)
    s_cbranch_scc1 L_rpd_kv_121
    v_cmp_ne_u32 vcc, s45, v254
    s_nop 0
    s_mov_b32 s71, vcc_lo
    s_and_b32 s50, vcc_lo, 0x40
    s_cbranch_scc1 L_rp_kv_120
L_rpd_kv_121:
    s_branch L_kvb_97
L_kvw_98:
    s_mov_b32 s52, 400000
L_rp_kv_122:
    buffer_load_dword v254, v252, s[4:7], s70 offen sc1
    s_sub_u32 s52, s52, 1
    s_cmp_eq_u32 s52, 0
    s_waitcnt vmcnt(0)
    s_cbranch_scc1 L_rpd_kv_123
    v_cmp_ne_u32 vcc, s45, v254
    s_nop 0
    s_mov_b32 s71, vcc_lo
    s_and_b32 s50, vcc_lo, 0x80
    s_cbranch_scc1 L_rp_kv_122
L_rpd_kv_123:
    s_branch L_kvb_99
L_kvw_100:
    s_mov_b32 s52, 400000
L_rp_kv_124:
    buffer_load_dword v254, v252, s[4:7], s70 offen sc1
    s_sub_u32 s52, s52, 1
    s_cmp_eq_u32 s52, 0
    s_waitcnt vmcnt(0)
    s_cbranch_scc1 L_rpd_kv_125
    v_cmp_ne_u32 vcc, s45, v254
    s_nop 0
    s_mov_b32 s71, vcc_lo
    s_and_b32 s50, vcc_lo, 0x100
    s_cbranch_scc1 L_rp_kv_124
L_rpd_kv_125:
    s_branch L_kvb_101
L_kvw_102:
    s_mov_b32 s52, 400000
L_rp_kv_126:
    buffer_load_dword v254, v252, s[4:7], s70 offen sc1
    s_sub_u32 s52, s52, 1
    s_cmp_eq_u32 s52, 0
    s_waitcnt vmcnt(0)
    s_cbranch_scc1 L_rpd_kv_127
    v_cmp_ne_u32 vcc, s45, v254
    s_nop 0
    s_mov_b32 s71, vcc_lo
    s_and_b32 s50, vcc_lo, 0x200
    s_cbranch_scc1 L_rp_kv_126
L_rpd_kv_127:
    s_branch L_kvb_103
L_kvw_104:
    s_mov_b32 s52, 400000
L_rp_kv_128:
    buffer_load_dword v254, v252, s[4:7], s70 offen sc1
    s_sub_u32 s52, s52, 1
    s_cmp_eq_u32 s52, 0
    s_waitcnt vmcnt(0)
    s_cbranch_scc1 L_rpd_kv_129
    v_cmp_ne_u32 vcc, s45, v254
    s_nop 0
    s_mov_b32 s71, vcc_lo
    s_and_b32 s50, vcc_lo, 0x400
    s_cbranch_scc1 L_rp_kv_128
L_rpd_kv_129:
    s_branch L_kvb_105
L_kvw_109:
    s_mov_b32 s52, 400000
L_rp_kv_130:
    buffer_load_dword v254, v252, s[4:7], s70 offen sc1
    s_sub_u32 s52, s52, 1
    s_cmp_eq_u32 s52, 0
    s_waitcnt vmcnt(0)
    s_cbranch_scc1 L_rpd_kv_131
    v_cmp_ne_u32 vcc, s45, v254
    s_nop 0
    s_mov_b32 s71, vcc_lo
    s_and_b32 s50, vcc_lo, 0x800
    s_cbranch_scc1 L_rp_kv_130
L_rpd_kv_131:
    s_branch L_kvb_110
L_kvw_111:
    s_mov_b32 s52, 400000
L_rp_kv_132:
    buffer_load_dword v254, v252, s[4:7], s70 offen sc1
    s_sub_u32 s52, s52, 1
    s_cmp_eq_u32 s52, 0
    s_waitcnt vmcnt(0)
    s_cbranch_scc1 L_rpd_kv_133
    v_cmp_ne_u32 vcc, s45, v254
    s_nop 0
    s_mov_b32 s71, vcc_lo
    s_and_b32 s50, vcc_lo, 0xfffff000
    s_cbranch_scc1 L_rp_kv_132
L_rpd_kv_133:
    s_branch L_kvb_112
L_fast_113:
    v_rcp_f32 v24, v24
    s_nop 0
    v_pk_mul_f32 v[16:17], v[16:17], v[24:25] op_sel_hi:[1,0]
    v_pk_mul_f32 v[18:19], v[18:19], v[24:25] op_sel_hi:[1,0]
    v_pk_mul_f32 v[20:21], v[20:21], v[24:25] op_sel_hi:[1,0]
    v_pk_mul_f32 v[22:23], v[22:23], v[24:25] op_sel_hi:[1,0]
    v_cvt_pk_bf16_f32 v52, v16, v17
    v_cvt_pk_bf16_f32 v53, v18, v19
    v_cvt_pk_bf16_f32 v54, v20, v21
    v_cvt_pk_bf16_f32 v55, v22, v23
    buffer_store_dwordx4 v[52:55], v2, s[4:7], s48 offen sc1
    s_lshl_b32 s47, s40, 10
    v_add_u32 v4, s47, v2
    ds_read_b128 v[56:59], v4 offset:16384
    s_waitcnt vmcnt(10)
    v_add_u32 v3, s89, v2
    ds_read_b128 v[16:19], v3 offset:0
    ds_read_b128 v[20:23], v3 offset:1024
    ds_read_b128 v[24:27], v3 offset:2048
    ds_read_b128 v[28:31], v3 offset:3072
    ds_read_b128 v[32:35], v3 offset:4096
    ds_read_b128 v[36:39], v3 offset:5120
    ds_read_b128 v[40:43], v3 offset:6144
    ds_read_b128 v[44:47], v3 offset:7168
    s_waitcnt lgkmcnt(0)
    s_mov_b32 s52, 400000
L_g_m2_134:
    v_xor_b32 v17, s3, v17
    v_xor_b32 v19, s3, v19
    v_or_b32 v48, v17, v19
    v_xor_b32 v21, s3, v21
    v_xor_b32 v23, s3, v23
    v_or3_b32 v48, v48, v21, v23
    v_pk_add_f32 v[16:17], v[16:17], v[20:21]
    v_pk_add_f32 v[18:19], v[18:19], v[22:23]
    v_xor_b32 v25, s3, v25
    v_xor_b32 v27, s3, v27
    v_or3_b32 v48, v48, v25, v27
    v_pk_add_f32 v[16:17], v[16:17], v[24:25]
    v_pk_add_f32 v[18:19], v[18:19], v[26:27]
    v_xor_b32 v29, s3, v29
    v_xor_b32 v31, s3, v31
    v_or3_b32 v48, v48, v29, v31
    v_pk_add_f32 v[16:17], v[16:17], v[28:29]
    v_pk_add_f32 v[18:19], v[18:19], v[30:31]
    v_xor_b32 v33, s3, v33
    v_xor_b32 v35, s3, v35
    v_or3_b32 v48, v48, v33, v35
    v_pk_add_f32 v[16:17], v[16:17], v[32:33]
    v_pk_add_f32 v[18:19], v[18:19], v[34:35]
    v_xor_b32 v37, s3, v37
    v_xor_b32 v39, s3, v39
    v_or3_b32 v48, v48, v37, v39
    v_pk_add_f32 v[16:17], v[16:17], v[36:37]
    v_pk_add_f32 v[18:19], v[18:19], v[38:39]
    v_xor_b32 v41, s3, v41
    v_xor_b32 v43, s3, v43
    v_or3_b32 v48, v48, v41, v43
    v_pk_add_f32 v[16:17], v[16:17], v[40:41]
    v_pk_add_f32 v[18:19], v[18:19], v[42:43]
    v_xor_b32 v45, s3, v45
    v_xor_b32 v47, s3, v47
    v_or3_b32 v48, v48, v45, v47
    v_pk_add_f32 v[16:17], v[16:17], v[44:45]
    v_pk_add_f32 v[18:19], v[18:19], v[46:47]
    v_and_b32 v48, 0xff, v48
    v_cmp_ne_u32 vcc, 0, v48
    s_sub_u32 s52, s52, 1
    s_cmp_eq_u32 s52, 0
    s_cbranch_scc1 L_gd_m2_135
    s_cbranch_vccz L_gd_m2_135
    s_mov_b32 s50, s88
    buffer_load_dwordx4 v[16:19], v2, s[4:7], s50 offen sc1
    s_add_u32 s50, s50, 12288
    buffer_load_dwordx4 v[20:23], v2, s[4:7], s50 offen sc1
    s_add_u32 s50, s50, 12288
    buffer_load_dwordx4 v[24:27], v2, s[4:7], s50 offen sc1
    s_add_u32 s50, s50, 12288
    buffer_load_dwordx4 v[28:31], v2, s[4:7], s50 offen sc1
    s_add_u32 s50, s50, 12288
    buffer_load_dwordx4 v[32:35], v2, s[4:7], s50 offen sc1
    s_add_u32 s50, s50, 12288
    buffer_load_dwordx4 v[36:39], v2, s[4:7], s50 offen sc1
    s_add_u32 s50, s50, 12288
    buffer_load_dwordx4 v[40:43], v2, s[4:7], s50 offen sc1
    s_add_u32 s50, s50, 12288
    buffer_load_dwordx4 v[44:47], v2, s[4:7], s50 offen sc1
    s_waitcnt vmcnt(0)
    s_branch L_g_m2_134
L_gd_m2_135:
    v_cvt_pk_bf16_f32 v20, v16, v17
    v_cvt_pk_bf16_f32 v21, v18, v19
    v_and_b32 v17, 0xffff0000, v20
    v_lshlrev_b32 v16, 16, v20
    v_and_b32 v19, 0xffff0000, v21
    v_lshlrev_b32 v18, 16, v21
    v_add_f32 v16, s82, v16
    v_add_f32 v17, s82, v17
    v_add_f32 v18, s82, v18
    v_add_f32 v19, s82, v19
    v_cvt_pk_bf16_f32 v20, v16, v17
    v_cvt_pk_bf16_f32 v21, v18, v19
    s_lshl_b32 s46, s40, 9
    s_add_u32 s46, s46, 145408
    v_lshlrev_b32 v4, 3, v0
    v_add_u32 v4, s46, v4
    ds_write_b64 v4, v[20:21]
    s_waitcnt lgkmcnt(0)
    v_and_b32 v9, 0xffff0000, v56
    v_lshlrev_b32 v8, 16, v56
    v_and_b32 v11, 0xffff0000, v57
    v_lshlrev_b32 v10, 16, v57
    v_and_b32 v13, 0xffff0000, v58
    v_lshlrev_b32 v12, 16, v58
    v_and_b32 v15, 0xffff0000, v59
    v_lshlrev_b32 v14, 16, v59
    s_and_b32 s48, s40, 3
    s_lshl_b32 s48, s48, 13
    s_lshl_b32 s49, s43, 16
    s_add_u32 s49, s49, s48
    s_add_u32 s49, s49, 5242880
    v_mul_u32_u24 v16, 512, v0
    v_mul_u32_u24 v17, 5120, v0
    s_add_u32 s46, s84, 32256
    s_add_u32 s51, s86, -4096
    s_waitcnt vmcnt(0)
    s_barrier
    s_mov_b64 exec, 3
    s_mov_b32 s52, 400000
L_pp_o_136:
    s_and_b32 s50, s52, 7
    s_cmp_eq_u32 s50, 1
    s_cbranch_scc1 L_ppg_137
    buffer_load_dword v5, v17, s[4:7], s51 offen sc1
    s_branch L_ppc_138
L_ppg_137:
    buffer_load_dword v5, v16, s[4:7], s46 offen sc1
L_ppc_138:
    s_sub_u32 s52, s52, 1
    s_cmp_eq_u32 s52, 0
    s_waitcnt vmcnt(0)
    s_cbranch_scc1 L_ppd_139
    v_cmp_ne_u32 vcc, s45, v5
    s_nop 0
    s_cbranch_vccnz L_pp_o_136
L_ppd_139:
    s_mov_b64 exec, -1
    s_setprio 3
    s_add_u32 m0, s48, 0
    s_add_u32 s50, s49, 0
    buffer_load_dwordx4 v2, s[4:7], s50 offen offset:0 sc1 lds
    buffer_load_dwordx4 v2, s[4:7], s50 offen offset:1024 sc1 lds
    s_add_u32 m0, s48, 32768
    s_add_u32 s50, s49, 32768
    buffer_load_dwordx4 v2, s[4:7], s50 offen offset:0 sc1 lds
    buffer_load_dwordx4 v2, s[4:7], s50 offen offset:1024 sc1 lds
    s_setprio 2
    s_add_u32 m0, s48, 2048
    s_add_u32 s50, s49, 2048
    buffer_load_dwordx4 v2, s[4:7], s50 offen offset:0 sc1 lds
    buffer_load_dwordx4 v2, s[4:7], s50 offen offset:1024 sc1 lds
    s_add_u32 m0, s48, 34816
    s_add_u32 s50, s49, 34816
    buffer_load_dwordx4 v2, s[4:7], s50 offen offset:0 sc1 lds
    buffer_load_dwordx4 v2, s[4:7], s50 offen offset:1024 sc1 lds
    s_setprio 1
    s_add_u32 m0, s48, 4096
    s_add_u32 s50, s49, 4096
    buffer_load_dwordx4 v2, s[4:7], s50 offen offset:0 sc1 lds
    buffer_load_dwordx4 v2, s[4:7], s50 offen offset:1024 sc1 lds
    s_add_u32 m0, s48, 36864
    s_add_u32 s50, s49, 36864
    buffer_load_dwordx4 v2, s[4:7], s50 offen offset:0 sc1 lds
    buffer_load_dwordx4 v2, s[4:7], s50 offen offset:1024 sc1 lds
    s_setprio 0
    s_add_u32 m0, s48, 6144
    s_add_u32 s50, s49, 6144
    buffer_load_dwordx4 v2, s[4:7], s50 offen offset:0 sc1 lds
    buffer_load_dwordx4 v2, s[4:7], s50 offen offset:1024 sc1 lds
    s_add_u32 m0, s48, 38912
    s_add_u32 s50, s49, 38912
    buffer_load_dwordx4 v2, s[4:7], s50 offen offset:0 sc1 lds
    buffer_load_dwordx4 v2, s[4:7], s50 offen offset:1024 sc1 lds
    s_and_b32 s51, s40, 1
    s_lshl_b32 s51, s51, 1
    s_lshr_b32 s47, s40, 2
    s_add_u32 s51, s51, s47
    s_lshl_b32 s47, s44, 2
    s_add_u32 s47, s47, s51
    s_lshl_b32 s48, s43, 5
    s_add_u32 s47, s47, s48
    s_lshl_b32 s47, s47, 1
    s_bfe_u32 s48, s40, 0x10001
    s_add_u32 s47, s47, s48
    s_lshl_b32 s47, s47, 10
    s_add_u32 s47, s47, 7340032
    s_lshl_b32 s51, s51, 10
    s_lshl_b32 s49, s48, 8
    s_add_u32 s51, s51, s49
    s_add_u32 s51, s51, 149504
    s_lshl_b32 s48, s48, 10
    v_add_u32 v3, s48, v2
    s_and_b32 s46, s40, 3
    s_lshl_b32 s46, s46, 12
    s_add_u32 s46, s46, 65536
    v_add_u32 v4, s46, v2
    s_waitcnt vmcnt(12)
    s_barrier
    v_lshrrev_b32 v120, 5, v0
    v_lshlrev_b32 v120, 4, v120
    s_add_u32 s46, s65, 157696
    v_add_u32 v120, s46, v120
    s_lshl_b32 s49, s44, 7
    v_lshrrev_b32 v124, 5, v0
    v_lshlrev_b32 v124, 4, v124
    s_add_u32 s46, s65, 148480
    s_add_u32 s46, s46, s49
    v_add_u32 v124, s46, v124
    ds_read_b128 v[120:123], v120
    ds_read_b128 v[124:127], v124
    s_waitcnt vmcnt(8)
    s_barrier
    s_waitcnt lgkmcnt(0)
    v_and_b32 v65, 0xffff0000, v120
    v_lshlrev_b32 v64, 16, v120
    v_and_b32 v67, 0xffff0000, v121
    v_lshlrev_b32 v66, 16, v121
    v_and_b32 v69, 0xffff0000, v122
    v_lshlrev_b32 v68, 16, v122
    v_and_b32 v71, 0xffff0000, v123
    v_lshlrev_b32 v70, 16, v123
    s_waitcnt vmcnt(4)
    s_barrier
    v_and_b32 v73, 0xffff0000, v124
    v_lshlrev_b32 v72, 16, v124
    v_and_b32 v75, 0xffff0000, v125
    v_lshlrev_b32 v74, 16, v125
    v_and_b32 v77, 0xffff0000, v126
    v_lshlrev_b32 v76, 16, v126
    v_and_b32 v79, 0xffff0000, v127
    v_lshlrev_b32 v78, 16, v127
    s_waitcnt vmcnt(0)
    s_barrier
    ds_read_b128 v[32:35], v3 offset:6144
    ds_read_b128 v[36:39], v3 offset:14336
    ds_read_b128 v[40:43], v3 offset:22528
    ds_read_b128 v[44:47], v3 offset:30720
    ds_read_b128 v[48:51], v3 offset:38912
    ds_read_b128 v[52:55], v3 offset:47104
    ds_read_b128 v[56:59], v3 offset:55296
    ds_read_b128 v[60:63], v3 offset:63488
    s_waitcnt lgkmcnt(7)
    v_mfma_f32_32x32x16_bf16 v[16:31], v[80:83], v[32:35], 0
    s_waitcnt lgkmcnt(6)
    v_mfma_f32_32x32x16_bf16 v[16:31], v[84:87], v[36:39], v[16:31]
    s_waitcnt lgkmcnt(5)
    v_mfma_f32_32x32x16_bf16 v[16:31], v[88:91], v[40:43], v[16:31]
    s_waitcnt lgkmcnt(4)
    v_mfma_f32_32x32x16_bf16 v[16:31], v[92:95], v[44:47], v[16:31]
    s_waitcnt lgkmcnt(3)
    v_mfma_f32_32x32x16_bf16 v[16:31], v[96:99], v[48:51], v[16:31]
    s_waitcnt lgkmcnt(2)
    v_mfma_f32_32x32x16_bf16 v[16:31], v[100:103], v[52:55], v[16:31]
    s_waitcnt lgkmcnt(1)
    v_mfma_f32_32x32x16_bf16 v[16:31], v[104:107], v[56:59], v[16:31]
    s_waitcnt lgkmcnt(0)
    v_mfma_f32_32x32x16_bf16 v[16:31], v[108:111], v[60:63], v[16:31]
    s_nop 11
    ds_write_b128 v4, v[24:27] offset:2048
    ds_write_b128 v4, v[28:31] offset:3072
    s_waitcnt lgkmcnt(0)
    s_barrier
    ds_read_b128 v[104:107], v4 offset:0
    ds_read_b128 v[108:111], v4 offset:1024
    s_waitcnt lgkmcnt(0)
    v_pk_add_f32 v[16:17], v[16:17], v[104:105]
    v_pk_add_f32 v[18:19], v[18:19], v[106:107]
    v_pk_add_f32 v[20:21], v[20:21], v[108:109]
    v_pk_add_f32 v[22:23], v[22:23], v[110:111]
    v_pk_fma_f32 v[8:9], v[16:17], v[64:65], v[8:9]
    v_pk_fma_f32 v[10:11], v[18:19], v[66:67], v[10:11]
    v_pk_fma_f32 v[12:13], v[20:21], v[68:69], v[12:13]
    v_pk_fma_f32 v[14:15], v[22:23], v[70:71], v[14:15]
    v_pk_mul_f32 v[72:73], v[72:73], v[8:9]
    v_pk_mul_f32 v[74:75], v[74:75], v[10:11]
    v_pk_mul_f32 v[76:77], v[76:77], v[12:13]
    v_pk_mul_f32 v[78:79], v[78:79], v[14:15]
    v_cvt_pk_bf16_f32 v72, v72, v73
    v_cvt_pk_bf16_f32 v73, v74, v75
    v_cvt_pk_bf16_f32 v74, v76, v77
    v_cvt_pk_bf16_f32 v75, v78, v79
    buffer_store_dwordx4 v[72:75], v2, s[4:7], s47 offen sc1
    v_pk_add_f32 v[64:65], v[8:9], v[10:11]
    v_pk_mul_f32 v[66:67], v[8:9], v[8:9]
    v_pk_add_f32 v[64:65], v[64:65], v[12:13]
    v_pk_fma_f32 v[66:67], v[10:11], v[10:11], v[66:67]
    v_pk_add_f32 v[64:65], v[64:65], v[14:15]
    v_pk_fma_f32 v[66:67], v[12:13], v[12:13], v[66:67]
    v_add_f32 v64, v64, v65
    v_pk_fma_f32 v[66:67], v[14:15], v[14:15], v[66:67]
    v_add_f32 v65, v66, v67
    v_lshrrev_b32 v66, 5, v0
    v_lshlrev_b32 v66, 8, v66
    v_lshl_add_u32 v66, v0, 3, v66
    v_add_u32 v66, s51, v66
    ds_write_b64 v66, v[64:65]
    s_waitcnt lgkmcnt(0)
    s_barrier
    s_cmp_lg_u32 s40, 4
    s_cbranch_scc1 L_nost_140
    v_lshlrev_b32 v66, 3, v0
    v_add_u32 v66, 149504, v66
    ds_read_b64 v[16:17], v66 offset:0
    ds_read_b64 v[18:19], v66 offset:512
    ds_read_b64 v[20:21], v66 offset:1024
    ds_read_b64 v[22:23], v66 offset:1536
    ds_read_b64 v[24:25], v66 offset:2048
    ds_read_b64 v[26:27], v66 offset:2560
    ds_read_b64 v[28:29], v66 offset:3072
    ds_read_b64 v[30:31], v66 offset:3584
    s_lshl_b32 s46, s83, 3
    s_add_u32 s46, s46, 262144
    s_waitcnt lgkmcnt(0)
    v_pk_add_f32 v[16:17], v[16:17], v[18:19]
    v_pk_add_f32 v[20:21], v[20:21], v[22:23]
    v_pk_add_f32 v[24:25], v[24:25], v[26:27]
    v_pk_add_f32 v[28:29], v[28:29], v[30:31]
    v_pk_add_f32 v[16:17], v[16:17], v[20:21]
    v_pk_add_f32 v[24:25], v[24:25], v[28:29]
    v_pk_add_f32 v[16:17], v[16:17], v[24:25]
    v_mov_b32 v104, v16
    v_mov_b32 v106, v17
    v_mov_b32 v105, s45
    v_mov_b32 v107, s45
    buffer_store_dwordx4 v[104:107], v2, s[4:7], s46 offen sc1
    s_waitcnt vmcnt(1)
    s_branch L_stj_141
L_nost_140:
    v_mov_b32 v5, s45
    v_lshlrev_b32 v4, 2, v0
    s_add_u32 s46, s83, 18644992
    s_cmp_lg_u32 s40, 5
    s_waitcnt vmcnt(0)
L_stj_141:
    s_cmp_lg_u32 s40, 5
    s_barrier
    s_cbranch_scc1 L_noflag_142
    s_mov_b32 exec_hi, 0
    buffer_store_dword v5, v4, s[4:7], s85 offen offset:896
    buffer_store_dword v5, v4, s[4:7], s46 offen sc1
    s_mov_b64 exec, -1
L_noflag_142:
    v_lshrrev_b32 v120, 4, v0
    v_lshlrev_b32 v5, 4, v120
    v_and_b32 v120, 1, v0
    v_xor_b32 v120, 1, v120
    v_lshl_add_u32 v5, v120, 10, v5
    v_add_u32 v5, 147456, v5
    ds_read_b128 v[16:19], v5 offset:0
    ds_read_b128 v[20:23], v5 offset:64
    ds_read_b128 v[24:27], v5 offset:128
    ds_read_b128 v[28:31], v5 offset:192
    ds_read_b128 v[32:35], v5 offset:256
    ds_read_b128 v[36:39], v5 offset:320
    ds_read_b128 v[40:43], v5 offset:384
    ds_read_b128 v[44:47], v5 offset:448
    ds_read_b128 v[48:51], v5 offset:512
    ds_read_b128 v[52:55], v5 offset:576
    ds_read_b128 v[56:59], v5 offset:640
    ds_read_b128 v[60:63], v5 offset:704
    s_waitcnt lgkmcnt(11)
    v_mfma_f32_16x16x32_bf16 v[120:123], v[16:19], v[128:131], 0
    ds_read_b128 v[16:19], v5 offset:768
    s_waitcnt lgkmcnt(11)
    v_mfma_f32_16x16x32_bf16 v[124:127], v[20:23], v[132:135], 0
    ds_read_b128 v[20:23], v5 offset:832
    s_waitcnt lgkmcnt(11)
    v_mfma_f32_16x16x32_bf16 v[120:123], v[24:27], v[136:139], v[120:123]
    ds_read_b128 v[24:27], v5 offset:896
    s_waitcnt lgkmcnt(11)
    v_mfma_f32_16x16x32_bf16 v[124:127], v[28:31], v[140:143], v[124:127]
    ds_read_b128 v[28:31], v5 offset:960
    s_waitcnt lgkmcnt(11)
    v_mfma_f32_16x16x32_bf16 v[120:123], v[32:35], v[144:147], v[120:123]
    s_waitcnt lgkmcnt(10)
    v_mfma_f32_16x16x32_bf16 v[124:127], v[36:39], v[148:151], v[124:127]
    s_waitcnt lgkmcnt(9)
    v_mfma_f32_16x16x32_bf16 v[120:123], v[40:43], v[152:155], v[120:123]
    s_waitcnt lgkmcnt(8)
    v_mfma_f32_16x16x32_bf16 v[124:127], v[44:47], v[156:159], v[124:127]
    s_waitcnt lgkmcnt(7)
    v_mfma_f32_16x16x32_bf16 v[120:123], v[48:51], v[160:163], v[120:123]
    s_waitcnt lgkmcnt(6)
    v_mfma_f32_16x16x32_bf16 v[124:127], v[52:55], v[164:167], v[124:127]
    s_waitcnt lgkmcnt(5)
    v_mfma_f32_16x16x32_bf16 v[120:123], v[56:59], v[168:171], v[120:123]
    s_waitcnt lgkmcnt(4)
    v_mfma_f32_16x16x32_bf16 v[124:127], v[60:63], v[172:175], v[124:127]
    s_waitcnt lgkmcnt(3)
    v_mfma_f32_16x16x32_bf16 v[120:123], v[16:19], v[176:179], v[120:123]
    s_waitcnt lgkmcnt(2)
    v_mfma_f32_16x16x32_bf16 v[124:127], v[20:23], v[180:183], v[124:127]
    s_waitcnt lgkmcnt(1)
    v_mfma_f32_16x16x32_bf16 v[120:123], v[24:27], v[184:187], v[120:123]
    s_waitcnt lgkmcnt(0)
    v_mfma_f32_16x16x32_bf16 v[124:127], v[28:31], v[188:191], v[124:127]
    v_cmp_gt_u32 vcc, 16, v0
    s_nop 6
    v_add_f32 v124, v124, v120
    v_add_f32 v125, v125, v121
    v_cndmask_b32 v124, 0, v124, vcc
    v_cndmask_b32 v125, 0, v125, vcc
    v_cvt_pk_bf16_f32 v113, v124, v125
    v_and_b32 v127, 0xffff0000, v113
    v_lshlrev_b32 v126, 16, v113
    v_sub_f32 v124, v124, v126
    v_sub_f32 v125, v125, v127
    v_cvt_pk_bf16_f32 v112, v126, v124
    v_cvt_pk_bf16_f32 v114, v125, v127
    v_mov_b32 v115, 0
    v_lshrrev_b32 v120, 4, v0
    v_lshlrev_b32 v5, 4, v120
    v_and_b32 v120, 1, v0
    v_xor_b32 v120, 1, v120
    v_lshl_add_u32 v5, v120, 10, v5
    v_add_u32 v5, 147456, v5
    ds_read_b128 v[16:19], v5 offset:0
    ds_read_b128 v[20:23], v5 offset:64
    ds_read_b128 v[24:27], v5 offset:128
    ds_read_b128 v[28:31], v5 offset:192
    ds_read_b128 v[32:35], v5 offset:256
    ds_read_b128 v[36:39], v5 offset:320
    ds_read_b128 v[40:43], v5 offset:384
    ds_read_b128 v[44:47], v5 offset:448
    ds_read_b128 v[48:51], v5 offset:512
    ds_read_b128 v[52:55], v5 offset:576
    ds_read_b128 v[56:59], v5 offset:640
    ds_read_b128 v[60:63], v5 offset:704
    s_waitcnt lgkmcnt(11)
    v_mfma_f32_16x16x32_bf16 v[120:123], v[16:19], v[192:195], 0
    ds_read_b128 v[16:19], v5 offset:768
    s_waitcnt lgkmcnt(11)
    v_mfma_f32_16x16x32_bf16 v[124:127], v[20:23], v[196:199], 0
    ds_read_b128 v[20:23], v5 offset:832
    s_waitcnt lgkmcnt(11)
    v_mfma_f32_16x16x32_bf16 v[120:123], v[24:27], v[200:203], v[120:123]
    ds_read_b128 v[24:27], v5 offset:896
    s_waitcnt lgkmcnt(11)
    v_mfma_f32_16x16x32_bf16 v[124:127], v[28:31], v[204:207], v[124:127]
    ds_read_b128 v[28:31], v5 offset:960
    s_waitcnt lgkmcnt(11)
    v_mfma_f32_16x16x32_bf16 v[120:123], v[32:35], v[208:211], v[120:123]
    s_waitcnt lgkmcnt(10)
    v_mfma_f32_16x16x32_bf16 v[124:127], v[36:39], v[212:215], v[124:127]
    s_waitcnt lgkmcnt(9)
    v_mfma_f32_16x16x32_bf16 v[120:123], v[40:43], v[216:219], v[120:123]
    s_waitcnt lgkmcnt(8)
    v_mfma_f32_16x16x32_bf16 v[124:127], v[44:47], v[220:223], v[124:127]
    s_waitcnt lgkmcnt(7)
    v_mfma_f32_16x16x32_bf16 v[120:123], v[48:51], v[224:227], v[120:123]
    s_waitcnt lgkmcnt(6)
    v_mfma_f32_16x16x32_bf16 v[124:127], v[52:55], v[228:231], v[124:127]
    s_waitcnt lgkmcnt(5)
    v_mfma_f32_16x16x32_bf16 v[120:123], v[56:59], v[232:235], v[120:123]
    s_waitcnt lgkmcnt(4)
    v_mfma_f32_16x16x32_bf16 v[124:127], v[60:63], v[236:239], v[124:127]
    s_waitcnt lgkmcnt(3)
    v_mfma_f32_16x16x32_bf16 v[120:123], v[16:19], v[240:243], v[120:123]
    s_waitcnt lgkmcnt(2)
    v_mfma_f32_16x16x32_bf16 v[124:127], v[20:23], v[244:247], v[124:127]
    s_waitcnt lgkmcnt(1)
    v_mfma_f32_16x16x32_bf16 v[120:123], v[24:27], v[248:251], v[120:123]
    s_waitcnt lgkmcnt(0)
    v_mfma_f32_16x16x32_bf16 v[124:127], v[28:31], v[252:255], v[124:127]
    v_cmp_gt_u32 vcc, 16, v0
    s_nop 6
    v_add_f32 v124, v124, v120
    v_add_f32 v125, v125, v121
    v_cndmask_b32 v124, 0, v124, vcc
    v_cndmask_b32 v125, 0, v125, vcc
    v_cvt_pk_bf16_f32 v117, v124, v125
    v_and_b32 v127, 0xffff0000, v117
    v_lshlrev_b32 v126, 16, v117
    v_sub_f32 v124, v124, v126
    v_sub_f32 v125, v125, v127
    v_cvt_pk_bf16_f32 v116, v126, v124
    v_cvt_pk_bf16_f32 v118, v125, v127
    v_mov_b32 v119, 0
    v_lshrrev_b32 v5, 4, v0
    v_lshrrev_b32 v3, 5, v0
    v_lshlrev_b32 v3, 11, v3
    v_and_b32 v5, 1, v5
    v_lshl_add_u32 v3, v5, 9, v3
    v_and_b32 v5, 15, v0
    v_lshl_add_u32 v3, v5, 4, v3
    v_lshlrev_b32 v111, 4, v5
    v_add_u32 v111, 157952, v111
    s_waitcnt lgkmcnt(0)
    s_mul_i32 s46, s43, 180224
    s_lshl_b32 s47, s58, 11
    s_add_u32 s46, s46, s47
    s_add_u32 s46, s46, 9437184
    s_add_u32 s47, s46, 8192
    s_barrier
    ds_read_b128 v[48:51], v3 offset:0
    ds_read_b128 v[52:55], v3 offset:256
    ds_read_b128 v[56:59], v3 offset:1024
    ds_read_b128 v[60:63], v3 offset:1280
    ds_read_b128 v[64:67], v3 offset:8192
    ds_read_b128 v[68:71], v3 offset:8448
    ds_read_b128 v[72:75], v3 offset:9216
    ds_read_b128 v[76:79], v3 offset:9472
    s_waitcnt lgkmcnt(6)
    v_mfma_f32_16x16x32_bf16 v[16:19], v[128:131], v[48:51], 0
    v_mfma_f32_16x16x32_bf16 v[32:35], v[192:195], v[48:51], 0
    ds_read_b128 v[80:83], v3 offset:16384
    v_mfma_f32_16x16x32_bf16 v[20:23], v[128:131], v[52:55], 0
    v_mfma_f32_16x16x32_bf16 v[36:39], v[192:195], v[52:55], 0
    ds_read_b128 v[84:87], v3 offset:16640
    s_waitcnt lgkmcnt(6)
    v_mfma_f32_16x16x32_bf16 v[24:27], v[128:131], v[56:59], 0
    v_mfma_f32_16x16x32_bf16 v[40:43], v[192:195], v[56:59], 0
    ds_read_b128 v[88:91], v3 offset:24576
    v_mfma_f32_16x16x32_bf16 v[28:31], v[128:131], v[60:63], 0
    v_mfma_f32_16x16x32_bf16 v[44:47], v[192:195], v[60:63], 0
    ds_read_b128 v[92:95], v3 offset:24832
    s_waitcnt lgkmcnt(6)
    v_mfma_f32_16x16x32_bf16 v[16:19], v[136:139], v[64:67], v[16:19]
    v_mfma_f32_16x16x32_bf16 v[32:35], v[200:203], v[64:67], v[32:35]
    ds_read_b128 v[48:51], v3 offset:32768
    v_mfma_f32_16x16x32_bf16 v[20:23], v[136:139], v[68:71], v[20:23]
    v_mfma_f32_16x16x32_bf16 v[36:39], v[200:203], v[68:71], v[36:39]
    ds_read_b128 v[52:55], v3 offset:33024
    s_waitcnt lgkmcnt(6)
    v_mfma_f32_16x16x32_bf16 v[24:27], v[136:139], v[72:75], v[24:27]
    v_mfma_f32_16x16x32_bf16 v[40:43], v[200:203], v[72:75], v[40:43]
    ds_read_b128 v[56:59], v3 offset:40960
    v_mfma_f32_16x16x32_bf16 v[28:31], v[136:139], v[76:79], v[28:31]
    v_mfma_f32_16x16x32_bf16 v[44:47], v[200:203], v[76:79], v[44:47]
    ds_read_b128 v[60:63], v3 offset:41216
    s_waitcnt lgkmcnt(6)
    v_mfma_f32_16x16x32_bf16 v[16:19], v[144:147], v[80:83], v[16:19]
    v_mfma_f32_16x16x32_bf16 v[32:35], v[208:211], v[80:83], v[32:35]
    ds_read_b128 v[64:67], v3 offset:49152
    v_mfma_f32_16x16x32_bf16 v[20:23], v[144:147], v[84:87], v[20:23]
    v_mfma_f32_16x16x32_bf16 v[36:39], v[208:211], v[84:87], v[36:39]
    ds_read_b128 v[68:71], v3 offset:49408
    s_waitcnt lgkmcnt(6)
    v_mfma_f32_16x16x32_bf16 v[16:19], v[152:155], v[88:91], v[16:19]
    v_mfma_f32_16x16x32_bf16 v[32:35], v[216:219], v[88:91], v[32:35]
    ds_read_b128 v[72:75], v3 offset:57344
    v_mfma_f32_16x16x32_bf16 v[20:23], v[152:155], v[92:95], v[20:23]
    v_mfma_f32_16x16x32_bf16 v[36:39], v[216:219], v[92:95], v[36:39]
    ds_read_b128 v[76:79], v3 offset:57600
    s_barrier
    s_waitcnt lgkmcnt(6)
    v_mfma_f32_16x16x32_bf16 v[16:19], v[160:163], v[48:51], v[16:19]
    v_mfma_f32_16x16x32_bf16 v[32:35], v[224:227], v[48:51], v[32:35]
    ds_read_b128 v[80:83], v3 offset:4096
    v_mfma_f32_16x16x32_bf16 v[20:23], v[160:163], v[52:55], v[20:23]
    v_mfma_f32_16x16x32_bf16 v[36:39], v[224:227], v[52:55], v[36:39]
    ds_read_b128 v[84:87], v3 offset:4352
    s_waitcnt lgkmcnt(6)
    v_mfma_f32_16x16x32_bf16 v[16:19], v[168:171], v[56:59], v[16:19]
    v_mfma_f32_16x16x32_bf16 v[32:35], v[232:235], v[56:59], v[32:35]
    ds_read_b128 v[88:91], v3 offset:12288
    v_mfma_f32_16x16x32_bf16 v[20:23], v[168:171], v[60:63], v[20:23]
    v_mfma_f32_16x16x32_bf16 v[36:39], v[232:235], v[60:63], v[36:39]
    ds_read_b128 v[92:95], v3 offset:12544
    s_waitcnt lgkmcnt(6)
    v_mfma_f32_16x16x32_bf16 v[16:19], v[176:179], v[64:67], v[16:19]
    v_mfma_f32_16x16x32_bf16 v[32:35], v[240:243], v[64:67], v[32:35]
    ds_read_b128 v[48:51], v3 offset:20480
    v_mfma_f32_16x16x32_bf16 v[20:23], v[176:179], v[68:71], v[20:23]
    v_mfma_f32_16x16x32_bf16 v[36:39], v[240:243], v[68:71], v[36:39]
    ds_read_b128 v[52:55], v3 offset:20736
    s_waitcnt lgkmcnt(6)
    v_mfma_f32_16x16x32_bf16 v[16:19], v[184:187], v[72:75], v[16:19]
    v_mfma_f32_16x16x32_bf16 v[32:35], v[248:251], v[72:75], v[32:35]
    ds_read_b128 v[56:59], v3 offset:28672
    v_mfma_f32_16x16x32_bf16 v[20:23], v[184:187], v[76:79], v[20:23]
    v_mfma_f32_16x16x32_bf16 v[36:39], v[248:251], v[76:79], v[36:39]
    ds_read_b128 v[60:63], v3 offset:28928
    s_waitcnt lgkmcnt(6)
    v_mfma_f32_16x16x32_bf16 v[16:19], v[132:135], v[80:83], v[16:19]
    v_mfma_f32_16x16x32_bf16 v[32:35], v[196:199], v[80:83], v[32:35]
    ds_read_b128 v[64:67], v3 offset:36864
    v_mfma_f32_16x16x32_bf16 v[20:23], v[132:135], v[84:87], v[20:23]
    v_mfma_f32_16x16x32_bf16 v[36:39], v[196:199], v[84:87], v[36:39]
    ds_read_b128 v[68:71], v3 offset:37120
    s_waitcnt lgkmcnt(6)
    v_mfma_f32_16x16x32_bf16 v[16:19], v[140:143], v[88:91], v[16:19]
    v_mfma_f32_16x16x32_bf16 v[32:35], v[204:207], v[88:91], v[32:35]
    ds_read_b128 v[72:75], v3 offset:45056
    v_mfma_f32_16x16x32_bf16 v[20:23], v[140:143], v[92:95], v[20:23]
    v_mfma_f32_16x16x32_bf16 v[36:39], v[204:207], v[92:95], v[36:39]
    ds_read_b128 v[76:79], v3 offset:45312
    s_waitcnt lgkmcnt(6)
    v_mfma_f32_16x16x32_bf16 v[16:19], v[148:151], v[48:51], v[16:19]
    v_mfma_f32_16x16x32_bf16 v[32:35], v[212:215], v[48:51], v[32:35]
    ds_read_b128 v[80:83], v3 offset:53248
    v_mfma_f32_16x16x32_bf16 v[20:23], v[148:151], v[52:55], v[20:23]
    v_mfma_f32_16x16x32_bf16 v[36:39], v[212:215], v[52:55], v[36:39]
    ds_read_b128 v[84:87], v3 offset:53504
    s_waitcnt lgkmcnt(6)
    v_mfma_f32_16x16x32_bf16 v[16:19], v[156:159], v[56:59], v[16:19]
    v_mfma_f32_16x16x32_bf16 v[32:35], v[220:223], v[56:59], v[32:35]
    ds_read_b128 v[88:91], v3 offset:61440
    v_mfma_f32_16x16x32_bf16 v[20:23], v[156:159], v[60:63], v[20:23]
    v_mfma_f32_16x16x32_bf16 v[36:39], v[220:223], v[60:63], v[36:39]
    ds_read_b128 v[92:95], v3 offset:61696
    s_barrier
    s_waitcnt lgkmcnt(6)
    v_mfma_f32_16x16x32_bf16 v[16:19], v[164:167], v[64:67], v[16:19]
    v_mfma_f32_16x16x32_bf16 v[32:35], v[228:231], v[64:67], v[32:35]
    ds_read_b128 v[48:51], v111 offset:0
    v_mfma_f32_16x16x32_bf16 v[20:23], v[164:167], v[68:71], v[20:23]
    v_mfma_f32_16x16x32_bf16 v[36:39], v[228:231], v[68:71], v[36:39]
    ds_read_b128 v[52:55], v111 offset:256
    s_waitcnt lgkmcnt(6)
    v_mfma_f32_16x16x32_bf16 v[16:19], v[172:175], v[72:75], v[16:19]
    v_mfma_f32_16x16x32_bf16 v[32:35], v[236:239], v[72:75], v[32:35]
    ds_read_b128 v[56:59], v3 offset:17408
    v_mfma_f32_16x16x32_bf16 v[20:23], v[172:175], v[76:79], v[20:23]
    v_mfma_f32_16x16x32_bf16 v[36:39], v[236:239], v[76:79], v[36:39]
    ds_read_b128 v[60:63], v3 offset:17664
    s_waitcnt lgkmcnt(6)
    v_mfma_f32_16x16x32_bf16 v[16:19], v[180:183], v[80:83], v[16:19]
    v_mfma_f32_16x16x32_bf16 v[32:35], v[244:247], v[80:83], v[32:35]
    ds_read_b128 v[64:67], v3 offset:25600
    v_mfma_f32_16x16x32_bf16 v[20:23], v[180:183], v[84:87], v[20:23]
    v_mfma_f32_16x16x32_bf16 v[36:39], v[244:247], v[84:87], v[36:39]
    ds_read_b128 v[68:71], v3 offset:25856
    s_waitcnt lgkmcnt(6)
    v_mfma_f32_16x16x32_bf16 v[16:19], v[188:191], v[88:91], v[16:19]
    v_mfma_f32_16x16x32_bf16 v[32:35], v[252:255], v[88:91], v[32:35]
    ds_read_b128 v[72:75], v3 offset:33792
    v_mfma_f32_16x16x32_bf16 v[20:23], v[188:191], v[92:95], v[20:23]
    v_mfma_f32_16x16x32_bf16 v[36:39], v[252:255], v[92:95], v[36:39]
    ds_read_b128 v[76:79], v3 offset:34048
    s_waitcnt lgkmcnt(6)
    v_mfma_f32_16x16x32_bf16 v[16:19], v[112:115], v[48:51], v[16:19]
    v_mfma_f32_16x16x32_bf16 v[32:35], v[116:119], v[48:51], v[32:35]
    ds_read_b128 v[80:83], v3 offset:41984
    v_mfma_f32_16x16x32_bf16 v[20:23], v[112:115], v[52:55], v[20:23]
    v_mfma_f32_16x16x32_bf16 v[36:39], v[116:119], v[52:55], v[36:39]
    ds_read_b128 v[84:87], v3 offset:42240
    s_waitcnt lgkmcnt(6)
    v_mfma_f32_16x16x32_bf16 v[24:27], v[144:147], v[56:59], v[24:27]
    v_mfma_f32_16x16x32_bf16 v[40:43], v[208:211], v[56:59], v[40:43]
    ds_read_b128 v[88:91], v3 offset:50176
    v_mfma_f32_16x16x32_bf16 v[28:31], v[144:147], v[60:63], v[28:31]
    v_mfma_f32_16x16x32_bf16 v[44:47], v[208:211], v[60:63], v[44:47]
    ds_read_b128 v[92:95], v3 offset:50432
    s_waitcnt lgkmcnt(6)
    v_mfma_f32_16x16x32_bf16 v[24:27], v[152:155], v[64:67], v[24:27]
    v_cvt_pk_bf16_f32 v96, v16, v17
    v_cvt_pk_bf16_f32 v97, v18, v19
    v_mfma_f32_16x16x32_bf16 v[40:43], v[216:219], v[64:67], v[40:43]
    v_cvt_pk_bf16_f32 v98, v20, v21
    v_cvt_pk_bf16_f32 v99, v22, v23
    ds_read_b128 v[48:51], v3 offset:58368
    v_mfma_f32_16x16x32_bf16 v[28:31], v[152:155], v[68:71], v[28:31]
    v_pk_max_i16 v96, v96, 0
    v_pk_max_i16 v98, v98, 0
    v_mfma_f32_16x16x32_bf16 v[44:47], v[216:219], v[68:71], v[44:47]
    v_pk_max_i16 v97, v97, 0
    v_pk_max_i16 v99, v99, 0
    ds_read_b128 v[52:55], v3 offset:58624
    s_waitcnt lgkmcnt(6)
    v_mfma_f32_16x16x32_bf16 v[24:27], v[160:163], v[72:75], v[24:27]
    v_permlane16_swap_b32 v96, v98
    v_permlane16_swap_b32 v97, v99
    v_mfma_f32_16x16x32_bf16 v[40:43], v[224:227], v[72:75], v[40:43]
    buffer_store_dwordx4 v[96:99], v2, s[4:7], s46 offen offset:0 sc1
    v_cvt_pk_bf16_f32 v100, v32, v33
    ds_read_b128 v[56:59], v3 offset:5120
    v_mfma_f32_16x16x32_bf16 v[28:31], v[160:163], v[76:79], v[28:31]
    v_cvt_pk_bf16_f32 v101, v34, v35
    v_cvt_pk_bf16_f32 v102, v36, v37
    v_mfma_f32_16x16x32_bf16 v[44:47], v[224:227], v[76:79], v[44:47]
    v_cvt_pk_bf16_f32 v103, v38, v39
    v_pk_max_i16 v100, v100, 0
    ds_read_b128 v[60:63], v3 offset:5376
    s_waitcnt lgkmcnt(6)
    v_mfma_f32_16x16x32_bf16 v[24:27], v[168:171], v[80:83], v[24:27]
    v_pk_max_i16 v102, v102, 0
    v_pk_max_i16 v101, v101, 0
    v_mfma_f32_16x16x32_bf16 v[40:43], v[232:235], v[80:83], v[40:43]
    v_pk_max_i16 v103, v103, 0
    v_permlane16_swap_b32 v100, v102
    ds_read_b128 v[64:67], v3 offset:13312
    v_mfma_f32_16x16x32_bf16 v[28:31], v[168:171], v[84:87], v[28:31]
    v_permlane16_swap_b32 v101, v103
    buffer_store_dwordx4 v[100:103], v2, s[4:7], s47 offen offset:0 sc1
    v_mfma_f32_16x16x32_bf16 v[44:47], v[232:235], v[84:87], v[44:47]
    ds_read_b128 v[68:71], v3 offset:13568
    s_waitcnt lgkmcnt(6)
    v_mfma_f32_16x16x32_bf16 v[24:27], v[176:179], v[88:91], v[24:27]
    v_mfma_f32_16x16x32_bf16 v[40:43], v[240:243], v[88:91], v[40:43]
    ds_read_b128 v[72:75], v3 offset:21504
    v_mfma_f32_16x16x32_bf16 v[28:31], v[176:179], v[92:95], v[28:31]
    v_mfma_f32_16x16x32_bf16 v[44:47], v[240:243], v[92:95], v[44:47]
    ds_read_b128 v[76:79], v3 offset:21760
    s_waitcnt lgkmcnt(6)
    v_mfma_f32_16x16x32_bf16 v[24:27], v[184:187], v[48:51], v[24:27]
    v_mfma_f32_16x16x32_bf16 v[40:43], v[248:251], v[48:51], v[40:43]
    ds_read_b128 v[80:83], v3 offset:29696
    v_mfma_f32_16x16x32_bf16 v[28:31], v[184:187], v[52:55], v[28:31]
    v_mfma_f32_16x16x32_bf16 v[44:47], v[248:251], v[52:55], v[44:47]
    ds_read_b128 v[84:87], v3 offset:29952
    s_waitcnt lgkmcnt(6)
    v_mfma_f32_16x16x32_bf16 v[24:27], v[132:135], v[56:59], v[24:27]
    v_mfma_f32_16x16x32_bf16 v[40:43], v[196:199], v[56:59], v[40:43]
    ds_read_b128 v[88:91], v3 offset:37888
    v_mfma_f32_16x16x32_bf16 v[28:31], v[132:135], v[60:63], v[28:31]
    v_mfma_f32_16x16x32_bf16 v[44:47], v[196:199], v[60:63], v[44:47]
    ds_read_b128 v[92:95], v3 offset:38144
    s_waitcnt lgkmcnt(6)
    v_mfma_f32_16x16x32_bf16 v[24:27], v[140:143], v[64:67], v[24:27]
    v_mfma_f32_16x16x32_bf16 v[40:43], v[204:207], v[64:67], v[40:43]
    ds_read_b128 v[48:51], v3 offset:46080
    v_mfma_f32_16x16x32_bf16 v[28:31], v[140:143], v[68:71], v[28:31]
    v_mfma_f32_16x16x32_bf16 v[44:47], v[204:207], v[68:71], v[44:47]
    ds_read_b128 v[52:55], v3 offset:46336
    s_waitcnt lgkmcnt(6)
    v_mfma_f32_16x16x32_bf16 v[24:27], v[148:151], v[72:75], v[24:27]
    v_mfma_f32_16x16x32_bf16 v[40:43], v[212:215], v[72:75], v[40:43]
    ds_read_b128 v[56:59], v3 offset:54272
    v_mfma_f32_16x16x32_bf16 v[28:31], v[148:151], v[76:79], v[28:31]
    v_mfma_f32_16x16x32_bf16 v[44:47], v[212:215], v[76:79], v[44:47]
    ds_read_b128 v[60:63], v3 offset:54528
    s_waitcnt lgkmcnt(6)
    v_mfma_f32_16x16x32_bf16 v[24:27], v[156:159], v[80:83], v[24:27]
    v_mfma_f32_16x16x32_bf16 v[40:43], v[220:223], v[80:83], v[40:43]
    ds_read_b128 v[64:67], v3 offset:62464
    v_mfma_f32_16x16x32_bf16 v[28:31], v[156:159], v[84:87], v[28:31]
    v_mfma_f32_16x16x32_bf16 v[44:47], v[220:223], v[84:87], v[44:47]
    ds_read_b128 v[68:71], v3 offset:62720
    s_waitcnt lgkmcnt(6)
    v_mfma_f32_16x16x32_bf16 v[24:27], v[164:167], v[88:91], v[24:27]
    v_mfma_f32_16x16x32_bf16 v[40:43], v[228:231], v[88:91], v[40:43]
    ds_read_b128 v[72:75], v111 offset:512
    v_mfma_f32_16x16x32_bf16 v[28:31], v[164:167], v[92:95], v[28:31]
    v_mfma_f32_16x16x32_bf16 v[44:47], v[228:231], v[92:95], v[44:47]
    ds_read_b128 v[76:79], v111 offset:768
    s_waitcnt lgkmcnt(6)
    v_mfma_f32_16x16x32_bf16 v[24:27], v[172:175], v[48:51], v[24:27]
    v_mfma_f32_16x16x32_bf16 v[40:43], v[236:239], v[48:51], v[40:43]
    v_mfma_f32_16x16x32_bf16 v[28:31], v[172:175], v[52:55], v[28:31]
    v_mfma_f32_16x16x32_bf16 v[44:47], v[236:239], v[52:55], v[44:47]
    s_waitcnt lgkmcnt(4)
    v_mfma_f32_16x16x32_bf16 v[24:27], v[180:183], v[56:59], v[24:27]
    v_mfma_f32_16x16x32_bf16 v[40:43], v[244:247], v[56:59], v[40:43]
    v_mfma_f32_16x16x32_bf16 v[28:31], v[180:183], v[60:63], v[28:31]
    v_mfma_f32_16x16x32_bf16 v[44:47], v[244:247], v[60:63], v[44:47]
    s_waitcnt lgkmcnt(2)
    v_mfma_f32_16x16x32_bf16 v[24:27], v[188:191], v[64:67], v[24:27]
    v_mfma_f32_16x16x32_bf16 v[40:43], v[252:255], v[64:67], v[40:43]
    v_mfma_f32_16x16x32_bf16 v[28:31], v[188:191], v[68:71], v[28:31]
    v_mfma_f32_16x16x32_bf16 v[44:47], v[252:255], v[68:71], v[44:47]
    s_waitcnt lgkmcnt(0)
    v_mfma_f32_16x16x32_bf16 v[24:27], v[112:115], v[72:75], v[24:27]
    v_mfma_f32_16x16x32_bf16 v[40:43], v[116:119], v[72:75], v[40:43]
    v_mfma_f32_16x16x32_bf16 v[28:31], v[112:115], v[76:79], v[28:31]
    v_mfma_f32_16x16x32_bf16 v[44:47], v[116:119], v[76:79], v[44:47]
    s_nop 4
    v_cvt_pk_bf16_f32 v120, v24, v25
    v_cvt_pk_bf16_f32 v121, v26, v27
    v_cvt_pk_bf16_f32 v122, v28, v29
    v_cvt_pk_bf16_f32 v123, v30, v31
    v_pk_max_i16 v120, v120, 0
    v_pk_max_i16 v122, v122, 0
    v_pk_max_i16 v121, v121, 0
    v_pk_max_i16 v123, v123, 0
    v_permlane16_swap_b32 v120, v122
    s_nop 0
    v_permlane16_swap_b32 v121, v123
    buffer_store_dwordx4 v[120:123], v2, s[4:7], s46 offen offset:1024 sc1
    v_cvt_pk_bf16_f32 v124, v40, v41
    v_cvt_pk_bf16_f32 v125, v42, v43
    v_cvt_pk_bf16_f32 v126, v44, v45
    v_cvt_pk_bf16_f32 v127, v46, v47
    v_pk_max_i16 v124, v124, 0
    v_pk_max_i16 v126, v126, 0
    v_pk_max_i16 v125, v125, 0
    v_pk_max_i16 v127, v127, 0
    v_permlane16_swap_b32 v124, v126
    s_nop 0
    v_permlane16_swap_b32 v125, v127
    buffer_store_dwordx4 v[124:127], v2, s[4:7], s47 offen offset:1024 sc1
    s_setprio 0
    s_lshl_b32 s46, s40, 11
    s_add_u32 s46, s46, 122880
    v_add_u32 v3, s46, v2
    ds_write_b128 v3, v[8:11]
    ds_write_b128 v3, v[12:15] offset:1024
    s_lshl_b32 s48, s40, 11
    s_mul_i32 s49, s43, 180224
    s_mul_i32 s47, s40, 22528
    s_add_u32 s49, s49, s47
    s_add_u32 s49, s49, 9437184
    s_waitcnt lgkmcnt(0)
    v_mul_u32_u24 v16, 512, v0
    v_mul_u32_u24 v17, 5120, v0
    s_add_u32 s46, s84, 65024
    s_add_u32 s51, s86, -3968
    s_waitcnt vmcnt(0)
    s_barrier
    s_mov_b64 exec, 3
    s_mov_b32 s52, 400000
L_pp_h_145:
    s_and_b32 s50, s52, 7
    s_cmp_eq_u32 s50, 1
    s_cbranch_scc1 L_ppg_146
    buffer_load_dword v5, v17, s[4:7], s51 offen sc1
    s_branch L_ppc_147
L_ppg_146:
    buffer_load_dword v5, v16, s[4:7], s46 offen sc1
L_ppc_147:
    s_sub_u32 s52, s52, 1
    s_cmp_eq_u32 s52, 0
    s_waitcnt vmcnt(0)
    s_cbranch_scc1 L_ppd_148
    v_cmp_ne_u32 vcc, s45, v5
    s_nop 0
    s_cbranch_vccnz L_pp_h_145
L_ppd_148:
    s_mov_b64 exec, -1
    s_setprio 3
    s_add_u32 m0, s48, -8192
    s_add_u32 s50, s49, -90112
    buffer_load_dwordx4 v2, s[4:7], s50 offen offset:0 sc1 lds
    buffer_load_dwordx4 v2, s[4:7], s50 offen offset:1024 sc1 lds
    s_add_u32 m0, s48, 0
    s_add_u32 s50, s49, 0
    buffer_load_dwordx4 v2, s[4:7], s50 offen offset:0 sc1 lds
    buffer_load_dwordx4 v2, s[4:7], s50 offen offset:1024 sc1 lds
    s_setprio 2
    s_add_u32 m0, s48, 8192
    s_add_u32 s50, s49, -88064
    buffer_load_dwordx4 v2, s[4:7], s50 offen offset:0 sc1 lds
    buffer_load_dwordx4 v2, s[4:7], s50 offen offset:1024 sc1 lds
    s_add_u32 m0, s48, 16384
    s_add_u32 s50, s49, 2048
    buffer_load_dwordx4 v2, s[4:7], s50 offen offset:0 sc1 lds
    buffer_load_dwordx4 v2, s[4:7], s50 offen offset:1024 sc1 lds
    s_setprio 1
    s_add_u32 m0, s48, 24576
    s_add_u32 s50, s49, -86016
    buffer_load_dwordx4 v2, s[4:7], s50 offen offset:0 sc1 lds
    buffer_load_dwordx4 v2, s[4:7], s50 offen offset:1024 sc1 lds
    s_add_u32 m0, s48, 32768
    s_add_u32 s50, s49, 4096
    buffer_load_dwordx4 v2, s[4:7], s50 offen offset:0 sc1 lds
    buffer_load_dwordx4 v2, s[4:7], s50 offen offset:1024 sc1 lds
    s_setprio 0
    s_add_u32 m0, s48, 40960
    s_add_u32 s50, s49, -83968
    buffer_load_dwordx4 v2, s[4:7], s50 offen offset:0 sc1 lds
    buffer_load_dwordx4 v2, s[4:7], s50 offen offset:1024 sc1 lds
    s_add_u32 m0, s48, 49152
    s_add_u32 s50, s49, 6144
    buffer_load_dwordx4 v2, s[4:7], s50 offen offset:0 sc1 lds
    buffer_load_dwordx4 v2, s[4:7], s50 offen offset:1024 sc1 lds
    s_waitcnt vmcnt(12)
    s_barrier
    s_add_u32 m0, s48, 57344
    s_add_u32 s50, s49, -81920
    buffer_load_dwordx4 v2, s[4:7], s50 offen offset:0 sc1 lds
    buffer_load_dwordx4 v2, s[4:7], s50 offen offset:1024 sc1 lds
    s_add_u32 m0, s48, 65536
    s_add_u32 s50, s49, 8192
    buffer_load_dwordx4 v2, s[4:7], s50 offen offset:0 sc1 lds
    buffer_load_dwordx4 v2, s[4:7], s50 offen offset:1024 sc1 lds
    s_waitcnt vmcnt(12)
    s_barrier
    s_add_u32 m0, s48, 73728
    s_add_u32 s50, s49, -79872
    buffer_load_dwordx4 v2, s[4:7], s50 offen offset:0 sc1 lds
    buffer_load_dwordx4 v2, s[4:7], s50 offen offset:1024 sc1 lds
    s_add_u32 m0, s48, 81920
    s_add_u32 s50, s49, 10240
    buffer_load_dwordx4 v2, s[4:7], s50 offen offset:0 sc1 lds
    buffer_load_dwordx4 v2, s[4:7], s50 offen offset:1024 sc1 lds
    s_waitcnt vmcnt(12)
    s_barrier
    s_add_u32 m0, s48, 90112
    s_add_u32 s50, s49, -77824
    buffer_load_dwordx4 v2, s[4:7], s50 offen offset:0 sc1 lds
    buffer_load_dwordx4 v2, s[4:7], s50 offen offset:1024 sc1 lds
    s_add_u32 m0, s48, 98304
    s_add_u32 s50, s49, 12288
    buffer_load_dwordx4 v2, s[4:7], s50 offen offset:0 sc1 lds
    buffer_load_dwordx4 v2, s[4:7], s50 offen offset:1024 sc1 lds
    s_waitcnt vmcnt(12)
    s_barrier
    s_add_u32 m0, s48, 106496
    s_add_u32 s50, s49, -75776
    buffer_load_dwordx4 v2, s[4:7], s50 offen offset:0 sc1 lds
    buffer_load_dwordx4 v2, s[4:7], s50 offen offset:1024 sc1 lds
    s_add_u32 m0, s48, 114688
    s_add_u32 s50, s49, 14336
    buffer_load_dwordx4 v2, s[4:7], s50 offen offset:0 sc1 lds
    buffer_load_dwordx4 v2, s[4:7], s50 offen offset:1024 sc1 lds
    s_waitcnt vmcnt(12)
    s_barrier
    s_add_u32 m0, s48, -8192
    s_add_u32 s50, s49, -73728
    buffer_load_dwordx4 v2, s[4:7], s50 offen offset:0 sc1 lds
    buffer_load_dwordx4 v2, s[4:7], s50 offen offset:1024 sc1 lds
    s_add_u32 m0, s48, 0
    s_add_u32 s50, s49, 16384
    buffer_load_dwordx4 v2, s[4:7], s50 offen offset:0 sc1 lds
    buffer_load_dwordx4 v2, s[4:7], s50 offen offset:1024 sc1 lds
    s_waitcnt vmcnt(12)
    s_barrier
    s_add_u32 m0, s48, 8192
    s_add_u32 s50, s49, -71680
    buffer_load_dwordx4 v2, s[4:7], s50 offen offset:0 sc1 lds
    buffer_load_dwordx4 v2, s[4:7], s50 offen offset:1024 sc1 lds
    s_add_u32 m0, s48, 16384
    s_add_u32 s50, s49, 18432
    buffer_load_dwordx4 v2, s[4:7], s50 offen offset:0 sc1 lds
    buffer_load_dwordx4 v2, s[4:7], s50 offen offset:1024 sc1 lds
    s_waitcnt vmcnt(12)
    s_barrier
    s_add_u32 m0, s48, 24576
    s_add_u32 s50, s49, -69632
    buffer_load_dwordx4 v2, s[4:7], s50 offen offset:0 sc1 lds
    buffer_load_dwordx4 v2, s[4:7], s50 offen offset:1024 sc1 lds
    s_add_u32 m0, s48, 32768
    s_add_u32 s50, s49, 20480
    buffer_load_dwordx4 v2, s[4:7], s50 offen offset:0 sc1 lds
    buffer_load_dwordx4 v2, s[4:7], s50 offen offset:1024 sc1 lds
    s_waitcnt vmcnt(12)
    s_barrier
    s_waitcnt vmcnt(8)
    s_barrier
    s_waitcnt vmcnt(4)
    s_barrier
    s_waitcnt vmcnt(0)
    s_barrier
    s_barrier
    s_endpgm
L_exit:
    s_endpgm
L_code_end:
.section .rodata,"a"
.p2align 6
.amdhsa_kernel adaLN_cond__softmax_full_mha__dense_activation_relu__prompt_kernel
  .amdhsa_next_free_vgpr 256
  .amdhsa_next_free_sgpr 102
  .amdhsa_accum_offset 256
  .amdhsa_group_segment_fixed_size 0
  .amdhsa_kernarg_size 88
  .amdhsa_user_sgpr_count 2
  .amdhsa_user_sgpr_kernarg_segment_ptr 1
  .amdhsa_system_sgpr_workgroup_id_x 1
.end_amdhsa_kernel
```
